```python
import torch

def _softmax(x, axis=-1):
    return torch.softmax(x, dim=axis)
def _gelu(x):
    return torch.nn.functional.gelu(x, approximate="tanh")
def _silu(x):
    return torch.nn.functional.silu(x)
def _sigmoid(x):
    return torch.sigmoid(x)
def _layernorm(x, axis=-1, eps=1e-5):
    m = x.mean(dim=axis, keepdim=True)
    v = x.var(dim=axis, keepdim=True, unbiased=False)
    return (x - m) / torch.sqrt(v + eps)
def _scatter_add(tgt, idx, src, axis=0):
    return tgt.clone().index_add_(axis, idx, src)
def _segment_sum(src, seg, n):
    out = torch.zeros((n,) + src.shape[1:], dtype=src.dtype)
    return out.index_add_(0, seg, src)
def _pad(x, pw):
    flat = tuple(v for pair in reversed(pw) for v in pair)
    return torch.nn.functional.pad(x, flat)

kernel_name = 'parallel_sum__mha_block__geglu_ffn__prompt'

def setup_inputs():

    _w = (lambda a: (lambda t: t.to(torch.bfloat16) if t.is_floating_point() else t)(torch.as_tensor(a)))
    def _A_setup():
        B, S, D, H = 1, 2048, 512, 32
        return {
            "x": _w((lambda *s: torch.randn(*s, dtype=torch.bfloat16) * 0.05)(B, S, D)),
            "wqkv": _w((lambda *s: torch.randn(*s, dtype=torch.bfloat16) * 0.2)(D, 3 * D)),
            "wo": _w((lambda *s: torch.randn(*s, dtype=torch.bfloat16) * 0.1)(D, D)),
        }
    _A_in = _A_setup()

    def _B_setup():
        B, S, D, F = 1, 2048, 512, 1792
        return {
            "x": _w((lambda *s: torch.randn(*s, dtype=torch.bfloat16) * 0.05)(B, S, D)),
            "w_gate": _w((lambda *s: torch.randn(*s, dtype=torch.bfloat16) * 0.1)(D, F)),
            "w_up": _w((lambda *s: torch.randn(*s, dtype=torch.bfloat16) * 0.1)(D, F)),
            "w_down": _w((lambda *s: torch.randn(*s, dtype=torch.bfloat16) * 0.1)(F, D)),
        }
    _B_in = _B_setup()

    return {
        "A_x": _A_in["x"],
        "A_wqkv": _A_in["wqkv"],
        "A_wo": _A_in["wo"],
        "B_x": _B_in["x"],
        "B_w_gate": _B_in["w_gate"],
        "B_w_up": _B_in["w_up"],
        "B_w_down": _B_in["w_down"],
    }

def reference(A_x, A_wqkv, A_wo, B_x, B_w_gate, B_w_up, B_w_down):
    def _A_ref(x, wqkv, wo):
        B, S, D = x.shape
        H = 32
        Dh = D // H
        qkv = (lambda x, *d: x.permute(*d))((x @ wqkv).reshape(B, S, 3, H, Dh), 2, 0, 3, 1, 4)
        q, k, v = qkv[0], qkv[1], qkv[2]
        scores = torch.einsum("bhqd,bhkd->bhqk", q, k) * (Dh ** -0.5)
        p = _softmax(scores, axis=-1)
        o = torch.einsum("bhqk,bhkd->bhqd", p, v)
        return (lambda x, *d: x.permute(*d))(o, 0, 2, 1, 3).reshape(B, S, D) @ wo

    def _B_ref(x, w_gate, w_up, w_down):
        return (_gelu(x @ w_gate) * (x @ w_up)) @ w_down

    x = A_x
    xn = _layernorm(x, axis=-1)
    return x + _A_ref(xn, A_wqkv, A_wo) + _B_ref(xn, B_w_gate, B_w_up, B_w_down)
```

```asm
; @launch grid=(256,1,1) block=(512,1,1) lds=163840
.amdgcn_target "amdgcn-amd-amdhsa--gfx950"
.text
.globl parallel_sum__mha_block__geglu_ffn__prompt_kernel
.p2align 8
.type parallel_sum__mha_block__geglu_ffn__prompt_kernel,@function
parallel_sum__mha_block__geglu_ffn__prompt_kernel:
s_cmp_ge_u32 s2, 256
s_cbranch_scc1 parallel_sum__mha_block__geglu_ffn__prompt_kernel_end
s_getpc_b64 s[78:79]
parallel_sum__mha_block__geglu_ffn__prompt_kernel_pc:
s_load_dwordx4 s[48:51], s[0:1], 0
s_load_dwordx4 s[52:55], s[0:1], 32
s_load_dwordx2 s[56:57], s[0:1], 72
s_load_dwordx2 s[92:93], s[0:1], 64
v_and_b32 v1, 63, v0
v_lshrrev_b32 v4, 6, v0
v_and_b32 v2, 15, v0
v_readfirstlane_b32 s28, v4
v_bfe_u32 v3, v0, 4, 2
s_and_b32 s33, s2, 1
s_lshl_b32 s33, s33, 3
s_lshr_b32 s34, s2, 3
s_and_b32 s34, s34, 7
s_add_u32 s29, s33, s34
s_lshr_b32 s33, s2, 1
s_and_b32 s33, s33, 3
s_lshl_b32 s33, s33, 2
s_lshr_b32 s34, s2, 6
s_add_u32 s30, s33, s34
s_and_b32 s31, s28, 1
s_lshr_b32 s32, s28, 1
s_cmp_ge_u32 s30, 14
s_cselect_b32 s43, 1, 0
s_lshr_b32 s58, s32, 1
s_xor_b32 s58, s58, s31
s_cmp_eq_u32 s43, 1
s_mov_b32 s35, 3584
s_cmov_b32 s35, 3072
s_lshl_b32 s36, s29, 17
s_lshl_b32 s37, s30, 7
s_lshl_b32 s38, s30, 8
s_sub_u32 s33, s30, 14
s_lshl_b32 s33, s33, 9
s_add_u32 s33, s33, 2048
s_cmp_eq_u32 s43, 1
s_cselect_b32 s38, s33, s38
s_cselect_b32 s33, 256, 0
s_add_u32 s39, s38, s33
s_lshl_b32 s46, s35, 5
s_sub_u32 s75, s38, s46
s_sub_u32 s76, s39, s46
s_mov_b32 s80, 0
s_mov_b32 s81, 0
v_lshrrev_b32 v7, 3, v1
v_and_b32 v8, 7, v1
s_lshl_b32 s33, s28, 4
v_add_u32 v4, s33, v7
v_lshlrev_b32 v4, 10, v4
v_xor_b32 v5, v8, v3
v_lshl_add_u32 v10, v5, 4, v4
v_xor_b32 v11, 64, v10
v_add_u32 v11, 8192, v11
v_bfe_u32 v6, v1, 4, 1
s_and_b32 s33, s28, 1
s_lshl_b32 s33, s33, 1
v_or_b32 v6, s33, v6
v_lshlrev_b32 v6, 1, v6
v_xor_b32 v5, v8, v6
s_lshl_b32 s33, s28, 3
v_add_u32 v4, s33, v7
v_mul_u32_u24 v4, 3072, v4
v_lshl_add_u32 v12, v5, 4, v4
s_lshr_b32 s33, s28, 1
s_and_b32 s33, s33, 1
s_lshl_b32 s33, s33, 2
v_or_b32 v6, s33, v3
v_lshlrev_b32 v6, 1, v6
v_xor_b32 v5, v2, v6
s_lshl_b32 s33, s28, 2
v_add_u32 v4, s33, v3
v_mul_lo_u32 v4, v4, s35
v_lshl_add_u32 v13, v5, 4, v4
s_lshl_b32 s40, s28, 11
s_lshl_b32 s41, s28, 10
s_add_u32 s41, s41, 16384
s_lshl_b32 s42, s28, 10
s_add_u32 s42, s42, 73728
s_waitcnt lgkmcnt(0)
s_mov_b32 s8, s48
s_and_b32 s9, s49, 0xffff
s_mov_b32 s10, 0x200000
s_mov_b32 s11, 0x20000
s_mov_b32 s12, s50
s_and_b32 s13, s51, 0xffff
s_mov_b32 s14, 0x180000
s_mov_b32 s15, 0x20000
s_add_u32 m0, s40, 0
s_add_u32 s82, s36, 0
buffer_load_dwordx4 v10, s[8:11], s82 offen sc1 lds
s_add_u32 m0, s40, 1024
s_add_u32 s33, s37, 0
buffer_load_dwordx4 v11, s[8:11], s82 offen sc1 lds
s_add_u32 m0, s41, 0
s_nop 0
buffer_load_dwordx4 v12, s[12:15], s33 offen sc1 lds
s_cmp_eq_u32 s43, 1
s_cselect_b32 s16, s50, s52
s_cselect_b32 s17, s51, s53
s_mov_b32 s18, 1835008
s_cmov_b32 s18, 1572864
s_mov_b32 s19, 0x20000
s_cselect_b32 s20, s50, s54
s_cselect_b32 s21, s51, s55
s_mov_b32 s22, 1835008
s_cmov_b32 s22, 1572864
s_mov_b32 s23, 0x20000
s_and_b32 s17, s17, 0xffff
s_and_b32 s21, s21, 0xffff
s_add_u32 m0, s42, 0
s_add_u32 s75, s75, s46
buffer_load_dwordx4 v13, s[16:19], s75 offen sc1 lds
s_lshl_b32 s69, s31, 6
v_add_u32 v4, s69, v2
v_lshlrev_b32 v4, 7, v4
v_lshrrev_b32 v5, 1, v2
v_xor_b32 v5, v5, v3
v_lshl_add_u32 v14, v5, 4, v4
v_xor_b32 v15, 64, v14
s_lshl_b32 s69, s32, 11
v_add_u32 v31, s69, v14
s_add_u32 m0, s42, 8192
s_add_u32 s76, s76, s46
buffer_load_dwordx4 v13, s[20:23], s76 offen sc1 lds
v_add_u32 v32, s69, v15
v_lshrrev_b32 v8, 2, v2
v_and_b32 v9, 3, v2
v_lshl_add_u32 v4, v3, 3, v8
v_lshrrev_b32 v5, 1, v8
v_and_b32 v6, 1, v3
v_lshl_or_b32 v5, v6, 1, v5
v_xor_b32 v5, s32, v5
v_lshlrev_b32 v5, 1, v5
s_add_u32 m0, s42, 16384
s_add_u32 s75, s75, s46
buffer_load_dwordx4 v13, s[16:19], s75 offen sc1 lds
v_lshrrev_b32 v6, 1, v9
v_add_u32 v5, v5, v6
v_lshlrev_b32 v5, 4, v5
v_and_b32 v6, 1, v9
v_lshl_add_u32 v5, v6, 3, v5
v_lshl_add_u32 v16, v4, 7, v5
v_add_u32 v16, 16384, v16
v_and_b32 v6, 1, v3
v_lshl_or_b32 v5, v6, 2, v8
s_add_u32 m0, s42, 24576
s_add_u32 s76, s76, s46
buffer_load_dwordx4 v13, s[20:23], s76 offen sc1 lds
v_lshlrev_b32 v5, 1, v5
v_lshrrev_b32 v6, 1, v9
v_xor_b32 v5, v5, v6
v_lshlrev_b32 v5, 4, v5
v_and_b32 v6, 1, v9
v_lshl_add_u32 v5, v6, 3, v5
v_lshl_add_u32 v5, v4, 8, v5
s_lshl_b32 s69, s32, 1
s_add_u32 s69, s69, 0
s_add_u32 m0, s40, 24576
s_add_u32 s82, s36, 128
buffer_load_dwordx4 v10, s[8:11], s82 offen sc1 lds
s_lshl_b32 s69, s69, 5
s_add_u32 s69, s69, 0
s_and_b32 s70, s32, 1
s_lshl_b32 s70, s70, 2
s_add_u32 s70, s70, 0
s_lshl_b32 s70, s70, 5
s_lshr_b32 s71, s32, 1
s_lshl_b32 s71, s71, 13
s_add_u32 s70, s70, s71
s_add_u32 m0, s40, 25600
s_add_u32 s33, s37, 196608
buffer_load_dwordx4 v11, s[8:11], s82 offen sc1 lds
s_add_u32 m0, s41, 24576
s_nop 0
buffer_load_dwordx4 v12, s[12:15], s33 offen sc1 lds
s_cmp_eq_u32 s43, 1
s_cselect_b32 s69, s70, s69
v_xor_b32 v17, s69, v5
v_add_u32 v17, 73728, v17
v_add_u32 v21, 32768, v17
s_lshl_b32 s69, s32, 1
s_add_u32 s69, s69, 1
s_lshl_b32 s69, s69, 5
s_add_u32 s69, s69, 0
s_add_u32 m0, s42, 32768
s_add_u32 s75, s75, s46
buffer_load_dwordx4 v13, s[16:19], s75 offen sc1 lds
s_and_b32 s70, s32, 1
s_lshl_b32 s70, s70, 2
s_add_u32 s70, s70, 1
s_lshl_b32 s70, s70, 5
s_lshr_b32 s71, s32, 1
s_lshl_b32 s71, s71, 13
s_add_u32 s70, s70, s71
s_cmp_eq_u32 s43, 1
s_cselect_b32 s69, s70, s69
v_xor_b32 v18, s69, v5
s_add_u32 m0, s42, 40960
s_add_u32 s76, s76, s46
buffer_load_dwordx4 v13, s[20:23], s76 offen sc1 lds
v_add_u32 v18, 73728, v18
v_add_u32 v22, 32768, v18
s_lshl_b32 s69, s32, 1
s_add_u32 s69, s69, 0
s_lshl_b32 s69, s69, 5
s_add_u32 s69, s69, 8192
s_and_b32 s70, s32, 1
s_lshl_b32 s70, s70, 2
s_add_u32 s70, s70, 2
s_lshl_b32 s70, s70, 5
s_lshr_b32 s71, s32, 1
s_lshl_b32 s71, s71, 13
s_add_u32 s70, s70, s71
s_cmp_eq_u32 s43, 1
s_cselect_b32 s69, s70, s69
v_xor_b32 v19, s69, v5
v_add_u32 v19, 73728, v19
v_add_u32 v23, 32768, v19
s_lshl_b32 s69, s32, 1
s_add_u32 s69, s69, 1
s_lshl_b32 s69, s69, 5
s_add_u32 s69, s69, 8192
s_and_b32 s70, s32, 1
s_lshl_b32 s70, s70, 2
s_add_u32 s70, s70, 3
s_lshl_b32 s70, s70, 5
s_lshr_b32 s71, s32, 1
s_lshl_b32 s71, s71, 13
s_add_u32 s70, s70, s71
s_cmp_eq_u32 s43, 1
s_cselect_b32 s69, s70, s69
v_xor_b32 v20, s69, v5
v_add_u32 v20, 73728, v20
v_add_u32 v24, 32768, v20
v_mov_b32 v25, 0
v_mov_b32 v26, 0
v_mov_b32 v27, 0
v_mov_b32 v28, 0
v_cmp_eq_u32 vcc, 0, v2
v_mov_b32 v4, 0x3f803f80
s_nop 0
v_cndmask_b32 v36, 0, v4, vcc
v_mov_b32 v37, v36
v_mov_b32 v38, v36
v_mov_b32 v39, v36
s_mov_b32 s59, 0xffff0000
s_mov_b32 s24, s56
s_and_b32 s25, s57, 0xffff
s_mov_b32 s26, 0x2000000
s_mov_b32 s27, 0x20000
s_mov_b32 s96, s92
s_and_b32 s97, s93, 0xffff
s_mov_b32 s98, 0x100
s_mov_b32 s99, 0x20000
s_lshl_b32 s33, s30, 11
s_lshl_b32 s34, s29, 7
s_add_u32 s94, s33, s34
s_add_u32 s94, s94, 20971520
s_lshl_b32 s33, s29, 13
s_lshl_b32 s34, s30, 9
s_add_u32 s95, s33, s34
s_add_u32 s95, s95, 21004288
s_cmp_ge_u32 s2, 8
s_cbranch_scc1 parallel_sum__mha_block__geglu_ffn__prompt_kernel_noclr
v_mov_b32 v120, 0
v_mov_b32 v121, 0
v_mov_b32 v122, 0
v_mov_b32 v123, 0
s_mul_i32 s33, s2, 40960
s_mul_i32 s34, s28, 5120
s_add_u32 s33, s33, s34
s_add_u32 s33, s33, 20971520
v_lshlrev_b32 v5, 4, v1
buffer_store_dwordx4 v[120:123], v5, s[24:27], s33 offen offset:0 sc1
buffer_store_dwordx4 v[120:123], v5, s[24:27], s33 offen offset:1024 sc1
buffer_store_dwordx4 v[120:123], v5, s[24:27], s33 offen offset:2048 sc1
buffer_store_dwordx4 v[120:123], v5, s[24:27], s33 offen offset:3072 sc1
s_add_u32 s33, s33, 4096
buffer_store_dwordx4 v[120:123], v5, s[24:27], s33 offen offset:0 sc1
parallel_sum__mha_block__geglu_ffn__prompt_kernel_noclr:
s_cmp_eq_u32 s43, 1
s_cbranch_scc1 parallel_sum__mha_block__geglu_ffn__prompt_kernel_typeB
s_cmp_eq_u32 s58, 1
s_cbranch_scc1 parallel_sum__mha_block__geglu_ffn__prompt_kernel_A1
s_waitcnt vmcnt(9)
s_waitcnt vmcnt(7)
s_waitcnt lgkmcnt(0)
s_barrier
ds_read_b128 v[80:83], v14 offset:0
ds_read_b128 v[84:87], v14 offset:2048
ds_read_b128 v[88:91], v14 offset:4096
ds_read_b128 v[92:95], v14 offset:6144
ds_read_b64_tr_b16 v[40:41], v16 offset:0
ds_read_b64_tr_b16 v[42:43], v16 offset:512
ds_read_b128 v[112:115], v31 offset:0
ds_read_b64_tr_b16 v[44:45], v17 offset:0
ds_read_b64_tr_b16 v[46:47], v17 offset:1024
ds_read_b64_tr_b16 v[48:49], v18 offset:0
ds_read_b64_tr_b16 v[50:51], v18 offset:1024
ds_read_b64_tr_b16 v[52:53], v19 offset:0
ds_read_b64_tr_b16 v[54:55], v19 offset:1024
ds_read_b64_tr_b16 v[56:57], v20 offset:0
ds_read_b64_tr_b16 v[58:59], v20 offset:1024
s_waitcnt lgkmcnt(0)
s_waitcnt vmcnt(5)
s_barrier
s_lshl_b32 s33, s28, 13
v_lshlrev_b32 v4, 7, v1
v_add_u32 v4, s33, v4
s_mov_b32 s33, parallel_sum__mha_block__geglu_ffn__prompt_kernel_end-parallel_sum__mha_block__geglu_ffn__prompt_kernel_pc-4
v_min_u32 v4, s33, v4
global_load_dword v235, v4, s[78:79]
v_mfma_f32_16x16x32_bf16 v[120:123], v[40:43], v[80:83], 0
ds_read_b128 v[96:99], v15 offset:0
v_lshlrev_b32 v29, 16, v112
v_mfma_f32_16x16x32_bf16 v[124:127], v[40:43], v[84:87], 0
ds_read_b128 v[100:103], v15 offset:2048
v_and_b32 v30, s59, v112
v_mfma_f32_16x16x32_bf16 v[128:131], v[40:43], v[88:91], 0
ds_read_b128 v[104:107], v15 offset:4096
v_add_f32 v25, v25, v29
s_add_u32 m0, s42, 49152
s_add_u32 s75, s75, s46
buffer_load_dwordx4 v13, s[16:19], s75 offen sc1 lds
v_mfma_f32_16x16x32_bf16 v[132:135], v[40:43], v[92:95], 0
ds_read_b128 v[108:111], v15 offset:6144
v_add_f32 v26, v26, v30
v_mfma_f32_16x16x32_bf16 v[200:203], v[40:43], v[36:39], 0
ds_read_b64_tr_b16 v[60:61], v16 offset:4096
v_fma_f32 v27, v29, v29, v27
v_mfma_f32_16x16x32_bf16 v[136:139], v[44:47], v[80:83], 0
ds_read_b64_tr_b16 v[62:63], v16 offset:4608
v_fma_f32 v28, v30, v30, v28
v_mfma_f32_16x16x32_bf16 v[140:143], v[44:47], v[84:87], 0
ds_read_b128 v[116:119], v32 offset:0
v_lshlrev_b32 v29, 16, v113
v_mfma_f32_16x16x32_bf16 v[144:147], v[44:47], v[88:91], 0
ds_read_b64_tr_b16 v[64:65], v17 offset:16384
v_and_b32 v30, s59, v113
s_add_u32 m0, s42, 57344
s_add_u32 s76, s76, s46
buffer_load_dwordx4 v13, s[20:23], s76 offen sc1 lds
v_mfma_f32_16x16x32_bf16 v[148:151], v[44:47], v[92:95], 0
ds_read_b64_tr_b16 v[66:67], v17 offset:17408
v_add_f32 v25, v25, v29
v_mfma_f32_16x16x32_bf16 v[204:207], v[44:47], v[36:39], 0
ds_read_b64_tr_b16 v[68:69], v18 offset:16384
v_add_f32 v26, v26, v30
v_mfma_f32_16x16x32_bf16 v[152:155], v[48:51], v[80:83], 0
ds_read_b64_tr_b16 v[70:71], v18 offset:17408
v_fma_f32 v27, v29, v29, v27
v_mfma_f32_16x16x32_bf16 v[156:159], v[48:51], v[84:87], 0
ds_read_b64_tr_b16 v[72:73], v19 offset:16384
v_fma_f32 v28, v30, v30, v28
v_mfma_f32_16x16x32_bf16 v[160:163], v[48:51], v[88:91], 0
ds_read_b64_tr_b16 v[74:75], v19 offset:17408
v_lshlrev_b32 v29, 16, v114
s_add_u32 m0, s40, 49152
s_add_u32 s82, s36, 256
buffer_load_dwordx4 v10, s[8:11], s82 offen sc1 lds
v_mfma_f32_16x16x32_bf16 v[164:167], v[48:51], v[92:95], 0
ds_read_b64_tr_b16 v[76:77], v20 offset:16384
v_and_b32 v30, s59, v114
v_mfma_f32_16x16x32_bf16 v[208:211], v[48:51], v[36:39], 0
ds_read_b64_tr_b16 v[78:79], v20 offset:17408
v_add_f32 v25, v25, v29
v_mfma_f32_16x16x32_bf16 v[168:171], v[52:55], v[80:83], 0
v_add_f32 v26, v26, v30
v_mfma_f32_16x16x32_bf16 v[172:175], v[52:55], v[84:87], 0
v_fma_f32 v27, v29, v29, v27
v_mfma_f32_16x16x32_bf16 v[176:179], v[52:55], v[88:91], 0
v_fma_f32 v28, v30, v30, v28
s_add_u32 m0, s40, 50176
s_add_u32 s33, s37, 393216
buffer_load_dwordx4 v11, s[8:11], s82 offen sc1 lds
s_add_u32 m0, s41, 49152
s_nop 0
buffer_load_dwordx4 v12, s[12:15], s33 offen sc1 lds
v_mfma_f32_16x16x32_bf16 v[180:183], v[52:55], v[92:95], 0
v_lshlrev_b32 v29, 16, v115
v_mfma_f32_16x16x32_bf16 v[212:215], v[52:55], v[36:39], 0
v_and_b32 v30, s59, v115
v_mfma_f32_16x16x32_bf16 v[184:187], v[56:59], v[80:83], 0
v_add_f32 v25, v25, v29
v_mfma_f32_16x16x32_bf16 v[188:191], v[56:59], v[84:87], 0
v_add_f32 v26, v26, v30
v_mfma_f32_16x16x32_bf16 v[192:195], v[56:59], v[88:91], 0
v_fma_f32 v27, v29, v29, v27
v_mfma_f32_16x16x32_bf16 v[196:199], v[56:59], v[92:95], 0
v_fma_f32 v28, v30, v30, v28
v_mfma_f32_16x16x32_bf16 v[216:219], v[56:59], v[36:39], 0
s_waitcnt lgkmcnt(0)
s_waitcnt vmcnt(6)
s_barrier
v_mfma_f32_16x16x32_bf16 v[120:123], v[60:63], v[96:99], v[120:123]
ds_read_b128 v[80:83], v14 offset:24576
v_lshlrev_b32 v29, 16, v116
v_and_b32 v30, s59, v116
v_mfma_f32_16x16x32_bf16 v[124:127], v[60:63], v[100:103], v[124:127]
ds_read_b128 v[84:87], v14 offset:26624
v_add_f32 v25, v25, v29
v_mfma_f32_16x16x32_bf16 v[128:131], v[60:63], v[104:107], v[128:131]
ds_read_b128 v[88:91], v14 offset:28672
v_add_f32 v26, v26, v30
s_add_u32 m0, s42, 65536
s_add_u32 s75, s75, s46
buffer_load_dwordx4 v13, s[16:19], s75 offen sc1 lds
v_mfma_f32_16x16x32_bf16 v[132:135], v[60:63], v[108:111], v[132:135]
ds_read_b128 v[92:95], v14 offset:30720
v_fma_f32 v27, v29, v29, v27
v_mfma_f32_16x16x32_bf16 v[136:139], v[64:67], v[96:99], v[136:139]
ds_read_b64_tr_b16 v[40:41], v16 offset:24576
v_fma_f32 v28, v30, v30, v28
v_mfma_f32_16x16x32_bf16 v[140:143], v[64:67], v[100:103], v[140:143]
ds_read_b64_tr_b16 v[42:43], v16 offset:25088
v_lshlrev_b32 v29, 16, v117
v_and_b32 v30, s59, v117
v_mfma_f32_16x16x32_bf16 v[144:147], v[64:67], v[104:107], v[144:147]
ds_read_b128 v[112:115], v31 offset:24576
v_add_f32 v25, v25, v29
s_add_u32 m0, s42, 73728
s_add_u32 s76, s76, s46
buffer_load_dwordx4 v13, s[20:23], s76 offen sc1 lds
v_mfma_f32_16x16x32_bf16 v[148:151], v[64:67], v[108:111], v[148:151]
ds_read_b64_tr_b16 v[44:45], v21 offset:0
v_add_f32 v26, v26, v30
v_mfma_f32_16x16x32_bf16 v[152:155], v[68:71], v[96:99], v[152:155]
ds_read_b64_tr_b16 v[46:47], v21 offset:1024
v_fma_f32 v27, v29, v29, v27
v_mfma_f32_16x16x32_bf16 v[156:159], v[68:71], v[100:103], v[156:159]
ds_read_b64_tr_b16 v[48:49], v22 offset:0
v_fma_f32 v28, v30, v30, v28
v_mfma_f32_16x16x32_bf16 v[160:163], v[68:71], v[104:107], v[160:163]
ds_read_b64_tr_b16 v[50:51], v22 offset:1024
v_lshlrev_b32 v29, 16, v118
v_and_b32 v30, s59, v118
s_add_u32 m0, s42, 0
s_add_u32 s75, s75, s46
buffer_load_dwordx4 v13, s[16:19], s75 offen sc1 lds
v_mfma_f32_16x16x32_bf16 v[164:167], v[68:71], v[108:111], v[164:167]
ds_read_b64_tr_b16 v[52:53], v23 offset:0
v_add_f32 v25, v25, v29
v_mfma_f32_16x16x32_bf16 v[168:171], v[72:75], v[96:99], v[168:171]
ds_read_b64_tr_b16 v[54:55], v23 offset:1024
v_add_f32 v26, v26, v30
v_mfma_f32_16x16x32_bf16 v[172:175], v[72:75], v[100:103], v[172:175]
ds_read_b64_tr_b16 v[56:57], v24 offset:0
v_fma_f32 v27, v29, v29, v27
v_mfma_f32_16x16x32_bf16 v[176:179], v[72:75], v[104:107], v[176:179]
ds_read_b64_tr_b16 v[58:59], v24 offset:1024
v_fma_f32 v28, v30, v30, v28
s_add_u32 m0, s42, 8192
s_add_u32 s76, s76, s46
buffer_load_dwordx4 v13, s[20:23], s76 offen sc1 lds
v_mfma_f32_16x16x32_bf16 v[180:183], v[72:75], v[108:111], v[180:183]
v_lshlrev_b32 v29, 16, v119
v_and_b32 v30, s59, v119
v_mfma_f32_16x16x32_bf16 v[184:187], v[76:79], v[96:99], v[184:187]
v_add_f32 v25, v25, v29
v_mfma_f32_16x16x32_bf16 v[188:191], v[76:79], v[100:103], v[188:191]
v_add_f32 v26, v26, v30
v_mfma_f32_16x16x32_bf16 v[192:195], v[76:79], v[104:107], v[192:195]
v_fma_f32 v27, v29, v29, v27
v_mfma_f32_16x16x32_bf16 v[196:199], v[76:79], v[108:111], v[196:199]
v_fma_f32 v28, v30, v30, v28
s_waitcnt lgkmcnt(0)
s_waitcnt vmcnt(7)
s_barrier
v_mfma_f32_16x16x32_bf16 v[120:123], v[40:43], v[80:83], v[120:123]
ds_read_b128 v[96:99], v15 offset:24576
v_lshlrev_b32 v29, 16, v112
v_mfma_f32_16x16x32_bf16 v[124:127], v[40:43], v[84:87], v[124:127]
ds_read_b128 v[100:103], v15 offset:26624
v_and_b32 v30, s59, v112
v_mfma_f32_16x16x32_bf16 v[128:131], v[40:43], v[88:91], v[128:131]
ds_read_b128 v[104:107], v15 offset:28672
v_add_f32 v25, v25, v29
s_add_u32 m0, s42, 16384
s_add_u32 s75, s75, s46
buffer_load_dwordx4 v13, s[16:19], s75 offen sc1 lds
v_mfma_f32_16x16x32_bf16 v[132:135], v[40:43], v[92:95], v[132:135]
ds_read_b128 v[108:111], v15 offset:30720
v_add_f32 v26, v26, v30
v_mfma_f32_16x16x32_bf16 v[200:203], v[40:43], v[36:39], v[200:203]
ds_read_b64_tr_b16 v[60:61], v16 offset:28672
v_fma_f32 v27, v29, v29, v27
v_mfma_f32_16x16x32_bf16 v[136:139], v[44:47], v[80:83], v[136:139]
ds_read_b64_tr_b16 v[62:63], v16 offset:29184
v_fma_f32 v28, v30, v30, v28
v_mfma_f32_16x16x32_bf16 v[140:143], v[44:47], v[84:87], v[140:143]
ds_read_b128 v[116:119], v32 offset:24576
v_lshlrev_b32 v29, 16, v113
v_mfma_f32_16x16x32_bf16 v[144:147], v[44:47], v[88:91], v[144:147]
ds_read_b64_tr_b16 v[64:65], v21 offset:16384
v_and_b32 v30, s59, v113
s_add_u32 m0, s42, 24576
s_add_u32 s76, s76, s46
buffer_load_dwordx4 v13, s[20:23], s76 offen sc1 lds
v_mfma_f32_16x16x32_bf16 v[148:151], v[44:47], v[92:95], v[148:151]
ds_read_b64_tr_b16 v[66:67], v21 offset:17408
v_add_f32 v25, v25, v29
v_mfma_f32_16x16x32_bf16 v[204:207], v[44:47], v[36:39], v[204:207]
ds_read_b64_tr_b16 v[68:69], v22 offset:16384
v_add_f32 v26, v26, v30
v_mfma_f32_16x16x32_bf16 v[152:155], v[48:51], v[80:83], v[152:155]
ds_read_b64_tr_b16 v[70:71], v22 offset:17408
v_fma_f32 v27, v29, v29, v27
v_mfma_f32_16x16x32_bf16 v[156:159], v[48:51], v[84:87], v[156:159]
ds_read_b64_tr_b16 v[72:73], v23 offset:16384
v_fma_f32 v28, v30, v30, v28
v_mfma_f32_16x16x32_bf16 v[160:163], v[48:51], v[88:91], v[160:163]
ds_read_b64_tr_b16 v[74:75], v23 offset:17408
v_lshlrev_b32 v29, 16, v114
s_add_u32 m0, s40, 0
s_add_u32 s82, s36, 384
buffer_load_dwordx4 v10, s[8:11], s82 offen sc1 lds
v_mfma_f32_16x16x32_bf16 v[164:167], v[48:51], v[92:95], v[164:167]
ds_read_b64_tr_b16 v[76:77], v24 offset:16384
v_and_b32 v30, s59, v114
v_mfma_f32_16x16x32_bf16 v[208:211], v[48:51], v[36:39], v[208:211]
ds_read_b64_tr_b16 v[78:79], v24 offset:17408
v_add_f32 v25, v25, v29
v_mfma_f32_16x16x32_bf16 v[168:171], v[52:55], v[80:83], v[168:171]
v_add_f32 v26, v26, v30
v_mfma_f32_16x16x32_bf16 v[172:175], v[52:55], v[84:87], v[172:175]
v_fma_f32 v27, v29, v29, v27
v_mfma_f32_16x16x32_bf16 v[176:179], v[52:55], v[88:91], v[176:179]
v_fma_f32 v28, v30, v30, v28
s_add_u32 m0, s40, 1024
s_add_u32 s33, s37, 589824
buffer_load_dwordx4 v11, s[8:11], s82 offen sc1 lds
s_add_u32 m0, s41, 0
s_nop 0
buffer_load_dwordx4 v12, s[12:15], s33 offen sc1 lds
v_mfma_f32_16x16x32_bf16 v[180:183], v[52:55], v[92:95], v[180:183]
v_lshlrev_b32 v29, 16, v115
v_mfma_f32_16x16x32_bf16 v[212:215], v[52:55], v[36:39], v[212:215]
v_and_b32 v30, s59, v115
v_mfma_f32_16x16x32_bf16 v[184:187], v[56:59], v[80:83], v[184:187]
v_add_f32 v25, v25, v29
v_mfma_f32_16x16x32_bf16 v[188:191], v[56:59], v[84:87], v[188:191]
v_add_f32 v26, v26, v30
v_mfma_f32_16x16x32_bf16 v[192:195], v[56:59], v[88:91], v[192:195]
v_fma_f32 v27, v29, v29, v27
v_mfma_f32_16x16x32_bf16 v[196:199], v[56:59], v[92:95], v[196:199]
v_fma_f32 v28, v30, v30, v28
v_mfma_f32_16x16x32_bf16 v[216:219], v[56:59], v[36:39], v[216:219]
s_waitcnt lgkmcnt(0)
s_waitcnt vmcnt(7)
s_barrier
v_mfma_f32_16x16x32_bf16 v[120:123], v[60:63], v[96:99], v[120:123]
ds_read_b128 v[80:83], v14 offset:49152
v_lshlrev_b32 v29, 16, v116
v_and_b32 v30, s59, v116
v_mfma_f32_16x16x32_bf16 v[124:127], v[60:63], v[100:103], v[124:127]
ds_read_b128 v[84:87], v14 offset:51200
v_add_f32 v25, v25, v29
v_mfma_f32_16x16x32_bf16 v[128:131], v[60:63], v[104:107], v[128:131]
ds_read_b128 v[88:91], v14 offset:53248
v_add_f32 v26, v26, v30
s_add_u32 m0, s42, 32768
s_add_u32 s75, s75, s46
buffer_load_dwordx4 v13, s[16:19], s75 offen sc1 lds
v_mfma_f32_16x16x32_bf16 v[132:135], v[60:63], v[108:111], v[132:135]
ds_read_b128 v[92:95], v14 offset:55296
v_fma_f32 v27, v29, v29, v27
v_mfma_f32_16x16x32_bf16 v[136:139], v[64:67], v[96:99], v[136:139]
ds_read_b64_tr_b16 v[40:41], v16 offset:49152
v_fma_f32 v28, v30, v30, v28
v_mfma_f32_16x16x32_bf16 v[140:143], v[64:67], v[100:103], v[140:143]
ds_read_b64_tr_b16 v[42:43], v16 offset:49664
v_lshlrev_b32 v29, 16, v117
v_and_b32 v30, s59, v117
v_mfma_f32_16x16x32_bf16 v[144:147], v[64:67], v[104:107], v[144:147]
ds_read_b128 v[112:115], v31 offset:49152
v_add_f32 v25, v25, v29
s_add_u32 m0, s42, 40960
s_add_u32 s76, s76, s46
buffer_load_dwordx4 v13, s[20:23], s76 offen sc1 lds
v_mfma_f32_16x16x32_bf16 v[148:151], v[64:67], v[108:111], v[148:151]
ds_read_b64_tr_b16 v[44:45], v21 offset:32768
v_add_f32 v26, v26, v30
v_mfma_f32_16x16x32_bf16 v[152:155], v[68:71], v[96:99], v[152:155]
ds_read_b64_tr_b16 v[46:47], v21 offset:33792
v_fma_f32 v27, v29, v29, v27
v_mfma_f32_16x16x32_bf16 v[156:159], v[68:71], v[100:103], v[156:159]
ds_read_b64_tr_b16 v[48:49], v22 offset:32768
v_fma_f32 v28, v30, v30, v28
v_mfma_f32_16x16x32_bf16 v[160:163], v[68:71], v[104:107], v[160:163]
ds_read_b64_tr_b16 v[50:51], v22 offset:33792
v_lshlrev_b32 v29, 16, v118
v_and_b32 v30, s59, v118
s_add_u32 m0, s42, 49152
s_add_u32 s75, s75, s46
buffer_load_dwordx4 v13, s[16:19], s75 offen sc1 lds
v_mfma_f32_16x16x32_bf16 v[164:167], v[68:71], v[108:111], v[164:167]
ds_read_b64_tr_b16 v[52:53], v23 offset:32768
v_add_f32 v25, v25, v29
v_mfma_f32_16x16x32_bf16 v[168:171], v[72:75], v[96:99], v[168:171]
ds_read_b64_tr_b16 v[54:55], v23 offset:33792
v_add_f32 v26, v26, v30
v_mfma_f32_16x16x32_bf16 v[172:175], v[72:75], v[100:103], v[172:175]
ds_read_b64_tr_b16 v[56:57], v24 offset:32768
v_fma_f32 v27, v29, v29, v27
v_mfma_f32_16x16x32_bf16 v[176:179], v[72:75], v[104:107], v[176:179]
ds_read_b64_tr_b16 v[58:59], v24 offset:33792
v_fma_f32 v28, v30, v30, v28
s_add_u32 m0, s42, 57344
s_add_u32 s76, s76, s46
buffer_load_dwordx4 v13, s[20:23], s76 offen sc1 lds
v_mfma_f32_16x16x32_bf16 v[180:183], v[72:75], v[108:111], v[180:183]
v_lshlrev_b32 v29, 16, v119
v_and_b32 v30, s59, v119
v_mfma_f32_16x16x32_bf16 v[184:187], v[76:79], v[96:99], v[184:187]
v_add_f32 v25, v25, v29
v_mfma_f32_16x16x32_bf16 v[188:191], v[76:79], v[100:103], v[188:191]
v_add_f32 v26, v26, v30
v_mfma_f32_16x16x32_bf16 v[192:195], v[76:79], v[104:107], v[192:195]
v_fma_f32 v27, v29, v29, v27
v_mfma_f32_16x16x32_bf16 v[196:199], v[76:79], v[108:111], v[196:199]
v_fma_f32 v28, v30, v30, v28
s_waitcnt lgkmcnt(0)
s_waitcnt vmcnt(9)
s_barrier
s_cmp_ge_u32 s2, 8
s_cbranch_scc1 parallel_sum__mha_block__geglu_ffn__prompt_kernel_A0_sig
s_cmp_lg_u32 s28, 7
s_cbranch_scc1 parallel_sum__mha_block__geglu_ffn__prompt_kernel_A0_sig
v_mov_b32 v4, s2
v_mov_b32 v5, 1
s_mov_b64 exec, 1
buffer_store_byte v5, v4, s[96:99], 0 offen sc1
s_mov_b64 exec, -1
parallel_sum__mha_block__geglu_ffn__prompt_kernel_A0_sig:
v_mfma_f32_16x16x32_bf16 v[120:123], v[40:43], v[80:83], v[120:123]
ds_read_b128 v[96:99], v15 offset:49152
v_lshlrev_b32 v29, 16, v112
v_mfma_f32_16x16x32_bf16 v[124:127], v[40:43], v[84:87], v[124:127]
ds_read_b128 v[100:103], v15 offset:51200
v_and_b32 v30, s59, v112
v_mfma_f32_16x16x32_bf16 v[128:131], v[40:43], v[88:91], v[128:131]
ds_read_b128 v[104:107], v15 offset:53248
v_add_f32 v25, v25, v29
s_add_u32 m0, s42, 65536
s_add_u32 s75, s75, s46
buffer_load_dwordx4 v13, s[16:19], s75 offen sc1 lds
v_mfma_f32_16x16x32_bf16 v[132:135], v[40:43], v[92:95], v[132:135]
ds_read_b128 v[108:111], v15 offset:55296
v_add_f32 v26, v26, v30
v_mfma_f32_16x16x32_bf16 v[200:203], v[40:43], v[36:39], v[200:203]
ds_read_b64_tr_b16 v[60:61], v16 offset:53248
v_fma_f32 v27, v29, v29, v27
v_mfma_f32_16x16x32_bf16 v[136:139], v[44:47], v[80:83], v[136:139]
ds_read_b64_tr_b16 v[62:63], v16 offset:53760
v_fma_f32 v28, v30, v30, v28
v_mfma_f32_16x16x32_bf16 v[140:143], v[44:47], v[84:87], v[140:143]
ds_read_b128 v[116:119], v32 offset:49152
v_lshlrev_b32 v29, 16, v113
v_mfma_f32_16x16x32_bf16 v[144:147], v[44:47], v[88:91], v[144:147]
ds_read_b64_tr_b16 v[64:65], v17 offset:0
v_and_b32 v30, s59, v113
s_add_u32 m0, s42, 73728
s_add_u32 s76, s76, s46
buffer_load_dwordx4 v13, s[20:23], s76 offen sc1 lds
v_mfma_f32_16x16x32_bf16 v[148:151], v[44:47], v[92:95], v[148:151]
ds_read_b64_tr_b16 v[66:67], v17 offset:1024
v_add_f32 v25, v25, v29
v_mfma_f32_16x16x32_bf16 v[204:207], v[44:47], v[36:39], v[204:207]
ds_read_b64_tr_b16 v[68:69], v18 offset:0
v_add_f32 v26, v26, v30
v_mfma_f32_16x16x32_bf16 v[152:155], v[48:51], v[80:83], v[152:155]
ds_read_b64_tr_b16 v[70:71], v18 offset:1024
v_fma_f32 v27, v29, v29, v27
v_mfma_f32_16x16x32_bf16 v[156:159], v[48:51], v[84:87], v[156:159]
ds_read_b64_tr_b16 v[72:73], v19 offset:0
v_fma_f32 v28, v30, v30, v28
v_mfma_f32_16x16x32_bf16 v[160:163], v[48:51], v[88:91], v[160:163]
ds_read_b64_tr_b16 v[74:75], v19 offset:1024
v_lshlrev_b32 v29, 16, v114
s_add_u32 m0, s40, 24576
s_add_u32 s82, s36, 512
buffer_load_dwordx4 v10, s[8:11], s82 offen sc1 lds
v_mfma_f32_16x16x32_bf16 v[164:167], v[48:51], v[92:95], v[164:167]
ds_read_b64_tr_b16 v[76:77], v20 offset:0
v_and_b32 v30, s59, v114
v_mfma_f32_16x16x32_bf16 v[208:211], v[48:51], v[36:39], v[208:211]
ds_read_b64_tr_b16 v[78:79], v20 offset:1024
v_add_f32 v25, v25, v29
v_mfma_f32_16x16x32_bf16 v[168:171], v[52:55], v[80:83], v[168:171]
v_add_f32 v26, v26, v30
v_mfma_f32_16x16x32_bf16 v[172:175], v[52:55], v[84:87], v[172:175]
v_fma_f32 v27, v29, v29, v27
v_mfma_f32_16x16x32_bf16 v[176:179], v[52:55], v[88:91], v[176:179]
v_fma_f32 v28, v30, v30, v28
s_add_u32 m0, s40, 25600
s_add_u32 s33, s37, 786432
buffer_load_dwordx4 v11, s[8:11], s82 offen sc1 lds
s_add_u32 m0, s41, 24576
s_nop 0
buffer_load_dwordx4 v12, s[12:15], s33 offen sc1 lds
v_mfma_f32_16x16x32_bf16 v[180:183], v[52:55], v[92:95], v[180:183]
v_lshlrev_b32 v29, 16, v115
v_mfma_f32_16x16x32_bf16 v[212:215], v[52:55], v[36:39], v[212:215]
v_and_b32 v30, s59, v115
v_mfma_f32_16x16x32_bf16 v[184:187], v[56:59], v[80:83], v[184:187]
v_add_f32 v25, v25, v29
v_mfma_f32_16x16x32_bf16 v[188:191], v[56:59], v[84:87], v[188:191]
v_add_f32 v26, v26, v30
v_mfma_f32_16x16x32_bf16 v[192:195], v[56:59], v[88:91], v[192:195]
v_fma_f32 v27, v29, v29, v27
v_mfma_f32_16x16x32_bf16 v[196:199], v[56:59], v[92:95], v[196:199]
v_fma_f32 v28, v30, v30, v28
v_mfma_f32_16x16x32_bf16 v[216:219], v[56:59], v[36:39], v[216:219]
s_waitcnt lgkmcnt(0)
s_waitcnt vmcnt(12)
s_waitcnt vmcnt(9)
s_barrier
v_mfma_f32_16x16x32_bf16 v[120:123], v[60:63], v[96:99], v[120:123]
ds_read_b128 v[80:83], v14 offset:0
v_lshlrev_b32 v29, 16, v116
v_and_b32 v30, s59, v116
v_mfma_f32_16x16x32_bf16 v[124:127], v[60:63], v[100:103], v[124:127]
ds_read_b128 v[84:87], v14 offset:2048
v_add_f32 v25, v25, v29
v_mfma_f32_16x16x32_bf16 v[128:131], v[60:63], v[104:107], v[128:131]
ds_read_b128 v[88:91], v14 offset:4096
v_add_f32 v26, v26, v30
s_add_u32 m0, s42, 0
s_add_u32 s75, s75, s46
buffer_load_dwordx4 v13, s[16:19], s75 offen sc1 lds
v_mfma_f32_16x16x32_bf16 v[132:135], v[60:63], v[108:111], v[132:135]
ds_read_b128 v[92:95], v14 offset:6144
v_fma_f32 v27, v29, v29, v27
v_mfma_f32_16x16x32_bf16 v[136:139], v[64:67], v[96:99], v[136:139]
ds_read_b64_tr_b16 v[40:41], v16 offset:0
v_fma_f32 v28, v30, v30, v28
v_mfma_f32_16x16x32_bf16 v[140:143], v[64:67], v[100:103], v[140:143]
ds_read_b64_tr_b16 v[42:43], v16 offset:512
v_lshlrev_b32 v29, 16, v117
v_and_b32 v30, s59, v117
v_mfma_f32_16x16x32_bf16 v[144:147], v[64:67], v[104:107], v[144:147]
ds_read_b128 v[112:115], v31 offset:0
v_add_f32 v25, v25, v29
v_mfma_f32_16x16x32_bf16 v[148:151], v[64:67], v[108:111], v[148:151]
ds_read_b64_tr_b16 v[44:45], v17 offset:16384
v_add_f32 v26, v26, v30
v_mfma_f32_16x16x32_bf16 v[152:155], v[68:71], v[96:99], v[152:155]
ds_read_b64_tr_b16 v[46:47], v17 offset:17408
v_fma_f32 v27, v29, v29, v27
v_mfma_f32_16x16x32_bf16 v[156:159], v[68:71], v[100:103], v[156:159]
ds_read_b64_tr_b16 v[48:49], v18 offset:16384
v_fma_f32 v28, v30, v30, v28
v_mfma_f32_16x16x32_bf16 v[160:163], v[68:71], v[104:107], v[160:163]
ds_read_b64_tr_b16 v[50:51], v18 offset:17408
v_lshlrev_b32 v29, 16, v118
v_and_b32 v30, s59, v118
v_mfma_f32_16x16x32_bf16 v[164:167], v[68:71], v[108:111], v[164:167]
ds_read_b64_tr_b16 v[52:53], v19 offset:16384
v_add_f32 v25, v25, v29
s_add_u32 m0, s42, 8192
s_add_u32 s76, s76, s46
buffer_load_dwordx4 v13, s[20:23], s76 offen sc1 lds
v_mfma_f32_16x16x32_bf16 v[168:171], v[72:75], v[96:99], v[168:171]
ds_read_b64_tr_b16 v[54:55], v19 offset:17408
v_add_f32 v26, v26, v30
v_mfma_f32_16x16x32_bf16 v[172:175], v[72:75], v[100:103], v[172:175]
ds_read_b64_tr_b16 v[56:57], v20 offset:16384
v_fma_f32 v27, v29, v29, v27
v_mfma_f32_16x16x32_bf16 v[176:179], v[72:75], v[104:107], v[176:179]
ds_read_b64_tr_b16 v[58:59], v20 offset:17408
v_fma_f32 v28, v30, v30, v28
v_mfma_f32_16x16x32_bf16 v[180:183], v[72:75], v[108:111], v[180:183]
v_lshlrev_b32 v29, 16, v119
v_and_b32 v30, s59, v119
v_mfma_f32_16x16x32_bf16 v[184:187], v[76:79], v[96:99], v[184:187]
v_add_f32 v25, v25, v29
v_mfma_f32_16x16x32_bf16 v[188:191], v[76:79], v[100:103], v[188:191]
v_add_f32 v26, v26, v30
v_mfma_f32_16x16x32_bf16 v[192:195], v[76:79], v[104:107], v[192:195]
v_fma_f32 v27, v29, v29, v27
v_mfma_f32_16x16x32_bf16 v[196:199], v[76:79], v[108:111], v[196:199]
v_fma_f32 v28, v30, v30, v28
s_waitcnt lgkmcnt(0)
s_waitcnt vmcnt(9)
s_barrier
v_mfma_f32_16x16x32_bf16 v[120:123], v[40:43], v[80:83], v[120:123]
ds_read_b128 v[96:99], v15 offset:0
v_lshlrev_b32 v29, 16, v112
v_mfma_f32_16x16x32_bf16 v[124:127], v[40:43], v[84:87], v[124:127]
ds_read_b128 v[100:103], v15 offset:2048
v_and_b32 v30, s59, v112
v_mfma_f32_16x16x32_bf16 v[128:131], v[40:43], v[88:91], v[128:131]
ds_read_b128 v[104:107], v15 offset:4096
v_add_f32 v25, v25, v29
s_add_u32 m0, s42, 16384
s_add_u32 s75, s75, s46
buffer_load_dwordx4 v13, s[16:19], s75 offen sc1 lds
v_mfma_f32_16x16x32_bf16 v[132:135], v[40:43], v[92:95], v[132:135]
ds_read_b128 v[108:111], v15 offset:6144
v_add_f32 v26, v26, v30
v_mfma_f32_16x16x32_bf16 v[200:203], v[40:43], v[36:39], v[200:203]
ds_read_b64_tr_b16 v[60:61], v16 offset:4096
v_fma_f32 v27, v29, v29, v27
v_mfma_f32_16x16x32_bf16 v[136:139], v[44:47], v[80:83], v[136:139]
ds_read_b64_tr_b16 v[62:63], v16 offset:4608
v_fma_f32 v28, v30, v30, v28
v_mfma_f32_16x16x32_bf16 v[140:143], v[44:47], v[84:87], v[140:143]
ds_read_b128 v[116:119], v32 offset:0
v_lshlrev_b32 v29, 16, v113
v_mfma_f32_16x16x32_bf16 v[144:147], v[44:47], v[88:91], v[144:147]
ds_read_b64_tr_b16 v[64:65], v21 offset:0
v_and_b32 v30, s59, v113
s_add_u32 m0, s42, 24576
s_add_u32 s76, s76, s46
buffer_load_dwordx4 v13, s[20:23], s76 offen sc1 lds
v_mfma_f32_16x16x32_bf16 v[148:151], v[44:47], v[92:95], v[148:151]
ds_read_b64_tr_b16 v[66:67], v21 offset:1024
v_add_f32 v25, v25, v29
v_mfma_f32_16x16x32_bf16 v[204:207], v[44:47], v[36:39], v[204:207]
ds_read_b64_tr_b16 v[68:69], v22 offset:0
v_add_f32 v26, v26, v30
v_mfma_f32_16x16x32_bf16 v[152:155], v[48:51], v[80:83], v[152:155]
ds_read_b64_tr_b16 v[70:71], v22 offset:1024
v_fma_f32 v27, v29, v29, v27
v_mfma_f32_16x16x32_bf16 v[156:159], v[48:51], v[84:87], v[156:159]
ds_read_b64_tr_b16 v[72:73], v23 offset:0
v_fma_f32 v28, v30, v30, v28
v_mfma_f32_16x16x32_bf16 v[160:163], v[48:51], v[88:91], v[160:163]
ds_read_b64_tr_b16 v[74:75], v23 offset:1024
v_lshlrev_b32 v29, 16, v114
s_add_u32 m0, s40, 49152
s_add_u32 s82, s36, 640
buffer_load_dwordx4 v10, s[8:11], s82 offen sc1 lds
v_mfma_f32_16x16x32_bf16 v[164:167], v[48:51], v[92:95], v[164:167]
ds_read_b64_tr_b16 v[76:77], v24 offset:0
v_and_b32 v30, s59, v114
v_mfma_f32_16x16x32_bf16 v[208:211], v[48:51], v[36:39], v[208:211]
ds_read_b64_tr_b16 v[78:79], v24 offset:1024
v_add_f32 v25, v25, v29
v_mfma_f32_16x16x32_bf16 v[168:171], v[52:55], v[80:83], v[168:171]
v_add_f32 v26, v26, v30
v_mfma_f32_16x16x32_bf16 v[172:175], v[52:55], v[84:87], v[172:175]
v_fma_f32 v27, v29, v29, v27
v_mfma_f32_16x16x32_bf16 v[176:179], v[52:55], v[88:91], v[176:179]
v_fma_f32 v28, v30, v30, v28
s_add_u32 m0, s40, 50176
s_add_u32 s33, s37, 983040
buffer_load_dwordx4 v11, s[8:11], s82 offen sc1 lds
s_add_u32 m0, s41, 49152
s_nop 0
buffer_load_dwordx4 v12, s[12:15], s33 offen sc1 lds
v_mfma_f32_16x16x32_bf16 v[180:183], v[52:55], v[92:95], v[180:183]
v_lshlrev_b32 v29, 16, v115
v_mfma_f32_16x16x32_bf16 v[212:215], v[52:55], v[36:39], v[212:215]
v_and_b32 v30, s59, v115
v_mfma_f32_16x16x32_bf16 v[184:187], v[56:59], v[80:83], v[184:187]
v_add_f32 v25, v25, v29
v_mfma_f32_16x16x32_bf16 v[188:191], v[56:59], v[84:87], v[188:191]
v_add_f32 v26, v26, v30
v_mfma_f32_16x16x32_bf16 v[192:195], v[56:59], v[88:91], v[192:195]
v_fma_f32 v27, v29, v29, v27
v_mfma_f32_16x16x32_bf16 v[196:199], v[56:59], v[92:95], v[196:199]
v_fma_f32 v28, v30, v30, v28
v_mfma_f32_16x16x32_bf16 v[216:219], v[56:59], v[36:39], v[216:219]
s_waitcnt lgkmcnt(0)
s_waitcnt vmcnt(12)
s_waitcnt vmcnt(7)
s_barrier
v_mfma_f32_16x16x32_bf16 v[120:123], v[60:63], v[96:99], v[120:123]
ds_read_b128 v[80:83], v14 offset:24576
v_lshlrev_b32 v29, 16, v116
v_and_b32 v30, s59, v116
v_mfma_f32_16x16x32_bf16 v[124:127], v[60:63], v[100:103], v[124:127]
ds_read_b128 v[84:87], v14 offset:26624
v_add_f32 v25, v25, v29
v_mfma_f32_16x16x32_bf16 v[128:131], v[60:63], v[104:107], v[128:131]
ds_read_b128 v[88:91], v14 offset:28672
v_add_f32 v26, v26, v30
s_add_u32 m0, s42, 32768
s_add_u32 s75, s75, s46
buffer_load_dwordx4 v13, s[16:19], s75 offen sc1 lds
v_mfma_f32_16x16x32_bf16 v[132:135], v[60:63], v[108:111], v[132:135]
ds_read_b128 v[92:95], v14 offset:30720
v_fma_f32 v27, v29, v29, v27
v_mfma_f32_16x16x32_bf16 v[136:139], v[64:67], v[96:99], v[136:139]
ds_read_b64_tr_b16 v[40:41], v16 offset:24576
v_fma_f32 v28, v30, v30, v28
v_mfma_f32_16x16x32_bf16 v[140:143], v[64:67], v[100:103], v[140:143]
ds_read_b64_tr_b16 v[42:43], v16 offset:25088
v_lshlrev_b32 v29, 16, v117
v_and_b32 v30, s59, v117
v_mfma_f32_16x16x32_bf16 v[144:147], v[64:67], v[104:107], v[144:147]
ds_read_b128 v[112:115], v31 offset:24576
v_add_f32 v25, v25, v29
v_mfma_f32_16x16x32_bf16 v[148:151], v[64:67], v[108:111], v[148:151]
ds_read_b64_tr_b16 v[44:45], v21 offset:16384
v_add_f32 v26, v26, v30
v_mfma_f32_16x16x32_bf16 v[152:155], v[68:71], v[96:99], v[152:155]
ds_read_b64_tr_b16 v[46:47], v21 offset:17408
v_fma_f32 v27, v29, v29, v27
v_mfma_f32_16x16x32_bf16 v[156:159], v[68:71], v[100:103], v[156:159]
ds_read_b64_tr_b16 v[48:49], v22 offset:16384
v_fma_f32 v28, v30, v30, v28
v_mfma_f32_16x16x32_bf16 v[160:163], v[68:71], v[104:107], v[160:163]
ds_read_b64_tr_b16 v[50:51], v22 offset:17408
v_lshlrev_b32 v29, 16, v118
v_and_b32 v30, s59, v118
v_mfma_f32_16x16x32_bf16 v[164:167], v[68:71], v[108:111], v[164:167]
ds_read_b64_tr_b16 v[52:53], v23 offset:16384
v_add_f32 v25, v25, v29
s_add_u32 m0, s42, 40960
s_add_u32 s76, s76, s46
buffer_load_dwordx4 v13, s[20:23], s76 offen sc1 lds
v_mfma_f32_16x16x32_bf16 v[168:171], v[72:75], v[96:99], v[168:171]
ds_read_b64_tr_b16 v[54:55], v23 offset:17408
v_add_f32 v26, v26, v30
v_mfma_f32_16x16x32_bf16 v[172:175], v[72:75], v[100:103], v[172:175]
ds_read_b64_tr_b16 v[56:57], v24 offset:16384
v_fma_f32 v27, v29, v29, v27
v_mfma_f32_16x16x32_bf16 v[176:179], v[72:75], v[104:107], v[176:179]
ds_read_b64_tr_b16 v[58:59], v24 offset:17408
v_fma_f32 v28, v30, v30, v28
v_mfma_f32_16x16x32_bf16 v[180:183], v[72:75], v[108:111], v[180:183]
v_lshlrev_b32 v29, 16, v119
v_and_b32 v30, s59, v119
v_mfma_f32_16x16x32_bf16 v[184:187], v[76:79], v[96:99], v[184:187]
v_add_f32 v25, v25, v29
v_mfma_f32_16x16x32_bf16 v[188:191], v[76:79], v[100:103], v[188:191]
v_add_f32 v26, v26, v30
v_mfma_f32_16x16x32_bf16 v[192:195], v[76:79], v[104:107], v[192:195]
v_fma_f32 v27, v29, v29, v27
v_mfma_f32_16x16x32_bf16 v[196:199], v[76:79], v[108:111], v[196:199]
v_fma_f32 v28, v30, v30, v28
s_waitcnt lgkmcnt(0)
s_barrier
v_mfma_f32_16x16x32_bf16 v[120:123], v[40:43], v[80:83], v[120:123]
ds_read_b128 v[96:99], v15 offset:24576
v_lshlrev_b32 v29, 16, v112
v_mfma_f32_16x16x32_bf16 v[124:127], v[40:43], v[84:87], v[124:127]
ds_read_b128 v[100:103], v15 offset:26624
v_and_b32 v30, s59, v112
v_mfma_f32_16x16x32_bf16 v[128:131], v[40:43], v[88:91], v[128:131]
ds_read_b128 v[104:107], v15 offset:28672
v_add_f32 v25, v25, v29
s_add_u32 m0, s42, 49152
s_add_u32 s75, s75, s46
buffer_load_dwordx4 v13, s[16:19], s75 offen sc1 lds
v_mfma_f32_16x16x32_bf16 v[132:135], v[40:43], v[92:95], v[132:135]
ds_read_b128 v[108:111], v15 offset:30720
v_add_f32 v26, v26, v30
v_mfma_f32_16x16x32_bf16 v[200:203], v[40:43], v[36:39], v[200:203]
ds_read_b64_tr_b16 v[60:61], v16 offset:28672
v_fma_f32 v27, v29, v29, v27
v_mfma_f32_16x16x32_bf16 v[136:139], v[44:47], v[80:83], v[136:139]
ds_read_b64_tr_b16 v[62:63], v16 offset:29184
v_fma_f32 v28, v30, v30, v28
v_mfma_f32_16x16x32_bf16 v[140:143], v[44:47], v[84:87], v[140:143]
ds_read_b128 v[116:119], v32 offset:24576
v_lshlrev_b32 v29, 16, v113
v_mfma_f32_16x16x32_bf16 v[144:147], v[44:47], v[88:91], v[144:147]
ds_read_b64_tr_b16 v[64:65], v21 offset:32768
v_and_b32 v30, s59, v113
s_add_u32 m0, s42, 57344
s_add_u32 s76, s76, s46
buffer_load_dwordx4 v13, s[20:23], s76 offen sc1 lds
v_mfma_f32_16x16x32_bf16 v[148:151], v[44:47], v[92:95], v[148:151]
ds_read_b64_tr_b16 v[66:67], v21 offset:33792
v_add_f32 v25, v25, v29
v_mfma_f32_16x16x32_bf16 v[204:207], v[44:47], v[36:39], v[204:207]
ds_read_b64_tr_b16 v[68:69], v22 offset:32768
v_add_f32 v26, v26, v30
v_mfma_f32_16x16x32_bf16 v[152:155], v[48:51], v[80:83], v[152:155]
ds_read_b64_tr_b16 v[70:71], v22 offset:33792
v_fma_f32 v27, v29, v29, v27
v_mfma_f32_16x16x32_bf16 v[156:159], v[48:51], v[84:87], v[156:159]
ds_read_b64_tr_b16 v[72:73], v23 offset:32768
v_fma_f32 v28, v30, v30, v28
v_mfma_f32_16x16x32_bf16 v[160:163], v[48:51], v[88:91], v[160:163]
ds_read_b64_tr_b16 v[74:75], v23 offset:33792
v_lshlrev_b32 v29, 16, v114
s_add_u32 m0, s40, 0
s_add_u32 s82, s36, 768
buffer_load_dwordx4 v10, s[8:11], s82 offen sc1 lds
v_mfma_f32_16x16x32_bf16 v[164:167], v[48:51], v[92:95], v[164:167]
ds_read_b64_tr_b16 v[76:77], v24 offset:32768
v_and_b32 v30, s59, v114
v_mfma_f32_16x16x32_bf16 v[208:211], v[48:51], v[36:39], v[208:211]
ds_read_b64_tr_b16 v[78:79], v24 offset:33792
v_add_f32 v25, v25, v29
v_mfma_f32_16x16x32_bf16 v[168:171], v[52:55], v[80:83], v[168:171]
v_add_f32 v26, v26, v30
v_mfma_f32_16x16x32_bf16 v[172:175], v[52:55], v[84:87], v[172:175]
v_fma_f32 v27, v29, v29, v27
v_mfma_f32_16x16x32_bf16 v[176:179], v[52:55], v[88:91], v[176:179]
v_fma_f32 v28, v30, v30, v28
s_add_u32 m0, s40, 1024
s_add_u32 s33, s37, 1179648
buffer_load_dwordx4 v11, s[8:11], s82 offen sc1 lds
s_add_u32 m0, s41, 0
s_nop 0
buffer_load_dwordx4 v12, s[12:15], s33 offen sc1 lds
v_mfma_f32_16x16x32_bf16 v[180:183], v[52:55], v[92:95], v[180:183]
v_lshlrev_b32 v29, 16, v115
v_mfma_f32_16x16x32_bf16 v[212:215], v[52:55], v[36:39], v[212:215]
v_and_b32 v30, s59, v115
v_mfma_f32_16x16x32_bf16 v[184:187], v[56:59], v[80:83], v[184:187]
v_add_f32 v25, v25, v29
v_mfma_f32_16x16x32_bf16 v[188:191], v[56:59], v[84:87], v[188:191]
v_add_f32 v26, v26, v30
v_mfma_f32_16x16x32_bf16 v[192:195], v[56:59], v[88:91], v[192:195]
v_fma_f32 v27, v29, v29, v27
v_mfma_f32_16x16x32_bf16 v[196:199], v[56:59], v[92:95], v[196:199]
v_fma_f32 v28, v30, v30, v28
v_mfma_f32_16x16x32_bf16 v[216:219], v[56:59], v[36:39], v[216:219]
s_waitcnt lgkmcnt(0)
s_waitcnt vmcnt(12)
s_waitcnt vmcnt(7)
s_barrier
v_mfma_f32_16x16x32_bf16 v[120:123], v[60:63], v[96:99], v[120:123]
ds_read_b128 v[80:83], v14 offset:49152
v_lshlrev_b32 v29, 16, v116
v_and_b32 v30, s59, v116
v_mfma_f32_16x16x32_bf16 v[124:127], v[60:63], v[100:103], v[124:127]
ds_read_b128 v[84:87], v14 offset:51200
v_add_f32 v25, v25, v29
v_mfma_f32_16x16x32_bf16 v[128:131], v[60:63], v[104:107], v[128:131]
ds_read_b128 v[88:91], v14 offset:53248
v_add_f32 v26, v26, v30
s_add_u32 m0, s42, 65536
s_add_u32 s75, s75, s46
buffer_load_dwordx4 v13, s[16:19], s75 offen sc1 lds
v_mfma_f32_16x16x32_bf16 v[132:135], v[60:63], v[108:111], v[132:135]
ds_read_b128 v[92:95], v14 offset:55296
v_fma_f32 v27, v29, v29, v27
v_mfma_f32_16x16x32_bf16 v[136:139], v[64:67], v[96:99], v[136:139]
ds_read_b64_tr_b16 v[40:41], v16 offset:49152
v_fma_f32 v28, v30, v30, v28
v_mfma_f32_16x16x32_bf16 v[140:143], v[64:67], v[100:103], v[140:143]
ds_read_b64_tr_b16 v[42:43], v16 offset:49664
v_lshlrev_b32 v29, 16, v117
v_and_b32 v30, s59, v117
v_mfma_f32_16x16x32_bf16 v[144:147], v[64:67], v[104:107], v[144:147]
ds_read_b128 v[112:115], v31 offset:49152
v_add_f32 v25, v25, v29
v_mfma_f32_16x16x32_bf16 v[148:151], v[64:67], v[108:111], v[148:151]
ds_read_b64_tr_b16 v[44:45], v17 offset:0
v_add_f32 v26, v26, v30
v_mfma_f32_16x16x32_bf16 v[152:155], v[68:71], v[96:99], v[152:155]
ds_read_b64_tr_b16 v[46:47], v17 offset:1024
v_fma_f32 v27, v29, v29, v27
v_mfma_f32_16x16x32_bf16 v[156:159], v[68:71], v[100:103], v[156:159]
ds_read_b64_tr_b16 v[48:49], v18 offset:0
v_fma_f32 v28, v30, v30, v28
v_mfma_f32_16x16x32_bf16 v[160:163], v[68:71], v[104:107], v[160:163]
ds_read_b64_tr_b16 v[50:51], v18 offset:1024
v_lshlrev_b32 v29, 16, v118
v_and_b32 v30, s59, v118
v_mfma_f32_16x16x32_bf16 v[164:167], v[68:71], v[108:111], v[164:167]
ds_read_b64_tr_b16 v[52:53], v19 offset:0
v_add_f32 v25, v25, v29
s_add_u32 m0, s42, 73728
s_add_u32 s76, s76, s46
buffer_load_dwordx4 v13, s[20:23], s76 offen sc1 lds
v_mfma_f32_16x16x32_bf16 v[168:171], v[72:75], v[96:99], v[168:171]
ds_read_b64_tr_b16 v[54:55], v19 offset:1024
v_add_f32 v26, v26, v30
v_mfma_f32_16x16x32_bf16 v[172:175], v[72:75], v[100:103], v[172:175]
ds_read_b64_tr_b16 v[56:57], v20 offset:0
v_fma_f32 v27, v29, v29, v27
v_mfma_f32_16x16x32_bf16 v[176:179], v[72:75], v[104:107], v[176:179]
ds_read_b64_tr_b16 v[58:59], v20 offset:1024
v_fma_f32 v28, v30, v30, v28
v_mfma_f32_16x16x32_bf16 v[180:183], v[72:75], v[108:111], v[180:183]
v_lshlrev_b32 v29, 16, v119
v_and_b32 v30, s59, v119
v_mfma_f32_16x16x32_bf16 v[184:187], v[76:79], v[96:99], v[184:187]
v_add_f32 v25, v25, v29
v_mfma_f32_16x16x32_bf16 v[188:191], v[76:79], v[100:103], v[188:191]
v_add_f32 v26, v26, v30
v_mfma_f32_16x16x32_bf16 v[192:195], v[76:79], v[104:107], v[192:195]
v_fma_f32 v27, v29, v29, v27
v_mfma_f32_16x16x32_bf16 v[196:199], v[76:79], v[108:111], v[196:199]
v_fma_f32 v28, v30, v30, v28
s_waitcnt lgkmcnt(0)
s_barrier
v_lshlrev_b32 v8, 2, v1
s_mov_b64 exec, 3
buffer_load_dword v9, v8, s[96:99], 0 offen sc1
s_mov_b64 exec, -1
v_mfma_f32_16x16x32_bf16 v[120:123], v[40:43], v[80:83], v[120:123]
ds_read_b128 v[96:99], v15 offset:49152
v_lshlrev_b32 v29, 16, v112
v_mfma_f32_16x16x32_bf16 v[124:127], v[40:43], v[84:87], v[124:127]
ds_read_b128 v[100:103], v15 offset:51200
v_and_b32 v30, s59, v112
v_mfma_f32_16x16x32_bf16 v[128:131], v[40:43], v[88:91], v[128:131]
ds_read_b128 v[104:107], v15 offset:53248
v_add_f32 v25, v25, v29
s_add_u32 m0, s42, 0
s_add_u32 s75, s75, s46
buffer_load_dwordx4 v13, s[16:19], s75 offen sc1 lds
v_mfma_f32_16x16x32_bf16 v[132:135], v[40:43], v[92:95], v[132:135]
ds_read_b128 v[108:111], v15 offset:55296
v_add_f32 v26, v26, v30
v_mfma_f32_16x16x32_bf16 v[200:203], v[40:43], v[36:39], v[200:203]
ds_read_b64_tr_b16 v[60:61], v16 offset:53248
v_fma_f32 v27, v29, v29, v27
v_mfma_f32_16x16x32_bf16 v[136:139], v[44:47], v[80:83], v[136:139]
ds_read_b64_tr_b16 v[62:63], v16 offset:53760
v_fma_f32 v28, v30, v30, v28
v_mfma_f32_16x16x32_bf16 v[140:143], v[44:47], v[84:87], v[140:143]
ds_read_b128 v[116:119], v32 offset:49152
v_lshlrev_b32 v29, 16, v113
v_mfma_f32_16x16x32_bf16 v[144:147], v[44:47], v[88:91], v[144:147]
ds_read_b64_tr_b16 v[64:65], v17 offset:16384
v_and_b32 v30, s59, v113
s_add_u32 m0, s42, 8192
s_add_u32 s76, s76, s46
buffer_load_dwordx4 v13, s[20:23], s76 offen sc1 lds
v_mfma_f32_16x16x32_bf16 v[148:151], v[44:47], v[92:95], v[148:151]
ds_read_b64_tr_b16 v[66:67], v17 offset:17408
v_add_f32 v25, v25, v29
v_mfma_f32_16x16x32_bf16 v[204:207], v[44:47], v[36:39], v[204:207]
ds_read_b64_tr_b16 v[68:69], v18 offset:16384
v_add_f32 v26, v26, v30
v_mfma_f32_16x16x32_bf16 v[152:155], v[48:51], v[80:83], v[152:155]
ds_read_b64_tr_b16 v[70:71], v18 offset:17408
v_fma_f32 v27, v29, v29, v27
v_mfma_f32_16x16x32_bf16 v[156:159], v[48:51], v[84:87], v[156:159]
ds_read_b64_tr_b16 v[72:73], v19 offset:16384
v_fma_f32 v28, v30, v30, v28
v_mfma_f32_16x16x32_bf16 v[160:163], v[48:51], v[88:91], v[160:163]
ds_read_b64_tr_b16 v[74:75], v19 offset:17408
v_lshlrev_b32 v29, 16, v114
s_add_u32 m0, s40, 24576
s_add_u32 s82, s36, 896
buffer_load_dwordx4 v10, s[8:11], s82 offen sc1 lds
v_mfma_f32_16x16x32_bf16 v[164:167], v[48:51], v[92:95], v[164:167]
ds_read_b64_tr_b16 v[76:77], v20 offset:16384
v_and_b32 v30, s59, v114
v_mfma_f32_16x16x32_bf16 v[208:211], v[48:51], v[36:39], v[208:211]
ds_read_b64_tr_b16 v[78:79], v20 offset:17408
v_add_f32 v25, v25, v29
v_mfma_f32_16x16x32_bf16 v[168:171], v[52:55], v[80:83], v[168:171]
v_add_f32 v26, v26, v30
v_mfma_f32_16x16x32_bf16 v[172:175], v[52:55], v[84:87], v[172:175]
v_fma_f32 v27, v29, v29, v27
v_mfma_f32_16x16x32_bf16 v[176:179], v[52:55], v[88:91], v[176:179]
v_fma_f32 v28, v30, v30, v28
s_add_u32 m0, s40, 25600
s_add_u32 s33, s37, 1376256
buffer_load_dwordx4 v11, s[8:11], s82 offen sc1 lds
s_add_u32 m0, s41, 24576
s_nop 0
buffer_load_dwordx4 v12, s[12:15], s33 offen sc1 lds
v_mfma_f32_16x16x32_bf16 v[180:183], v[52:55], v[92:95], v[180:183]
v_lshlrev_b32 v29, 16, v115
v_mfma_f32_16x16x32_bf16 v[212:215], v[52:55], v[36:39], v[212:215]
v_and_b32 v30, s59, v115
v_mfma_f32_16x16x32_bf16 v[184:187], v[56:59], v[80:83], v[184:187]
v_add_f32 v25, v25, v29
v_mfma_f32_16x16x32_bf16 v[188:191], v[56:59], v[84:87], v[188:191]
v_add_f32 v26, v26, v30
v_mfma_f32_16x16x32_bf16 v[192:195], v[56:59], v[88:91], v[192:195]
v_fma_f32 v27, v29, v29, v27
v_mfma_f32_16x16x32_bf16 v[196:199], v[56:59], v[92:95], v[196:199]
v_fma_f32 v28, v30, v30, v28
v_mfma_f32_16x16x32_bf16 v[216:219], v[56:59], v[36:39], v[216:219]
s_waitcnt lgkmcnt(0)
s_waitcnt vmcnt(13)
s_waitcnt vmcnt(8)
s_barrier
v_mfma_f32_16x16x32_bf16 v[120:123], v[60:63], v[96:99], v[120:123]
ds_read_b128 v[80:83], v14 offset:0
v_lshlrev_b32 v29, 16, v116
v_and_b32 v30, s59, v116
v_mfma_f32_16x16x32_bf16 v[124:127], v[60:63], v[100:103], v[124:127]
ds_read_b128 v[84:87], v14 offset:2048
v_add_f32 v25, v25, v29
v_mfma_f32_16x16x32_bf16 v[128:131], v[60:63], v[104:107], v[128:131]
ds_read_b128 v[88:91], v14 offset:4096
v_add_f32 v26, v26, v30
v_mfma_f32_16x16x32_bf16 v[132:135], v[60:63], v[108:111], v[132:135]
ds_read_b128 v[92:95], v14 offset:6144
v_fma_f32 v27, v29, v29, v27
v_mfma_f32_16x16x32_bf16 v[136:139], v[64:67], v[96:99], v[136:139]
ds_read_b64_tr_b16 v[40:41], v16 offset:0
v_fma_f32 v28, v30, v30, v28
v_mfma_f32_16x16x32_bf16 v[140:143], v[64:67], v[100:103], v[140:143]
ds_read_b64_tr_b16 v[42:43], v16 offset:512
v_lshlrev_b32 v29, 16, v117
v_and_b32 v30, s59, v117
v_mfma_f32_16x16x32_bf16 v[144:147], v[64:67], v[104:107], v[144:147]
ds_read_b128 v[112:115], v31 offset:0
v_add_f32 v25, v25, v29
v_mfma_f32_16x16x32_bf16 v[148:151], v[64:67], v[108:111], v[148:151]
ds_read_b64_tr_b16 v[44:45], v21 offset:0
v_add_f32 v26, v26, v30
v_mfma_f32_16x16x32_bf16 v[152:155], v[68:71], v[96:99], v[152:155]
ds_read_b64_tr_b16 v[46:47], v21 offset:1024
v_fma_f32 v27, v29, v29, v27
v_mfma_f32_16x16x32_bf16 v[156:159], v[68:71], v[100:103], v[156:159]
ds_read_b64_tr_b16 v[48:49], v22 offset:0
v_fma_f32 v28, v30, v30, v28
v_mfma_f32_16x16x32_bf16 v[160:163], v[68:71], v[104:107], v[160:163]
ds_read_b64_tr_b16 v[50:51], v22 offset:1024
v_lshlrev_b32 v29, 16, v118
v_and_b32 v30, s59, v118
v_mfma_f32_16x16x32_bf16 v[164:167], v[68:71], v[108:111], v[164:167]
ds_read_b64_tr_b16 v[52:53], v23 offset:0
v_add_f32 v25, v25, v29
v_mfma_f32_16x16x32_bf16 v[168:171], v[72:75], v[96:99], v[168:171]
ds_read_b64_tr_b16 v[54:55], v23 offset:1024
v_add_f32 v26, v26, v30
v_mfma_f32_16x16x32_bf16 v[172:175], v[72:75], v[100:103], v[172:175]
ds_read_b64_tr_b16 v[56:57], v24 offset:0
v_fma_f32 v27, v29, v29, v27
v_mfma_f32_16x16x32_bf16 v[176:179], v[72:75], v[104:107], v[176:179]
ds_read_b64_tr_b16 v[58:59], v24 offset:1024
v_fma_f32 v28, v30, v30, v28
v_mfma_f32_16x16x32_bf16 v[180:183], v[72:75], v[108:111], v[180:183]
v_lshlrev_b32 v29, 16, v119
v_and_b32 v30, s59, v119
v_mfma_f32_16x16x32_bf16 v[184:187], v[76:79], v[96:99], v[184:187]
v_add_f32 v25, v25, v29
v_mfma_f32_16x16x32_bf16 v[188:191], v[76:79], v[100:103], v[188:191]
v_add_f32 v26, v26, v30
v_mfma_f32_16x16x32_bf16 v[192:195], v[76:79], v[104:107], v[192:195]
v_fma_f32 v27, v29, v29, v27
v_mfma_f32_16x16x32_bf16 v[196:199], v[76:79], v[108:111], v[196:199]
v_fma_f32 v28, v30, v30, v28
s_waitcnt lgkmcnt(0)
s_barrier
v_mfma_f32_16x16x32_bf16 v[120:123], v[40:43], v[80:83], v[120:123]
ds_read_b128 v[96:99], v15 offset:0
v_lshlrev_b32 v29, 16, v112
v_mfma_f32_16x16x32_bf16 v[124:127], v[40:43], v[84:87], v[124:127]
ds_read_b128 v[100:103], v15 offset:2048
v_and_b32 v30, s59, v112
v_mfma_f32_16x16x32_bf16 v[128:131], v[40:43], v[88:91], v[128:131]
ds_read_b128 v[104:107], v15 offset:4096
v_add_f32 v25, v25, v29
v_mfma_f32_16x16x32_bf16 v[132:135], v[40:43], v[92:95], v[132:135]
ds_read_b128 v[108:111], v15 offset:6144
v_add_f32 v26, v26, v30
v_mfma_f32_16x16x32_bf16 v[200:203], v[40:43], v[36:39], v[200:203]
ds_read_b64_tr_b16 v[60:61], v16 offset:4096
v_fma_f32 v27, v29, v29, v27
v_mfma_f32_16x16x32_bf16 v[136:139], v[44:47], v[80:83], v[136:139]
ds_read_b64_tr_b16 v[62:63], v16 offset:4608
v_fma_f32 v28, v30, v30, v28
v_mfma_f32_16x16x32_bf16 v[140:143], v[44:47], v[84:87], v[140:143]
ds_read_b128 v[116:119], v32 offset:0
v_lshlrev_b32 v29, 16, v113
v_mfma_f32_16x16x32_bf16 v[144:147], v[44:47], v[88:91], v[144:147]
ds_read_b64_tr_b16 v[64:65], v21 offset:16384
v_and_b32 v30, s59, v113
v_mfma_f32_16x16x32_bf16 v[148:151], v[44:47], v[92:95], v[148:151]
ds_read_b64_tr_b16 v[66:67], v21 offset:17408
v_add_f32 v25, v25, v29
v_mfma_f32_16x16x32_bf16 v[204:207], v[44:47], v[36:39], v[204:207]
ds_read_b64_tr_b16 v[68:69], v22 offset:16384
v_add_f32 v26, v26, v30
v_mfma_f32_16x16x32_bf16 v[152:155], v[48:51], v[80:83], v[152:155]
ds_read_b64_tr_b16 v[70:71], v22 offset:17408
v_fma_f32 v27, v29, v29, v27
v_mfma_f32_16x16x32_bf16 v[156:159], v[48:51], v[84:87], v[156:159]
ds_read_b64_tr_b16 v[72:73], v23 offset:16384
v_fma_f32 v28, v30, v30, v28
v_mfma_f32_16x16x32_bf16 v[160:163], v[48:51], v[88:91], v[160:163]
ds_read_b64_tr_b16 v[74:75], v23 offset:17408
v_lshlrev_b32 v29, 16, v114
v_mfma_f32_16x16x32_bf16 v[164:167], v[48:51], v[92:95], v[164:167]
ds_read_b64_tr_b16 v[76:77], v24 offset:16384
v_and_b32 v30, s59, v114
v_mfma_f32_16x16x32_bf16 v[208:211], v[48:51], v[36:39], v[208:211]
ds_read_b64_tr_b16 v[78:79], v24 offset:17408
v_add_f32 v25, v25, v29
v_mfma_f32_16x16x32_bf16 v[168:171], v[52:55], v[80:83], v[168:171]
v_add_f32 v26, v26, v30
v_mfma_f32_16x16x32_bf16 v[172:175], v[52:55], v[84:87], v[172:175]
v_fma_f32 v27, v29, v29, v27
v_mfma_f32_16x16x32_bf16 v[176:179], v[52:55], v[88:91], v[176:179]
v_fma_f32 v28, v30, v30, v28
v_mfma_f32_16x16x32_bf16 v[180:183], v[52:55], v[92:95], v[180:183]
v_lshlrev_b32 v29, 16, v115
v_mfma_f32_16x16x32_bf16 v[212:215], v[52:55], v[36:39], v[212:215]
v_and_b32 v30, s59, v115
v_mfma_f32_16x16x32_bf16 v[184:187], v[56:59], v[80:83], v[184:187]
v_add_f32 v25, v25, v29
v_mfma_f32_16x16x32_bf16 v[188:191], v[56:59], v[84:87], v[188:191]
v_add_f32 v26, v26, v30
v_mfma_f32_16x16x32_bf16 v[192:195], v[56:59], v[88:91], v[192:195]
v_fma_f32 v27, v29, v29, v27
v_mfma_f32_16x16x32_bf16 v[196:199], v[56:59], v[92:95], v[196:199]
v_fma_f32 v28, v30, v30, v28
v_mfma_f32_16x16x32_bf16 v[216:219], v[56:59], v[36:39], v[216:219]
s_waitcnt lgkmcnt(0)
s_waitcnt vmcnt(6)
s_waitcnt vmcnt(0)
s_barrier
v_mfma_f32_16x16x32_bf16 v[120:123], v[60:63], v[96:99], v[120:123]
ds_read_b128 v[80:83], v14 offset:24576
v_lshlrev_b32 v29, 16, v116
v_and_b32 v30, s59, v116
v_mfma_f32_16x16x32_bf16 v[124:127], v[60:63], v[100:103], v[124:127]
ds_read_b128 v[84:87], v14 offset:26624
v_add_f32 v25, v25, v29
v_mfma_f32_16x16x32_bf16 v[128:131], v[60:63], v[104:107], v[128:131]
ds_read_b128 v[88:91], v14 offset:28672
v_add_f32 v26, v26, v30
v_mfma_f32_16x16x32_bf16 v[132:135], v[60:63], v[108:111], v[132:135]
ds_read_b128 v[92:95], v14 offset:30720
v_fma_f32 v27, v29, v29, v27
v_mfma_f32_16x16x32_bf16 v[136:139], v[64:67], v[96:99], v[136:139]
ds_read_b64_tr_b16 v[40:41], v16 offset:24576
v_fma_f32 v28, v30, v30, v28
v_mfma_f32_16x16x32_bf16 v[140:143], v[64:67], v[100:103], v[140:143]
ds_read_b64_tr_b16 v[42:43], v16 offset:25088
v_lshlrev_b32 v29, 16, v117
v_and_b32 v30, s59, v117
v_mfma_f32_16x16x32_bf16 v[144:147], v[64:67], v[104:107], v[144:147]
ds_read_b128 v[112:115], v31 offset:24576
v_add_f32 v25, v25, v29
v_mfma_f32_16x16x32_bf16 v[148:151], v[64:67], v[108:111], v[148:151]
ds_read_b64_tr_b16 v[44:45], v21 offset:32768
v_add_f32 v26, v26, v30
v_mfma_f32_16x16x32_bf16 v[152:155], v[68:71], v[96:99], v[152:155]
ds_read_b64_tr_b16 v[46:47], v21 offset:33792
v_fma_f32 v27, v29, v29, v27
v_mfma_f32_16x16x32_bf16 v[156:159], v[68:71], v[100:103], v[156:159]
ds_read_b64_tr_b16 v[48:49], v22 offset:32768
v_fma_f32 v28, v30, v30, v28
v_mfma_f32_16x16x32_bf16 v[160:163], v[68:71], v[104:107], v[160:163]
ds_read_b64_tr_b16 v[50:51], v22 offset:33792
v_lshlrev_b32 v29, 16, v118
v_and_b32 v30, s59, v118
v_mfma_f32_16x16x32_bf16 v[164:167], v[68:71], v[108:111], v[164:167]
ds_read_b64_tr_b16 v[52:53], v23 offset:32768
v_add_f32 v25, v25, v29
v_mfma_f32_16x16x32_bf16 v[168:171], v[72:75], v[96:99], v[168:171]
ds_read_b64_tr_b16 v[54:55], v23 offset:33792
v_add_f32 v26, v26, v30
v_mfma_f32_16x16x32_bf16 v[172:175], v[72:75], v[100:103], v[172:175]
ds_read_b64_tr_b16 v[56:57], v24 offset:32768
v_fma_f32 v27, v29, v29, v27
v_mfma_f32_16x16x32_bf16 v[176:179], v[72:75], v[104:107], v[176:179]
ds_read_b64_tr_b16 v[58:59], v24 offset:33792
v_fma_f32 v28, v30, v30, v28
v_mfma_f32_16x16x32_bf16 v[180:183], v[72:75], v[108:111], v[180:183]
v_lshlrev_b32 v29, 16, v119
v_and_b32 v30, s59, v119
v_mfma_f32_16x16x32_bf16 v[184:187], v[76:79], v[96:99], v[184:187]
v_add_f32 v25, v25, v29
v_mfma_f32_16x16x32_bf16 v[188:191], v[76:79], v[100:103], v[188:191]
v_add_f32 v26, v26, v30
v_mfma_f32_16x16x32_bf16 v[192:195], v[76:79], v[104:107], v[192:195]
v_fma_f32 v27, v29, v29, v27
v_mfma_f32_16x16x32_bf16 v[196:199], v[76:79], v[108:111], v[196:199]
v_fma_f32 v28, v30, v30, v28
s_waitcnt lgkmcnt(0)
s_barrier
v_mfma_f32_16x16x32_bf16 v[120:123], v[40:43], v[80:83], v[120:123]
ds_read_b128 v[96:99], v15 offset:24576
v_lshlrev_b32 v29, 16, v112
v_mfma_f32_16x16x32_bf16 v[124:127], v[40:43], v[84:87], v[124:127]
ds_read_b128 v[100:103], v15 offset:26624
v_and_b32 v30, s59, v112
v_mfma_f32_16x16x32_bf16 v[128:131], v[40:43], v[88:91], v[128:131]
ds_read_b128 v[104:107], v15 offset:28672
v_add_f32 v25, v25, v29
v_mfma_f32_16x16x32_bf16 v[132:135], v[40:43], v[92:95], v[132:135]
ds_read_b128 v[108:111], v15 offset:30720
v_add_f32 v26, v26, v30
v_mfma_f32_16x16x32_bf16 v[200:203], v[40:43], v[36:39], v[200:203]
ds_read_b64_tr_b16 v[60:61], v16 offset:28672
v_fma_f32 v27, v29, v29, v27
v_mfma_f32_16x16x32_bf16 v[136:139], v[44:47], v[80:83], v[136:139]
ds_read_b64_tr_b16 v[62:63], v16 offset:29184
v_fma_f32 v28, v30, v30, v28
v_mfma_f32_16x16x32_bf16 v[140:143], v[44:47], v[84:87], v[140:143]
ds_read_b128 v[116:119], v32 offset:24576
v_lshlrev_b32 v29, 16, v113
v_mfma_f32_16x16x32_bf16 v[144:147], v[44:47], v[88:91], v[144:147]
ds_read_b64_tr_b16 v[64:65], v17 offset:0
v_and_b32 v30, s59, v113
v_mfma_f32_16x16x32_bf16 v[148:151], v[44:47], v[92:95], v[148:151]
ds_read_b64_tr_b16 v[66:67], v17 offset:1024
v_add_f32 v25, v25, v29
v_mfma_f32_16x16x32_bf16 v[204:207], v[44:47], v[36:39], v[204:207]
ds_read_b64_tr_b16 v[68:69], v18 offset:0
v_add_f32 v26, v26, v30
v_mfma_f32_16x16x32_bf16 v[152:155], v[48:51], v[80:83], v[152:155]
ds_read_b64_tr_b16 v[70:71], v18 offset:1024
v_fma_f32 v27, v29, v29, v27
v_mfma_f32_16x16x32_bf16 v[156:159], v[48:51], v[84:87], v[156:159]
ds_read_b64_tr_b16 v[72:73], v19 offset:0
v_fma_f32 v28, v30, v30, v28
v_mfma_f32_16x16x32_bf16 v[160:163], v[48:51], v[88:91], v[160:163]
ds_read_b64_tr_b16 v[74:75], v19 offset:1024
v_lshlrev_b32 v29, 16, v114
v_mfma_f32_16x16x32_bf16 v[164:167], v[48:51], v[92:95], v[164:167]
ds_read_b64_tr_b16 v[76:77], v20 offset:0
v_and_b32 v30, s59, v114
v_mfma_f32_16x16x32_bf16 v[208:211], v[48:51], v[36:39], v[208:211]
ds_read_b64_tr_b16 v[78:79], v20 offset:1024
v_add_f32 v25, v25, v29
v_mfma_f32_16x16x32_bf16 v[168:171], v[52:55], v[80:83], v[168:171]
v_add_f32 v26, v26, v30
v_mfma_f32_16x16x32_bf16 v[172:175], v[52:55], v[84:87], v[172:175]
v_fma_f32 v27, v29, v29, v27
v_mfma_f32_16x16x32_bf16 v[176:179], v[52:55], v[88:91], v[176:179]
v_fma_f32 v28, v30, v30, v28
v_mfma_f32_16x16x32_bf16 v[180:183], v[52:55], v[92:95], v[180:183]
v_lshlrev_b32 v29, 16, v115
v_mfma_f32_16x16x32_bf16 v[212:215], v[52:55], v[36:39], v[212:215]
v_and_b32 v30, s59, v115
v_mfma_f32_16x16x32_bf16 v[184:187], v[56:59], v[80:83], v[184:187]
v_add_f32 v25, v25, v29
v_mfma_f32_16x16x32_bf16 v[188:191], v[56:59], v[84:87], v[188:191]
v_add_f32 v26, v26, v30
v_mfma_f32_16x16x32_bf16 v[192:195], v[56:59], v[88:91], v[192:195]
v_fma_f32 v27, v29, v29, v27
v_mfma_f32_16x16x32_bf16 v[196:199], v[56:59], v[92:95], v[196:199]
v_fma_f32 v28, v30, v30, v28
v_mfma_f32_16x16x32_bf16 v[216:219], v[56:59], v[36:39], v[216:219]
s_waitcnt lgkmcnt(0)
s_barrier
v_mfma_f32_16x16x32_bf16 v[120:123], v[60:63], v[96:99], v[120:123]
v_lshlrev_b32 v29, 16, v116
v_and_b32 v30, s59, v116
v_mfma_f32_16x16x32_bf16 v[124:127], v[60:63], v[100:103], v[124:127]
v_add_f32 v25, v25, v29
v_mfma_f32_16x16x32_bf16 v[128:131], v[60:63], v[104:107], v[128:131]
v_add_f32 v26, v26, v30
v_mfma_f32_16x16x32_bf16 v[132:135], v[60:63], v[108:111], v[132:135]
v_fma_f32 v27, v29, v29, v27
v_mfma_f32_16x16x32_bf16 v[136:139], v[64:67], v[96:99], v[136:139]
v_fma_f32 v28, v30, v30, v28
v_mfma_f32_16x16x32_bf16 v[140:143], v[64:67], v[100:103], v[140:143]
v_lshlrev_b32 v29, 16, v117
v_and_b32 v30, s59, v117
v_mfma_f32_16x16x32_bf16 v[144:147], v[64:67], v[104:107], v[144:147]
v_add_f32 v25, v25, v29
v_mfma_f32_16x16x32_bf16 v[148:151], v[64:67], v[108:111], v[148:151]
v_add_f32 v26, v26, v30
v_mfma_f32_16x16x32_bf16 v[152:155], v[68:71], v[96:99], v[152:155]
v_fma_f32 v27, v29, v29, v27
v_mfma_f32_16x16x32_bf16 v[156:159], v[68:71], v[100:103], v[156:159]
v_fma_f32 v28, v30, v30, v28
v_mfma_f32_16x16x32_bf16 v[160:163], v[68:71], v[104:107], v[160:163]
v_lshlrev_b32 v29, 16, v118
v_and_b32 v30, s59, v118
v_mfma_f32_16x16x32_bf16 v[164:167], v[68:71], v[108:111], v[164:167]
v_add_f32 v25, v25, v29
v_mfma_f32_16x16x32_bf16 v[168:171], v[72:75], v[96:99], v[168:171]
v_add_f32 v26, v26, v30
v_mfma_f32_16x16x32_bf16 v[172:175], v[72:75], v[100:103], v[172:175]
v_fma_f32 v27, v29, v29, v27
v_mfma_f32_16x16x32_bf16 v[176:179], v[72:75], v[104:107], v[176:179]
v_fma_f32 v28, v30, v30, v28
v_mfma_f32_16x16x32_bf16 v[180:183], v[72:75], v[108:111], v[180:183]
v_lshlrev_b32 v29, 16, v119
v_and_b32 v30, s59, v119
v_mfma_f32_16x16x32_bf16 v[184:187], v[76:79], v[96:99], v[184:187]
v_add_f32 v25, v25, v29
v_mfma_f32_16x16x32_bf16 v[188:191], v[76:79], v[100:103], v[188:191]
v_add_f32 v26, v26, v30
v_mfma_f32_16x16x32_bf16 v[192:195], v[76:79], v[104:107], v[192:195]
v_fma_f32 v27, v29, v29, v27
v_mfma_f32_16x16x32_bf16 v[196:199], v[76:79], v[108:111], v[196:199]
v_fma_f32 v28, v30, v30, v28
s_branch parallel_sum__mha_block__geglu_ffn__prompt_kernel_Atail
parallel_sum__mha_block__geglu_ffn__prompt_kernel_A1:
s_waitcnt vmcnt(9)
s_waitcnt vmcnt(7)
s_waitcnt lgkmcnt(0)
s_barrier
ds_read_b128 v[80:83], v14 offset:0
ds_read_b128 v[84:87], v14 offset:2048
ds_read_b128 v[88:91], v14 offset:4096
ds_read_b128 v[92:95], v14 offset:6144
ds_read_b64_tr_b16 v[40:41], v16 offset:0
ds_read_b64_tr_b16 v[42:43], v16 offset:512
ds_read_b128 v[112:115], v31 offset:0
ds_read_b64_tr_b16 v[44:45], v17 offset:0
ds_read_b64_tr_b16 v[46:47], v17 offset:1024
ds_read_b64_tr_b16 v[48:49], v18 offset:0
ds_read_b64_tr_b16 v[50:51], v18 offset:1024
ds_read_b64_tr_b16 v[52:53], v19 offset:0
ds_read_b64_tr_b16 v[54:55], v19 offset:1024
ds_read_b64_tr_b16 v[56:57], v20 offset:0
ds_read_b64_tr_b16 v[58:59], v20 offset:1024
s_waitcnt lgkmcnt(0)
s_waitcnt vmcnt(5)
s_barrier
s_lshl_b32 s33, s28, 13
v_lshlrev_b32 v4, 7, v1
v_add_u32 v4, s33, v4
s_mov_b32 s33, parallel_sum__mha_block__geglu_ffn__prompt_kernel_end-parallel_sum__mha_block__geglu_ffn__prompt_kernel_pc-4
v_min_u32 v4, s33, v4
global_load_dword v235, v4, s[78:79]
v_mfma_f32_16x16x32_bf16 v[120:123], v[40:43], v[80:83], 0
ds_read_b128 v[96:99], v15 offset:0
v_lshlrev_b32 v29, 16, v112
v_and_b32 v30, s59, v112
v_mfma_f32_16x16x32_bf16 v[124:127], v[40:43], v[84:87], 0
ds_read_b128 v[100:103], v15 offset:2048
v_add_f32 v25, v25, v29
v_mfma_f32_16x16x32_bf16 v[128:131], v[40:43], v[88:91], 0
ds_read_b128 v[104:107], v15 offset:4096
v_add_f32 v26, v26, v30
s_add_u32 m0, s42, 49152
s_add_u32 s75, s75, s46
buffer_load_dwordx4 v13, s[16:19], s75 offen sc1 lds
v_mfma_f32_16x16x32_bf16 v[132:135], v[40:43], v[92:95], 0
ds_read_b128 v[108:111], v15 offset:6144
v_fma_f32 v27, v29, v29, v27
v_mfma_f32_16x16x32_bf16 v[136:139], v[44:47], v[80:83], 0
ds_read_b64_tr_b16 v[60:61], v16 offset:4096
v_fma_f32 v28, v30, v30, v28
v_mfma_f32_16x16x32_bf16 v[140:143], v[44:47], v[84:87], 0
ds_read_b64_tr_b16 v[62:63], v16 offset:4608
v_lshlrev_b32 v29, 16, v113
v_and_b32 v30, s59, v113
v_mfma_f32_16x16x32_bf16 v[144:147], v[44:47], v[88:91], 0
ds_read_b128 v[116:119], v32 offset:0
v_add_f32 v25, v25, v29
s_add_u32 m0, s42, 57344
s_add_u32 s76, s76, s46
buffer_load_dwordx4 v13, s[20:23], s76 offen sc1 lds
v_mfma_f32_16x16x32_bf16 v[148:151], v[44:47], v[92:95], 0
ds_read_b64_tr_b16 v[64:65], v17 offset:16384
v_add_f32 v26, v26, v30
v_mfma_f32_16x16x32_bf16 v[152:155], v[48:51], v[80:83], 0
ds_read_b64_tr_b16 v[66:67], v17 offset:17408
v_fma_f32 v27, v29, v29, v27
v_mfma_f32_16x16x32_bf16 v[156:159], v[48:51], v[84:87], 0
ds_read_b64_tr_b16 v[68:69], v18 offset:16384
v_fma_f32 v28, v30, v30, v28
v_mfma_f32_16x16x32_bf16 v[160:163], v[48:51], v[88:91], 0
ds_read_b64_tr_b16 v[70:71], v18 offset:17408
v_lshlrev_b32 v29, 16, v114
v_and_b32 v30, s59, v114
s_add_u32 m0, s40, 49152
s_add_u32 s82, s36, 256
buffer_load_dwordx4 v10, s[8:11], s82 offen sc1 lds
v_mfma_f32_16x16x32_bf16 v[164:167], v[48:51], v[92:95], 0
ds_read_b64_tr_b16 v[72:73], v19 offset:16384
v_add_f32 v25, v25, v29
v_mfma_f32_16x16x32_bf16 v[168:171], v[52:55], v[80:83], 0
ds_read_b64_tr_b16 v[74:75], v19 offset:17408
v_add_f32 v26, v26, v30
v_mfma_f32_16x16x32_bf16 v[172:175], v[52:55], v[84:87], 0
ds_read_b64_tr_b16 v[76:77], v20 offset:16384
v_fma_f32 v27, v29, v29, v27
v_mfma_f32_16x16x32_bf16 v[176:179], v[52:55], v[88:91], 0
ds_read_b64_tr_b16 v[78:79], v20 offset:17408
v_fma_f32 v28, v30, v30, v28
s_add_u32 m0, s40, 50176
s_add_u32 s33, s37, 393216
buffer_load_dwordx4 v11, s[8:11], s82 offen sc1 lds
s_add_u32 m0, s41, 49152
s_nop 0
buffer_load_dwordx4 v12, s[12:15], s33 offen sc1 lds
v_mfma_f32_16x16x32_bf16 v[180:183], v[52:55], v[92:95], 0
v_lshlrev_b32 v29, 16, v115
v_and_b32 v30, s59, v115
v_mfma_f32_16x16x32_bf16 v[184:187], v[56:59], v[80:83], 0
v_add_f32 v25, v25, v29
v_mfma_f32_16x16x32_bf16 v[188:191], v[56:59], v[84:87], 0
v_add_f32 v26, v26, v30
v_mfma_f32_16x16x32_bf16 v[192:195], v[56:59], v[88:91], 0
v_fma_f32 v27, v29, v29, v27
v_mfma_f32_16x16x32_bf16 v[196:199], v[56:59], v[92:95], 0
v_fma_f32 v28, v30, v30, v28
s_waitcnt lgkmcnt(0)
s_waitcnt vmcnt(6)
s_barrier
v_mfma_f32_16x16x32_bf16 v[120:123], v[60:63], v[96:99], v[120:123]
ds_read_b128 v[80:83], v14 offset:24576
v_lshlrev_b32 v29, 16, v116
v_mfma_f32_16x16x32_bf16 v[124:127], v[60:63], v[100:103], v[124:127]
ds_read_b128 v[84:87], v14 offset:26624
v_and_b32 v30, s59, v116
v_mfma_f32_16x16x32_bf16 v[128:131], v[60:63], v[104:107], v[128:131]
ds_read_b128 v[88:91], v14 offset:28672
v_add_f32 v25, v25, v29
s_add_u32 m0, s42, 65536
s_add_u32 s75, s75, s46
buffer_load_dwordx4 v13, s[16:19], s75 offen sc1 lds
v_mfma_f32_16x16x32_bf16 v[132:135], v[60:63], v[108:111], v[132:135]
ds_read_b128 v[92:95], v14 offset:30720
v_add_f32 v26, v26, v30
v_mfma_f32_16x16x32_bf16 v[200:203], v[60:63], v[36:39], 0
ds_read_b64_tr_b16 v[40:41], v16 offset:24576
v_fma_f32 v27, v29, v29, v27
v_mfma_f32_16x16x32_bf16 v[136:139], v[64:67], v[96:99], v[136:139]
ds_read_b64_tr_b16 v[42:43], v16 offset:25088
v_fma_f32 v28, v30, v30, v28
v_mfma_f32_16x16x32_bf16 v[140:143], v[64:67], v[100:103], v[140:143]
ds_read_b128 v[112:115], v31 offset:24576
v_lshlrev_b32 v29, 16, v117
v_mfma_f32_16x16x32_bf16 v[144:147], v[64:67], v[104:107], v[144:147]
ds_read_b64_tr_b16 v[44:45], v21 offset:0
v_and_b32 v30, s59, v117
s_add_u32 m0, s42, 73728
s_add_u32 s76, s76, s46
buffer_load_dwordx4 v13, s[20:23], s76 offen sc1 lds
v_mfma_f32_16x16x32_bf16 v[148:151], v[64:67], v[108:111], v[148:151]
ds_read_b64_tr_b16 v[46:47], v21 offset:1024
v_add_f32 v25, v25, v29
v_mfma_f32_16x16x32_bf16 v[204:207], v[64:67], v[36:39], 0
ds_read_b64_tr_b16 v[48:49], v22 offset:0
v_add_f32 v26, v26, v30
v_mfma_f32_16x16x32_bf16 v[152:155], v[68:71], v[96:99], v[152:155]
ds_read_b64_tr_b16 v[50:51], v22 offset:1024
v_fma_f32 v27, v29, v29, v27
v_mfma_f32_16x16x32_bf16 v[156:159], v[68:71], v[100:103], v[156:159]
ds_read_b64_tr_b16 v[52:53], v23 offset:0
v_fma_f32 v28, v30, v30, v28
v_mfma_f32_16x16x32_bf16 v[160:163], v[68:71], v[104:107], v[160:163]
ds_read_b64_tr_b16 v[54:55], v23 offset:1024
v_lshlrev_b32 v29, 16, v118
s_add_u32 m0, s42, 0
s_add_u32 s75, s75, s46
buffer_load_dwordx4 v13, s[16:19], s75 offen sc1 lds
v_mfma_f32_16x16x32_bf16 v[164:167], v[68:71], v[108:111], v[164:167]
ds_read_b64_tr_b16 v[56:57], v24 offset:0
v_and_b32 v30, s59, v118
v_mfma_f32_16x16x32_bf16 v[208:211], v[68:71], v[36:39], 0
ds_read_b64_tr_b16 v[58:59], v24 offset:1024
v_add_f32 v25, v25, v29
v_mfma_f32_16x16x32_bf16 v[168:171], v[72:75], v[96:99], v[168:171]
v_add_f32 v26, v26, v30
v_mfma_f32_16x16x32_bf16 v[172:175], v[72:75], v[100:103], v[172:175]
v_fma_f32 v27, v29, v29, v27
v_mfma_f32_16x16x32_bf16 v[176:179], v[72:75], v[104:107], v[176:179]
v_fma_f32 v28, v30, v30, v28
s_add_u32 m0, s42, 8192
s_add_u32 s76, s76, s46
buffer_load_dwordx4 v13, s[20:23], s76 offen sc1 lds
v_mfma_f32_16x16x32_bf16 v[180:183], v[72:75], v[108:111], v[180:183]
v_lshlrev_b32 v29, 16, v119
v_mfma_f32_16x16x32_bf16 v[212:215], v[72:75], v[36:39], 0
v_and_b32 v30, s59, v119
v_mfma_f32_16x16x32_bf16 v[184:187], v[76:79], v[96:99], v[184:187]
v_add_f32 v25, v25, v29
v_mfma_f32_16x16x32_bf16 v[188:191], v[76:79], v[100:103], v[188:191]
v_add_f32 v26, v26, v30
v_mfma_f32_16x16x32_bf16 v[192:195], v[76:79], v[104:107], v[192:195]
v_fma_f32 v27, v29, v29, v27
v_mfma_f32_16x16x32_bf16 v[196:199], v[76:79], v[108:111], v[196:199]
v_fma_f32 v28, v30, v30, v28
v_mfma_f32_16x16x32_bf16 v[216:219], v[76:79], v[36:39], 0
s_waitcnt lgkmcnt(0)
s_waitcnt vmcnt(7)
s_barrier
v_mfma_f32_16x16x32_bf16 v[120:123], v[40:43], v[80:83], v[120:123]
ds_read_b128 v[96:99], v15 offset:24576
v_lshlrev_b32 v29, 16, v112
v_and_b32 v30, s59, v112
v_mfma_f32_16x16x32_bf16 v[124:127], v[40:43], v[84:87], v[124:127]
ds_read_b128 v[100:103], v15 offset:26624
v_add_f32 v25, v25, v29
v_mfma_f32_16x16x32_bf16 v[128:131], v[40:43], v[88:91], v[128:131]
ds_read_b128 v[104:107], v15 offset:28672
v_add_f32 v26, v26, v30
s_add_u32 m0, s42, 16384
s_add_u32 s75, s75, s46
buffer_load_dwordx4 v13, s[16:19], s75 offen sc1 lds
v_mfma_f32_16x16x32_bf16 v[132:135], v[40:43], v[92:95], v[132:135]
ds_read_b128 v[108:111], v15 offset:30720
v_fma_f32 v27, v29, v29, v27
v_mfma_f32_16x16x32_bf16 v[136:139], v[44:47], v[80:83], v[136:139]
ds_read_b64_tr_b16 v[60:61], v16 offset:28672
v_fma_f32 v28, v30, v30, v28
v_mfma_f32_16x16x32_bf16 v[140:143], v[44:47], v[84:87], v[140:143]
ds_read_b64_tr_b16 v[62:63], v16 offset:29184
v_lshlrev_b32 v29, 16, v113
v_and_b32 v30, s59, v113
v_mfma_f32_16x16x32_bf16 v[144:147], v[44:47], v[88:91], v[144:147]
ds_read_b128 v[116:119], v32 offset:24576
v_add_f32 v25, v25, v29
s_add_u32 m0, s42, 24576
s_add_u32 s76, s76, s46
buffer_load_dwordx4 v13, s[20:23], s76 offen sc1 lds
v_mfma_f32_16x16x32_bf16 v[148:151], v[44:47], v[92:95], v[148:151]
ds_read_b64_tr_b16 v[64:65], v21 offset:16384
v_add_f32 v26, v26, v30
v_mfma_f32_16x16x32_bf16 v[152:155], v[48:51], v[80:83], v[152:155]
ds_read_b64_tr_b16 v[66:67], v21 offset:17408
v_fma_f32 v27, v29, v29, v27
v_mfma_f32_16x16x32_bf16 v[156:159], v[48:51], v[84:87], v[156:159]
ds_read_b64_tr_b16 v[68:69], v22 offset:16384
v_fma_f32 v28, v30, v30, v28
v_mfma_f32_16x16x32_bf16 v[160:163], v[48:51], v[88:91], v[160:163]
ds_read_b64_tr_b16 v[70:71], v22 offset:17408
v_lshlrev_b32 v29, 16, v114
v_and_b32 v30, s59, v114
s_add_u32 m0, s40, 0
s_add_u32 s82, s36, 384
buffer_load_dwordx4 v10, s[8:11], s82 offen sc1 lds
v_mfma_f32_16x16x32_bf16 v[164:167], v[48:51], v[92:95], v[164:167]
ds_read_b64_tr_b16 v[72:73], v23 offset:16384
v_add_f32 v25, v25, v29
v_mfma_f32_16x16x32_bf16 v[168:171], v[52:55], v[80:83], v[168:171]
ds_read_b64_tr_b16 v[74:75], v23 offset:17408
v_add_f32 v26, v26, v30
v_mfma_f32_16x16x32_bf16 v[172:175], v[52:55], v[84:87], v[172:175]
ds_read_b64_tr_b16 v[76:77], v24 offset:16384
v_fma_f32 v27, v29, v29, v27
v_mfma_f32_16x16x32_bf16 v[176:179], v[52:55], v[88:91], v[176:179]
ds_read_b64_tr_b16 v[78:79], v24 offset:17408
v_fma_f32 v28, v30, v30, v28
s_add_u32 m0, s40, 1024
s_add_u32 s33, s37, 589824
buffer_load_dwordx4 v11, s[8:11], s82 offen sc1 lds
s_add_u32 m0, s41, 0
s_nop 0
buffer_load_dwordx4 v12, s[12:15], s33 offen sc1 lds
v_mfma_f32_16x16x32_bf16 v[180:183], v[52:55], v[92:95], v[180:183]
v_lshlrev_b32 v29, 16, v115
v_and_b32 v30, s59, v115
v_mfma_f32_16x16x32_bf16 v[184:187], v[56:59], v[80:83], v[184:187]
v_add_f32 v25, v25, v29
v_mfma_f32_16x16x32_bf16 v[188:191], v[56:59], v[84:87], v[188:191]
v_add_f32 v26, v26, v30
v_mfma_f32_16x16x32_bf16 v[192:195], v[56:59], v[88:91], v[192:195]
v_fma_f32 v27, v29, v29, v27
v_mfma_f32_16x16x32_bf16 v[196:199], v[56:59], v[92:95], v[196:199]
v_fma_f32 v28, v30, v30, v28
s_waitcnt lgkmcnt(0)
s_waitcnt vmcnt(7)
s_barrier
v_mfma_f32_16x16x32_bf16 v[120:123], v[60:63], v[96:99], v[120:123]
ds_read_b128 v[80:83], v14 offset:49152
v_lshlrev_b32 v29, 16, v116
v_mfma_f32_16x16x32_bf16 v[124:127], v[60:63], v[100:103], v[124:127]
ds_read_b128 v[84:87], v14 offset:51200
v_and_b32 v30, s59, v116
v_mfma_f32_16x16x32_bf16 v[128:131], v[60:63], v[104:107], v[128:131]
ds_read_b128 v[88:91], v14 offset:53248
v_add_f32 v25, v25, v29
s_add_u32 m0, s42, 32768
s_add_u32 s75, s75, s46
buffer_load_dwordx4 v13, s[16:19], s75 offen sc1 lds
v_mfma_f32_16x16x32_bf16 v[132:135], v[60:63], v[108:111], v[132:135]
ds_read_b128 v[92:95], v14 offset:55296
v_add_f32 v26, v26, v30
v_mfma_f32_16x16x32_bf16 v[200:203], v[60:63], v[36:39], v[200:203]
ds_read_b64_tr_b16 v[40:41], v16 offset:49152
v_fma_f32 v27, v29, v29, v27
v_mfma_f32_16x16x32_bf16 v[136:139], v[64:67], v[96:99], v[136:139]
ds_read_b64_tr_b16 v[42:43], v16 offset:49664
v_fma_f32 v28, v30, v30, v28
v_mfma_f32_16x16x32_bf16 v[140:143], v[64:67], v[100:103], v[140:143]
ds_read_b128 v[112:115], v31 offset:49152
v_lshlrev_b32 v29, 16, v117
v_mfma_f32_16x16x32_bf16 v[144:147], v[64:67], v[104:107], v[144:147]
ds_read_b64_tr_b16 v[44:45], v21 offset:32768
v_and_b32 v30, s59, v117
s_add_u32 m0, s42, 40960
s_add_u32 s76, s76, s46
buffer_load_dwordx4 v13, s[20:23], s76 offen sc1 lds
v_mfma_f32_16x16x32_bf16 v[148:151], v[64:67], v[108:111], v[148:151]
ds_read_b64_tr_b16 v[46:47], v21 offset:33792
v_add_f32 v25, v25, v29
v_mfma_f32_16x16x32_bf16 v[204:207], v[64:67], v[36:39], v[204:207]
ds_read_b64_tr_b16 v[48:49], v22 offset:32768
v_add_f32 v26, v26, v30
v_mfma_f32_16x16x32_bf16 v[152:155], v[68:71], v[96:99], v[152:155]
ds_read_b64_tr_b16 v[50:51], v22 offset:33792
v_fma_f32 v27, v29, v29, v27
v_mfma_f32_16x16x32_bf16 v[156:159], v[68:71], v[100:103], v[156:159]
ds_read_b64_tr_b16 v[52:53], v23 offset:32768
v_fma_f32 v28, v30, v30, v28
v_mfma_f32_16x16x32_bf16 v[160:163], v[68:71], v[104:107], v[160:163]
ds_read_b64_tr_b16 v[54:55], v23 offset:33792
v_lshlrev_b32 v29, 16, v118
s_add_u32 m0, s42, 49152
s_add_u32 s75, s75, s46
buffer_load_dwordx4 v13, s[16:19], s75 offen sc1 lds
v_mfma_f32_16x16x32_bf16 v[164:167], v[68:71], v[108:111], v[164:167]
ds_read_b64_tr_b16 v[56:57], v24 offset:32768
v_and_b32 v30, s59, v118
v_mfma_f32_16x16x32_bf16 v[208:211], v[68:71], v[36:39], v[208:211]
ds_read_b64_tr_b16 v[58:59], v24 offset:33792
v_add_f32 v25, v25, v29
v_mfma_f32_16x16x32_bf16 v[168:171], v[72:75], v[96:99], v[168:171]
v_add_f32 v26, v26, v30
v_mfma_f32_16x16x32_bf16 v[172:175], v[72:75], v[100:103], v[172:175]
v_fma_f32 v27, v29, v29, v27
v_mfma_f32_16x16x32_bf16 v[176:179], v[72:75], v[104:107], v[176:179]
v_fma_f32 v28, v30, v30, v28
s_add_u32 m0, s42, 57344
s_add_u32 s76, s76, s46
buffer_load_dwordx4 v13, s[20:23], s76 offen sc1 lds
v_mfma_f32_16x16x32_bf16 v[180:183], v[72:75], v[108:111], v[180:183]
v_lshlrev_b32 v29, 16, v119
v_mfma_f32_16x16x32_bf16 v[212:215], v[72:75], v[36:39], v[212:215]
v_and_b32 v30, s59, v119
v_mfma_f32_16x16x32_bf16 v[184:187], v[76:79], v[96:99], v[184:187]
v_add_f32 v25, v25, v29
v_mfma_f32_16x16x32_bf16 v[188:191], v[76:79], v[100:103], v[188:191]
v_add_f32 v26, v26, v30
v_mfma_f32_16x16x32_bf16 v[192:195], v[76:79], v[104:107], v[192:195]
v_fma_f32 v27, v29, v29, v27
v_mfma_f32_16x16x32_bf16 v[196:199], v[76:79], v[108:111], v[196:199]
v_fma_f32 v28, v30, v30, v28
v_mfma_f32_16x16x32_bf16 v[216:219], v[76:79], v[36:39], v[216:219]
s_waitcnt lgkmcnt(0)
s_waitcnt vmcnt(9)
s_barrier
s_cmp_ge_u32 s2, 8
s_cbranch_scc1 parallel_sum__mha_block__geglu_ffn__prompt_kernel_A1_sig
s_cmp_lg_u32 s28, 7
s_cbranch_scc1 parallel_sum__mha_block__geglu_ffn__prompt_kernel_A1_sig
v_mov_b32 v4, s2
v_mov_b32 v5, 1
s_mov_b64 exec, 1
buffer_store_byte v5, v4, s[96:99], 0 offen sc1
s_mov_b64 exec, -1
parallel_sum__mha_block__geglu_ffn__prompt_kernel_A1_sig:
v_mfma_f32_16x16x32_bf16 v[120:123], v[40:43], v[80:83], v[120:123]
ds_read_b128 v[96:99], v15 offset:49152
v_lshlrev_b32 v29, 16, v112
v_and_b32 v30, s59, v112
v_mfma_f32_16x16x32_bf16 v[124:127], v[40:43], v[84:87], v[124:127]
ds_read_b128 v[100:103], v15 offset:51200
v_add_f32 v25, v25, v29
v_mfma_f32_16x16x32_bf16 v[128:131], v[40:43], v[88:91], v[128:131]
ds_read_b128 v[104:107], v15 offset:53248
v_add_f32 v26, v26, v30
s_add_u32 m0, s42, 65536
s_add_u32 s75, s75, s46
buffer_load_dwordx4 v13, s[16:19], s75 offen sc1 lds
v_mfma_f32_16x16x32_bf16 v[132:135], v[40:43], v[92:95], v[132:135]
ds_read_b128 v[108:111], v15 offset:55296
v_fma_f32 v27, v29, v29, v27
v_mfma_f32_16x16x32_bf16 v[136:139], v[44:47], v[80:83], v[136:139]
ds_read_b64_tr_b16 v[60:61], v16 offset:53248
v_fma_f32 v28, v30, v30, v28
v_mfma_f32_16x16x32_bf16 v[140:143], v[44:47], v[84:87], v[140:143]
ds_read_b64_tr_b16 v[62:63], v16 offset:53760
v_lshlrev_b32 v29, 16, v113
v_and_b32 v30, s59, v113
v_mfma_f32_16x16x32_bf16 v[144:147], v[44:47], v[88:91], v[144:147]
ds_read_b128 v[116:119], v32 offset:49152
v_add_f32 v25, v25, v29
s_add_u32 m0, s42, 73728
s_add_u32 s76, s76, s46
buffer_load_dwordx4 v13, s[20:23], s76 offen sc1 lds
v_mfma_f32_16x16x32_bf16 v[148:151], v[44:47], v[92:95], v[148:151]
ds_read_b64_tr_b16 v[64:65], v17 offset:0
v_add_f32 v26, v26, v30
v_mfma_f32_16x16x32_bf16 v[152:155], v[48:51], v[80:83], v[152:155]
ds_read_b64_tr_b16 v[66:67], v17 offset:1024
v_fma_f32 v27, v29, v29, v27
v_mfma_f32_16x16x32_bf16 v[156:159], v[48:51], v[84:87], v[156:159]
ds_read_b64_tr_b16 v[68:69], v18 offset:0
v_fma_f32 v28, v30, v30, v28
v_mfma_f32_16x16x32_bf16 v[160:163], v[48:51], v[88:91], v[160:163]
ds_read_b64_tr_b16 v[70:71], v18 offset:1024
v_lshlrev_b32 v29, 16, v114
v_and_b32 v30, s59, v114
s_add_u32 m0, s40, 24576
s_add_u32 s82, s36, 512
buffer_load_dwordx4 v10, s[8:11], s82 offen sc1 lds
v_mfma_f32_16x16x32_bf16 v[164:167], v[48:51], v[92:95], v[164:167]
ds_read_b64_tr_b16 v[72:73], v19 offset:0
v_add_f32 v25, v25, v29
v_mfma_f32_16x16x32_bf16 v[168:171], v[52:55], v[80:83], v[168:171]
ds_read_b64_tr_b16 v[74:75], v19 offset:1024
v_add_f32 v26, v26, v30
v_mfma_f32_16x16x32_bf16 v[172:175], v[52:55], v[84:87], v[172:175]
ds_read_b64_tr_b16 v[76:77], v20 offset:0
v_fma_f32 v27, v29, v29, v27
v_mfma_f32_16x16x32_bf16 v[176:179], v[52:55], v[88:91], v[176:179]
ds_read_b64_tr_b16 v[78:79], v20 offset:1024
v_fma_f32 v28, v30, v30, v28
s_add_u32 m0, s40, 25600
s_add_u32 s33, s37, 786432
buffer_load_dwordx4 v11, s[8:11], s82 offen sc1 lds
s_add_u32 m0, s41, 24576
s_nop 0
buffer_load_dwordx4 v12, s[12:15], s33 offen sc1 lds
v_mfma_f32_16x16x32_bf16 v[180:183], v[52:55], v[92:95], v[180:183]
v_lshlrev_b32 v29, 16, v115
v_and_b32 v30, s59, v115
v_mfma_f32_16x16x32_bf16 v[184:187], v[56:59], v[80:83], v[184:187]
v_add_f32 v25, v25, v29
v_mfma_f32_16x16x32_bf16 v[188:191], v[56:59], v[84:87], v[188:191]
v_add_f32 v26, v26, v30
v_mfma_f32_16x16x32_bf16 v[192:195], v[56:59], v[88:91], v[192:195]
v_fma_f32 v27, v29, v29, v27
v_mfma_f32_16x16x32_bf16 v[196:199], v[56:59], v[92:95], v[196:199]
v_fma_f32 v28, v30, v30, v28
s_waitcnt lgkmcnt(0)
s_waitcnt vmcnt(12)
s_waitcnt vmcnt(9)
s_barrier
v_mfma_f32_16x16x32_bf16 v[120:123], v[60:63], v[96:99], v[120:123]
ds_read_b128 v[80:83], v14 offset:0
v_lshlrev_b32 v29, 16, v116
v_mfma_f32_16x16x32_bf16 v[124:127], v[60:63], v[100:103], v[124:127]
ds_read_b128 v[84:87], v14 offset:2048
v_and_b32 v30, s59, v116
v_mfma_f32_16x16x32_bf16 v[128:131], v[60:63], v[104:107], v[128:131]
ds_read_b128 v[88:91], v14 offset:4096
v_add_f32 v25, v25, v29
s_add_u32 m0, s42, 0
s_add_u32 s75, s75, s46
buffer_load_dwordx4 v13, s[16:19], s75 offen sc1 lds
v_mfma_f32_16x16x32_bf16 v[132:135], v[60:63], v[108:111], v[132:135]
ds_read_b128 v[92:95], v14 offset:6144
v_add_f32 v26, v26, v30
v_mfma_f32_16x16x32_bf16 v[200:203], v[60:63], v[36:39], v[200:203]
ds_read_b64_tr_b16 v[40:41], v16 offset:0
v_fma_f32 v27, v29, v29, v27
v_mfma_f32_16x16x32_bf16 v[136:139], v[64:67], v[96:99], v[136:139]
ds_read_b64_tr_b16 v[42:43], v16 offset:512
v_fma_f32 v28, v30, v30, v28
v_mfma_f32_16x16x32_bf16 v[140:143], v[64:67], v[100:103], v[140:143]
ds_read_b128 v[112:115], v31 offset:0
v_lshlrev_b32 v29, 16, v117
v_mfma_f32_16x16x32_bf16 v[144:147], v[64:67], v[104:107], v[144:147]
ds_read_b64_tr_b16 v[44:45], v17 offset:16384
v_and_b32 v30, s59, v117
v_mfma_f32_16x16x32_bf16 v[148:151], v[64:67], v[108:111], v[148:151]
ds_read_b64_tr_b16 v[46:47], v17 offset:17408
v_add_f32 v25, v25, v29
v_mfma_f32_16x16x32_bf16 v[204:207], v[64:67], v[36:39], v[204:207]
ds_read_b64_tr_b16 v[48:49], v18 offset:16384
v_add_f32 v26, v26, v30
v_mfma_f32_16x16x32_bf16 v[152:155], v[68:71], v[96:99], v[152:155]
ds_read_b64_tr_b16 v[50:51], v18 offset:17408
v_fma_f32 v27, v29, v29, v27
v_mfma_f32_16x16x32_bf16 v[156:159], v[68:71], v[100:103], v[156:159]
ds_read_b64_tr_b16 v[52:53], v19 offset:16384
v_fma_f32 v28, v30, v30, v28
v_mfma_f32_16x16x32_bf16 v[160:163], v[68:71], v[104:107], v[160:163]
ds_read_b64_tr_b16 v[54:55], v19 offset:17408
v_lshlrev_b32 v29, 16, v118
v_mfma_f32_16x16x32_bf16 v[164:167], v[68:71], v[108:111], v[164:167]
ds_read_b64_tr_b16 v[56:57], v20 offset:16384
v_and_b32 v30, s59, v118
s_add_u32 m0, s42, 8192
s_add_u32 s76, s76, s46
buffer_load_dwordx4 v13, s[20:23], s76 offen sc1 lds
v_mfma_f32_16x16x32_bf16 v[208:211], v[68:71], v[36:39], v[208:211]
ds_read_b64_tr_b16 v[58:59], v20 offset:17408
v_add_f32 v25, v25, v29
v_mfma_f32_16x16x32_bf16 v[168:171], v[72:75], v[96:99], v[168:171]
v_add_f32 v26, v26, v30
v_mfma_f32_16x16x32_bf16 v[172:175], v[72:75], v[100:103], v[172:175]
v_fma_f32 v27, v29, v29, v27
v_mfma_f32_16x16x32_bf16 v[176:179], v[72:75], v[104:107], v[176:179]
v_fma_f32 v28, v30, v30, v28
v_mfma_f32_16x16x32_bf16 v[180:183], v[72:75], v[108:111], v[180:183]
v_lshlrev_b32 v29, 16, v119
v_mfma_f32_16x16x32_bf16 v[212:215], v[72:75], v[36:39], v[212:215]
v_and_b32 v30, s59, v119
v_mfma_f32_16x16x32_bf16 v[184:187], v[76:79], v[96:99], v[184:187]
v_add_f32 v25, v25, v29
v_mfma_f32_16x16x32_bf16 v[188:191], v[76:79], v[100:103], v[188:191]
v_add_f32 v26, v26, v30
v_mfma_f32_16x16x32_bf16 v[192:195], v[76:79], v[104:107], v[192:195]
v_fma_f32 v27, v29, v29, v27
v_mfma_f32_16x16x32_bf16 v[196:199], v[76:79], v[108:111], v[196:199]
v_fma_f32 v28, v30, v30, v28
v_mfma_f32_16x16x32_bf16 v[216:219], v[76:79], v[36:39], v[216:219]
s_waitcnt lgkmcnt(0)
s_waitcnt vmcnt(9)
s_barrier
v_mfma_f32_16x16x32_bf16 v[120:123], v[40:43], v[80:83], v[120:123]
ds_read_b128 v[96:99], v15 offset:0
v_lshlrev_b32 v29, 16, v112
v_and_b32 v30, s59, v112
v_mfma_f32_16x16x32_bf16 v[124:127], v[40:43], v[84:87], v[124:127]
ds_read_b128 v[100:103], v15 offset:2048
v_add_f32 v25, v25, v29
v_mfma_f32_16x16x32_bf16 v[128:131], v[40:43], v[88:91], v[128:131]
ds_read_b128 v[104:107], v15 offset:4096
v_add_f32 v26, v26, v30
s_add_u32 m0, s42, 16384
s_add_u32 s75, s75, s46
buffer_load_dwordx4 v13, s[16:19], s75 offen sc1 lds
v_mfma_f32_16x16x32_bf16 v[132:135], v[40:43], v[92:95], v[132:135]
ds_read_b128 v[108:111], v15 offset:6144
v_fma_f32 v27, v29, v29, v27
v_mfma_f32_16x16x32_bf16 v[136:139], v[44:47], v[80:83], v[136:139]
ds_read_b64_tr_b16 v[60:61], v16 offset:4096
v_fma_f32 v28, v30, v30, v28
v_mfma_f32_16x16x32_bf16 v[140:143], v[44:47], v[84:87], v[140:143]
ds_read_b64_tr_b16 v[62:63], v16 offset:4608
v_lshlrev_b32 v29, 16, v113
v_and_b32 v30, s59, v113
v_mfma_f32_16x16x32_bf16 v[144:147], v[44:47], v[88:91], v[144:147]
ds_read_b128 v[116:119], v32 offset:0
v_add_f32 v25, v25, v29
s_add_u32 m0, s42, 24576
s_add_u32 s76, s76, s46
buffer_load_dwordx4 v13, s[20:23], s76 offen sc1 lds
v_mfma_f32_16x16x32_bf16 v[148:151], v[44:47], v[92:95], v[148:151]
ds_read_b64_tr_b16 v[64:65], v21 offset:0
v_add_f32 v26, v26, v30
v_mfma_f32_16x16x32_bf16 v[152:155], v[48:51], v[80:83], v[152:155]
ds_read_b64_tr_b16 v[66:67], v21 offset:1024
v_fma_f32 v27, v29, v29, v27
v_mfma_f32_16x16x32_bf16 v[156:159], v[48:51], v[84:87], v[156:159]
ds_read_b64_tr_b16 v[68:69], v22 offset:0
v_fma_f32 v28, v30, v30, v28
v_mfma_f32_16x16x32_bf16 v[160:163], v[48:51], v[88:91], v[160:163]
ds_read_b64_tr_b16 v[70:71], v22 offset:1024
v_lshlrev_b32 v29, 16, v114
v_and_b32 v30, s59, v114
s_add_u32 m0, s40, 49152
s_add_u32 s82, s36, 640
buffer_load_dwordx4 v10, s[8:11], s82 offen sc1 lds
v_mfma_f32_16x16x32_bf16 v[164:167], v[48:51], v[92:95], v[164:167]
ds_read_b64_tr_b16 v[72:73], v23 offset:0
v_add_f32 v25, v25, v29
v_mfma_f32_16x16x32_bf16 v[168:171], v[52:55], v[80:83], v[168:171]
ds_read_b64_tr_b16 v[74:75], v23 offset:1024
v_add_f32 v26, v26, v30
v_mfma_f32_16x16x32_bf16 v[172:175], v[52:55], v[84:87], v[172:175]
ds_read_b64_tr_b16 v[76:77], v24 offset:0
v_fma_f32 v27, v29, v29, v27
v_mfma_f32_16x16x32_bf16 v[176:179], v[52:55], v[88:91], v[176:179]
ds_read_b64_tr_b16 v[78:79], v24 offset:1024
v_fma_f32 v28, v30, v30, v28
s_add_u32 m0, s40, 50176
s_add_u32 s33, s37, 983040
buffer_load_dwordx4 v11, s[8:11], s82 offen sc1 lds
s_add_u32 m0, s41, 49152
s_nop 0
buffer_load_dwordx4 v12, s[12:15], s33 offen sc1 lds
v_mfma_f32_16x16x32_bf16 v[180:183], v[52:55], v[92:95], v[180:183]
v_lshlrev_b32 v29, 16, v115
v_and_b32 v30, s59, v115
v_mfma_f32_16x16x32_bf16 v[184:187], v[56:59], v[80:83], v[184:187]
v_add_f32 v25, v25, v29
v_mfma_f32_16x16x32_bf16 v[188:191], v[56:59], v[84:87], v[188:191]
v_add_f32 v26, v26, v30
v_mfma_f32_16x16x32_bf16 v[192:195], v[56:59], v[88:91], v[192:195]
v_fma_f32 v27, v29, v29, v27
v_mfma_f32_16x16x32_bf16 v[196:199], v[56:59], v[92:95], v[196:199]
v_fma_f32 v28, v30, v30, v28
s_waitcnt lgkmcnt(0)
s_waitcnt vmcnt(12)
s_waitcnt vmcnt(7)
s_barrier
v_mfma_f32_16x16x32_bf16 v[120:123], v[60:63], v[96:99], v[120:123]
ds_read_b128 v[80:83], v14 offset:24576
v_lshlrev_b32 v29, 16, v116
v_mfma_f32_16x16x32_bf16 v[124:127], v[60:63], v[100:103], v[124:127]
ds_read_b128 v[84:87], v14 offset:26624
v_and_b32 v30, s59, v116
v_mfma_f32_16x16x32_bf16 v[128:131], v[60:63], v[104:107], v[128:131]
ds_read_b128 v[88:91], v14 offset:28672
v_add_f32 v25, v25, v29
s_add_u32 m0, s42, 32768
s_add_u32 s75, s75, s46
buffer_load_dwordx4 v13, s[16:19], s75 offen sc1 lds
v_mfma_f32_16x16x32_bf16 v[132:135], v[60:63], v[108:111], v[132:135]
ds_read_b128 v[92:95], v14 offset:30720
v_add_f32 v26, v26, v30
v_mfma_f32_16x16x32_bf16 v[200:203], v[60:63], v[36:39], v[200:203]
ds_read_b64_tr_b16 v[40:41], v16 offset:24576
v_fma_f32 v27, v29, v29, v27
v_mfma_f32_16x16x32_bf16 v[136:139], v[64:67], v[96:99], v[136:139]
ds_read_b64_tr_b16 v[42:43], v16 offset:25088
v_fma_f32 v28, v30, v30, v28
v_mfma_f32_16x16x32_bf16 v[140:143], v[64:67], v[100:103], v[140:143]
ds_read_b128 v[112:115], v31 offset:24576
v_lshlrev_b32 v29, 16, v117
v_mfma_f32_16x16x32_bf16 v[144:147], v[64:67], v[104:107], v[144:147]
ds_read_b64_tr_b16 v[44:45], v21 offset:16384
v_and_b32 v30, s59, v117
v_mfma_f32_16x16x32_bf16 v[148:151], v[64:67], v[108:111], v[148:151]
ds_read_b64_tr_b16 v[46:47], v21 offset:17408
v_add_f32 v25, v25, v29
v_mfma_f32_16x16x32_bf16 v[204:207], v[64:67], v[36:39], v[204:207]
ds_read_b64_tr_b16 v[48:49], v22 offset:16384
v_add_f32 v26, v26, v30
v_mfma_f32_16x16x32_bf16 v[152:155], v[68:71], v[96:99], v[152:155]
ds_read_b64_tr_b16 v[50:51], v22 offset:17408
v_fma_f32 v27, v29, v29, v27
v_mfma_f32_16x16x32_bf16 v[156:159], v[68:71], v[100:103], v[156:159]
ds_read_b64_tr_b16 v[52:53], v23 offset:16384
v_fma_f32 v28, v30, v30, v28
v_mfma_f32_16x16x32_bf16 v[160:163], v[68:71], v[104:107], v[160:163]
ds_read_b64_tr_b16 v[54:55], v23 offset:17408
v_lshlrev_b32 v29, 16, v118
v_mfma_f32_16x16x32_bf16 v[164:167], v[68:71], v[108:111], v[164:167]
ds_read_b64_tr_b16 v[56:57], v24 offset:16384
v_and_b32 v30, s59, v118
s_add_u32 m0, s42, 40960
s_add_u32 s76, s76, s46
buffer_load_dwordx4 v13, s[20:23], s76 offen sc1 lds
v_mfma_f32_16x16x32_bf16 v[208:211], v[68:71], v[36:39], v[208:211]
ds_read_b64_tr_b16 v[58:59], v24 offset:17408
v_add_f32 v25, v25, v29
v_mfma_f32_16x16x32_bf16 v[168:171], v[72:75], v[96:99], v[168:171]
v_add_f32 v26, v26, v30
v_mfma_f32_16x16x32_bf16 v[172:175], v[72:75], v[100:103], v[172:175]
v_fma_f32 v27, v29, v29, v27
v_mfma_f32_16x16x32_bf16 v[176:179], v[72:75], v[104:107], v[176:179]
v_fma_f32 v28, v30, v30, v28
v_mfma_f32_16x16x32_bf16 v[180:183], v[72:75], v[108:111], v[180:183]
v_lshlrev_b32 v29, 16, v119
v_mfma_f32_16x16x32_bf16 v[212:215], v[72:75], v[36:39], v[212:215]
v_and_b32 v30, s59, v119
v_mfma_f32_16x16x32_bf16 v[184:187], v[76:79], v[96:99], v[184:187]
v_add_f32 v25, v25, v29
v_mfma_f32_16x16x32_bf16 v[188:191], v[76:79], v[100:103], v[188:191]
v_add_f32 v26, v26, v30
v_mfma_f32_16x16x32_bf16 v[192:195], v[76:79], v[104:107], v[192:195]
v_fma_f32 v27, v29, v29, v27
v_mfma_f32_16x16x32_bf16 v[196:199], v[76:79], v[108:111], v[196:199]
v_fma_f32 v28, v30, v30, v28
v_mfma_f32_16x16x32_bf16 v[216:219], v[76:79], v[36:39], v[216:219]
s_waitcnt lgkmcnt(0)
s_barrier
v_mfma_f32_16x16x32_bf16 v[120:123], v[40:43], v[80:83], v[120:123]
ds_read_b128 v[96:99], v15 offset:24576
v_lshlrev_b32 v29, 16, v112
v_and_b32 v30, s59, v112
v_mfma_f32_16x16x32_bf16 v[124:127], v[40:43], v[84:87], v[124:127]
ds_read_b128 v[100:103], v15 offset:26624
v_add_f32 v25, v25, v29
v_mfma_f32_16x16x32_bf16 v[128:131], v[40:43], v[88:91], v[128:131]
ds_read_b128 v[104:107], v15 offset:28672
v_add_f32 v26, v26, v30
s_add_u32 m0, s42, 49152
s_add_u32 s75, s75, s46
buffer_load_dwordx4 v13, s[16:19], s75 offen sc1 lds
v_mfma_f32_16x16x32_bf16 v[132:135], v[40:43], v[92:95], v[132:135]
ds_read_b128 v[108:111], v15 offset:30720
v_fma_f32 v27, v29, v29, v27
v_mfma_f32_16x16x32_bf16 v[136:139], v[44:47], v[80:83], v[136:139]
ds_read_b64_tr_b16 v[60:61], v16 offset:28672
v_fma_f32 v28, v30, v30, v28
v_mfma_f32_16x16x32_bf16 v[140:143], v[44:47], v[84:87], v[140:143]
ds_read_b64_tr_b16 v[62:63], v16 offset:29184
v_lshlrev_b32 v29, 16, v113
v_and_b32 v30, s59, v113
v_mfma_f32_16x16x32_bf16 v[144:147], v[44:47], v[88:91], v[144:147]
ds_read_b128 v[116:119], v32 offset:24576
v_add_f32 v25, v25, v29
s_add_u32 m0, s42, 57344
s_add_u32 s76, s76, s46
buffer_load_dwordx4 v13, s[20:23], s76 offen sc1 lds
v_mfma_f32_16x16x32_bf16 v[148:151], v[44:47], v[92:95], v[148:151]
ds_read_b64_tr_b16 v[64:65], v21 offset:32768
v_add_f32 v26, v26, v30
v_mfma_f32_16x16x32_bf16 v[152:155], v[48:51], v[80:83], v[152:155]
ds_read_b64_tr_b16 v[66:67], v21 offset:33792
v_fma_f32 v27, v29, v29, v27
v_mfma_f32_16x16x32_bf16 v[156:159], v[48:51], v[84:87], v[156:159]
ds_read_b64_tr_b16 v[68:69], v22 offset:32768
v_fma_f32 v28, v30, v30, v28
v_mfma_f32_16x16x32_bf16 v[160:163], v[48:51], v[88:91], v[160:163]
ds_read_b64_tr_b16 v[70:71], v22 offset:33792
v_lshlrev_b32 v29, 16, v114
v_and_b32 v30, s59, v114
s_add_u32 m0, s40, 0
s_add_u32 s82, s36, 768
buffer_load_dwordx4 v10, s[8:11], s82 offen sc1 lds
v_mfma_f32_16x16x32_bf16 v[164:167], v[48:51], v[92:95], v[164:167]
ds_read_b64_tr_b16 v[72:73], v23 offset:32768
v_add_f32 v25, v25, v29
v_mfma_f32_16x16x32_bf16 v[168:171], v[52:55], v[80:83], v[168:171]
ds_read_b64_tr_b16 v[74:75], v23 offset:33792
v_add_f32 v26, v26, v30
v_mfma_f32_16x16x32_bf16 v[172:175], v[52:55], v[84:87], v[172:175]
ds_read_b64_tr_b16 v[76:77], v24 offset:32768
v_fma_f32 v27, v29, v29, v27
v_mfma_f32_16x16x32_bf16 v[176:179], v[52:55], v[88:91], v[176:179]
ds_read_b64_tr_b16 v[78:79], v24 offset:33792
v_fma_f32 v28, v30, v30, v28
s_add_u32 m0, s40, 1024
s_add_u32 s33, s37, 1179648
buffer_load_dwordx4 v11, s[8:11], s82 offen sc1 lds
s_add_u32 m0, s41, 0
s_nop 0
buffer_load_dwordx4 v12, s[12:15], s33 offen sc1 lds
v_mfma_f32_16x16x32_bf16 v[180:183], v[52:55], v[92:95], v[180:183]
v_lshlrev_b32 v29, 16, v115
v_and_b32 v30, s59, v115
v_mfma_f32_16x16x32_bf16 v[184:187], v[56:59], v[80:83], v[184:187]
v_add_f32 v25, v25, v29
v_mfma_f32_16x16x32_bf16 v[188:191], v[56:59], v[84:87], v[188:191]
v_add_f32 v26, v26, v30
v_mfma_f32_16x16x32_bf16 v[192:195], v[56:59], v[88:91], v[192:195]
v_fma_f32 v27, v29, v29, v27
v_mfma_f32_16x16x32_bf16 v[196:199], v[56:59], v[92:95], v[196:199]
v_fma_f32 v28, v30, v30, v28
s_waitcnt lgkmcnt(0)
s_waitcnt vmcnt(12)
s_waitcnt vmcnt(7)
s_barrier
v_mfma_f32_16x16x32_bf16 v[120:123], v[60:63], v[96:99], v[120:123]
ds_read_b128 v[80:83], v14 offset:49152
v_lshlrev_b32 v29, 16, v116
v_mfma_f32_16x16x32_bf16 v[124:127], v[60:63], v[100:103], v[124:127]
ds_read_b128 v[84:87], v14 offset:51200
v_and_b32 v30, s59, v116
v_mfma_f32_16x16x32_bf16 v[128:131], v[60:63], v[104:107], v[128:131]
ds_read_b128 v[88:91], v14 offset:53248
v_add_f32 v25, v25, v29
s_add_u32 m0, s42, 65536
s_add_u32 s75, s75, s46
buffer_load_dwordx4 v13, s[16:19], s75 offen sc1 lds
v_mfma_f32_16x16x32_bf16 v[132:135], v[60:63], v[108:111], v[132:135]
ds_read_b128 v[92:95], v14 offset:55296
v_add_f32 v26, v26, v30
v_mfma_f32_16x16x32_bf16 v[200:203], v[60:63], v[36:39], v[200:203]
ds_read_b64_tr_b16 v[40:41], v16 offset:49152
v_fma_f32 v27, v29, v29, v27
v_mfma_f32_16x16x32_bf16 v[136:139], v[64:67], v[96:99], v[136:139]
ds_read_b64_tr_b16 v[42:43], v16 offset:49664
v_fma_f32 v28, v30, v30, v28
v_mfma_f32_16x16x32_bf16 v[140:143], v[64:67], v[100:103], v[140:143]
ds_read_b128 v[112:115], v31 offset:49152
v_lshlrev_b32 v29, 16, v117
v_mfma_f32_16x16x32_bf16 v[144:147], v[64:67], v[104:107], v[144:147]
ds_read_b64_tr_b16 v[44:45], v17 offset:0
v_and_b32 v30, s59, v117
v_mfma_f32_16x16x32_bf16 v[148:151], v[64:67], v[108:111], v[148:151]
ds_read_b64_tr_b16 v[46:47], v17 offset:1024
v_add_f32 v25, v25, v29
v_mfma_f32_16x16x32_bf16 v[204:207], v[64:67], v[36:39], v[204:207]
ds_read_b64_tr_b16 v[48:49], v18 offset:0
v_add_f32 v26, v26, v30
v_mfma_f32_16x16x32_bf16 v[152:155], v[68:71], v[96:99], v[152:155]
ds_read_b64_tr_b16 v[50:51], v18 offset:1024
v_fma_f32 v27, v29, v29, v27
v_mfma_f32_16x16x32_bf16 v[156:159], v[68:71], v[100:103], v[156:159]
ds_read_b64_tr_b16 v[52:53], v19 offset:0
v_fma_f32 v28, v30, v30, v28
v_mfma_f32_16x16x32_bf16 v[160:163], v[68:71], v[104:107], v[160:163]
ds_read_b64_tr_b16 v[54:55], v19 offset:1024
v_lshlrev_b32 v29, 16, v118
v_mfma_f32_16x16x32_bf16 v[164:167], v[68:71], v[108:111], v[164:167]
ds_read_b64_tr_b16 v[56:57], v20 offset:0
v_and_b32 v30, s59, v118
s_add_u32 m0, s42, 73728
s_add_u32 s76, s76, s46
buffer_load_dwordx4 v13, s[20:23], s76 offen sc1 lds
v_mfma_f32_16x16x32_bf16 v[208:211], v[68:71], v[36:39], v[208:211]
ds_read_b64_tr_b16 v[58:59], v20 offset:1024
v_add_f32 v25, v25, v29
v_mfma_f32_16x16x32_bf16 v[168:171], v[72:75], v[96:99], v[168:171]
v_add_f32 v26, v26, v30
v_mfma_f32_16x16x32_bf16 v[172:175], v[72:75], v[100:103], v[172:175]
v_fma_f32 v27, v29, v29, v27
v_mfma_f32_16x16x32_bf16 v[176:179], v[72:75], v[104:107], v[176:179]
v_fma_f32 v28, v30, v30, v28
v_mfma_f32_16x16x32_bf16 v[180:183], v[72:75], v[108:111], v[180:183]
v_lshlrev_b32 v29, 16, v119
v_mfma_f32_16x16x32_bf16 v[212:215], v[72:75], v[36:39], v[212:215]
v_and_b32 v30, s59, v119
v_mfma_f32_16x16x32_bf16 v[184:187], v[76:79], v[96:99], v[184:187]
v_add_f32 v25, v25, v29
v_mfma_f32_16x16x32_bf16 v[188:191], v[76:79], v[100:103], v[188:191]
v_add_f32 v26, v26, v30
v_mfma_f32_16x16x32_bf16 v[192:195], v[76:79], v[104:107], v[192:195]
v_fma_f32 v27, v29, v29, v27
v_mfma_f32_16x16x32_bf16 v[196:199], v[76:79], v[108:111], v[196:199]
v_fma_f32 v28, v30, v30, v28
v_mfma_f32_16x16x32_bf16 v[216:219], v[76:79], v[36:39], v[216:219]
s_waitcnt lgkmcnt(0)
s_barrier
v_lshlrev_b32 v8, 2, v1
s_mov_b64 exec, 3
buffer_load_dword v9, v8, s[96:99], 0 offen sc1
s_mov_b64 exec, -1
v_mfma_f32_16x16x32_bf16 v[120:123], v[40:43], v[80:83], v[120:123]
ds_read_b128 v[96:99], v15 offset:49152
v_lshlrev_b32 v29, 16, v112
v_and_b32 v30, s59, v112
v_mfma_f32_16x16x32_bf16 v[124:127], v[40:43], v[84:87], v[124:127]
ds_read_b128 v[100:103], v15 offset:51200
v_add_f32 v25, v25, v29
v_mfma_f32_16x16x32_bf16 v[128:131], v[40:43], v[88:91], v[128:131]
ds_read_b128 v[104:107], v15 offset:53248
v_add_f32 v26, v26, v30
s_add_u32 m0, s42, 0
s_add_u32 s75, s75, s46
buffer_load_dwordx4 v13, s[16:19], s75 offen sc1 lds
v_mfma_f32_16x16x32_bf16 v[132:135], v[40:43], v[92:95], v[132:135]
ds_read_b128 v[108:111], v15 offset:55296
v_fma_f32 v27, v29, v29, v27
v_mfma_f32_16x16x32_bf16 v[136:139], v[44:47], v[80:83], v[136:139]
ds_read_b64_tr_b16 v[60:61], v16 offset:53248
v_fma_f32 v28, v30, v30, v28
v_mfma_f32_16x16x32_bf16 v[140:143], v[44:47], v[84:87], v[140:143]
ds_read_b64_tr_b16 v[62:63], v16 offset:53760
v_lshlrev_b32 v29, 16, v113
v_and_b32 v30, s59, v113
v_mfma_f32_16x16x32_bf16 v[144:147], v[44:47], v[88:91], v[144:147]
ds_read_b128 v[116:119], v32 offset:49152
v_add_f32 v25, v25, v29
s_add_u32 m0, s42, 8192
s_add_u32 s76, s76, s46
buffer_load_dwordx4 v13, s[20:23], s76 offen sc1 lds
v_mfma_f32_16x16x32_bf16 v[148:151], v[44:47], v[92:95], v[148:151]
ds_read_b64_tr_b16 v[64:65], v17 offset:16384
v_add_f32 v26, v26, v30
v_mfma_f32_16x16x32_bf16 v[152:155], v[48:51], v[80:83], v[152:155]
ds_read_b64_tr_b16 v[66:67], v17 offset:17408
v_fma_f32 v27, v29, v29, v27
v_mfma_f32_16x16x32_bf16 v[156:159], v[48:51], v[84:87], v[156:159]
ds_read_b64_tr_b16 v[68:69], v18 offset:16384
v_fma_f32 v28, v30, v30, v28
v_mfma_f32_16x16x32_bf16 v[160:163], v[48:51], v[88:91], v[160:163]
ds_read_b64_tr_b16 v[70:71], v18 offset:17408
v_lshlrev_b32 v29, 16, v114
v_and_b32 v30, s59, v114
s_add_u32 m0, s40, 24576
s_add_u32 s82, s36, 896
buffer_load_dwordx4 v10, s[8:11], s82 offen sc1 lds
v_mfma_f32_16x16x32_bf16 v[164:167], v[48:51], v[92:95], v[164:167]
ds_read_b64_tr_b16 v[72:73], v19 offset:16384
v_add_f32 v25, v25, v29
v_mfma_f32_16x16x32_bf16 v[168:171], v[52:55], v[80:83], v[168:171]
ds_read_b64_tr_b16 v[74:75], v19 offset:17408
v_add_f32 v26, v26, v30
v_mfma_f32_16x16x32_bf16 v[172:175], v[52:55], v[84:87], v[172:175]
ds_read_b64_tr_b16 v[76:77], v20 offset:16384
v_fma_f32 v27, v29, v29, v27
v_mfma_f32_16x16x32_bf16 v[176:179], v[52:55], v[88:91], v[176:179]
ds_read_b64_tr_b16 v[78:79], v20 offset:17408
v_fma_f32 v28, v30, v30, v28
s_add_u32 m0, s40, 25600
s_add_u32 s33, s37, 1376256
buffer_load_dwordx4 v11, s[8:11], s82 offen sc1 lds
s_add_u32 m0, s41, 24576
s_nop 0
buffer_load_dwordx4 v12, s[12:15], s33 offen sc1 lds
v_mfma_f32_16x16x32_bf16 v[180:183], v[52:55], v[92:95], v[180:183]
v_lshlrev_b32 v29, 16, v115
v_and_b32 v30, s59, v115
v_mfma_f32_16x16x32_bf16 v[184:187], v[56:59], v[80:83], v[184:187]
v_add_f32 v25, v25, v29
v_mfma_f32_16x16x32_bf16 v[188:191], v[56:59], v[84:87], v[188:191]
v_add_f32 v26, v26, v30
v_mfma_f32_16x16x32_bf16 v[192:195], v[56:59], v[88:91], v[192:195]
v_fma_f32 v27, v29, v29, v27
v_mfma_f32_16x16x32_bf16 v[196:199], v[56:59], v[92:95], v[196:199]
v_fma_f32 v28, v30, v30, v28
s_waitcnt lgkmcnt(0)
s_waitcnt vmcnt(13)
s_waitcnt vmcnt(8)
s_barrier
v_mfma_f32_16x16x32_bf16 v[120:123], v[60:63], v[96:99], v[120:123]
ds_read_b128 v[80:83], v14 offset:0
v_lshlrev_b32 v29, 16, v116
v_mfma_f32_16x16x32_bf16 v[124:127], v[60:63], v[100:103], v[124:127]
ds_read_b128 v[84:87], v14 offset:2048
v_and_b32 v30, s59, v116
v_mfma_f32_16x16x32_bf16 v[128:131], v[60:63], v[104:107], v[128:131]
ds_read_b128 v[88:91], v14 offset:4096
v_add_f32 v25, v25, v29
v_mfma_f32_16x16x32_bf16 v[132:135], v[60:63], v[108:111], v[132:135]
ds_read_b128 v[92:95], v14 offset:6144
v_add_f32 v26, v26, v30
v_mfma_f32_16x16x32_bf16 v[200:203], v[60:63], v[36:39], v[200:203]
ds_read_b64_tr_b16 v[40:41], v16 offset:0
v_fma_f32 v27, v29, v29, v27
v_mfma_f32_16x16x32_bf16 v[136:139], v[64:67], v[96:99], v[136:139]
ds_read_b64_tr_b16 v[42:43], v16 offset:512
v_fma_f32 v28, v30, v30, v28
v_mfma_f32_16x16x32_bf16 v[140:143], v[64:67], v[100:103], v[140:143]
ds_read_b128 v[112:115], v31 offset:0
v_lshlrev_b32 v29, 16, v117
v_mfma_f32_16x16x32_bf16 v[144:147], v[64:67], v[104:107], v[144:147]
ds_read_b64_tr_b16 v[44:45], v21 offset:0
v_and_b32 v30, s59, v117
v_mfma_f32_16x16x32_bf16 v[148:151], v[64:67], v[108:111], v[148:151]
ds_read_b64_tr_b16 v[46:47], v21 offset:1024
v_add_f32 v25, v25, v29
v_mfma_f32_16x16x32_bf16 v[204:207], v[64:67], v[36:39], v[204:207]
ds_read_b64_tr_b16 v[48:49], v22 offset:0
v_add_f32 v26, v26, v30
v_mfma_f32_16x16x32_bf16 v[152:155], v[68:71], v[96:99], v[152:155]
ds_read_b64_tr_b16 v[50:51], v22 offset:1024
v_fma_f32 v27, v29, v29, v27
v_mfma_f32_16x16x32_bf16 v[156:159], v[68:71], v[100:103], v[156:159]
ds_read_b64_tr_b16 v[52:53], v23 offset:0
v_fma_f32 v28, v30, v30, v28
v_mfma_f32_16x16x32_bf16 v[160:163], v[68:71], v[104:107], v[160:163]
ds_read_b64_tr_b16 v[54:55], v23 offset:1024
v_lshlrev_b32 v29, 16, v118
v_mfma_f32_16x16x32_bf16 v[164:167], v[68:71], v[108:111], v[164:167]
ds_read_b64_tr_b16 v[56:57], v24 offset:0
v_and_b32 v30, s59, v118
v_mfma_f32_16x16x32_bf16 v[208:211], v[68:71], v[36:39], v[208:211]
ds_read_b64_tr_b16 v[58:59], v24 offset:1024
v_add_f32 v25, v25, v29
v_mfma_f32_16x16x32_bf16 v[168:171], v[72:75], v[96:99], v[168:171]
v_add_f32 v26, v26, v30
v_mfma_f32_16x16x32_bf16 v[172:175], v[72:75], v[100:103], v[172:175]
v_fma_f32 v27, v29, v29, v27
v_mfma_f32_16x16x32_bf16 v[176:179], v[72:75], v[104:107], v[176:179]
v_fma_f32 v28, v30, v30, v28
v_mfma_f32_16x16x32_bf16 v[180:183], v[72:75], v[108:111], v[180:183]
v_lshlrev_b32 v29, 16, v119
v_mfma_f32_16x16x32_bf16 v[212:215], v[72:75], v[36:39], v[212:215]
v_and_b32 v30, s59, v119
v_mfma_f32_16x16x32_bf16 v[184:187], v[76:79], v[96:99], v[184:187]
v_add_f32 v25, v25, v29
v_mfma_f32_16x16x32_bf16 v[188:191], v[76:79], v[100:103], v[188:191]
v_add_f32 v26, v26, v30
v_mfma_f32_16x16x32_bf16 v[192:195], v[76:79], v[104:107], v[192:195]
v_fma_f32 v27, v29, v29, v27
v_mfma_f32_16x16x32_bf16 v[196:199], v[76:79], v[108:111], v[196:199]
v_fma_f32 v28, v30, v30, v28
v_mfma_f32_16x16x32_bf16 v[216:219], v[76:79], v[36:39], v[216:219]
s_waitcnt lgkmcnt(0)
s_barrier
v_mfma_f32_16x16x32_bf16 v[120:123], v[40:43], v[80:83], v[120:123]
ds_read_b128 v[96:99], v15 offset:0
v_lshlrev_b32 v29, 16, v112
v_and_b32 v30, s59, v112
v_mfma_f32_16x16x32_bf16 v[124:127], v[40:43], v[84:87], v[124:127]
ds_read_b128 v[100:103], v15 offset:2048
v_add_f32 v25, v25, v29
v_mfma_f32_16x16x32_bf16 v[128:131], v[40:43], v[88:91], v[128:131]
ds_read_b128 v[104:107], v15 offset:4096
v_add_f32 v26, v26, v30
v_mfma_f32_16x16x32_bf16 v[132:135], v[40:43], v[92:95], v[132:135]
ds_read_b128 v[108:111], v15 offset:6144
v_fma_f32 v27, v29, v29, v27
v_mfma_f32_16x16x32_bf16 v[136:139], v[44:47], v[80:83], v[136:139]
ds_read_b64_tr_b16 v[60:61], v16 offset:4096
v_fma_f32 v28, v30, v30, v28
v_mfma_f32_16x16x32_bf16 v[140:143], v[44:47], v[84:87], v[140:143]
ds_read_b64_tr_b16 v[62:63], v16 offset:4608
v_lshlrev_b32 v29, 16, v113
v_and_b32 v30, s59, v113
v_mfma_f32_16x16x32_bf16 v[144:147], v[44:47], v[88:91], v[144:147]
ds_read_b128 v[116:119], v32 offset:0
v_add_f32 v25, v25, v29
v_mfma_f32_16x16x32_bf16 v[148:151], v[44:47], v[92:95], v[148:151]
ds_read_b64_tr_b16 v[64:65], v21 offset:16384
v_add_f32 v26, v26, v30
v_mfma_f32_16x16x32_bf16 v[152:155], v[48:51], v[80:83], v[152:155]
ds_read_b64_tr_b16 v[66:67], v21 offset:17408
v_fma_f32 v27, v29, v29, v27
v_mfma_f32_16x16x32_bf16 v[156:159], v[48:51], v[84:87], v[156:159]
ds_read_b64_tr_b16 v[68:69], v22 offset:16384
v_fma_f32 v28, v30, v30, v28
v_mfma_f32_16x16x32_bf16 v[160:163], v[48:51], v[88:91], v[160:163]
ds_read_b64_tr_b16 v[70:71], v22 offset:17408
v_lshlrev_b32 v29, 16, v114
v_and_b32 v30, s59, v114
v_mfma_f32_16x16x32_bf16 v[164:167], v[48:51], v[92:95], v[164:167]
ds_read_b64_tr_b16 v[72:73], v23 offset:16384
v_add_f32 v25, v25, v29
v_mfma_f32_16x16x32_bf16 v[168:171], v[52:55], v[80:83], v[168:171]
ds_read_b64_tr_b16 v[74:75], v23 offset:17408
v_add_f32 v26, v26, v30
v_mfma_f32_16x16x32_bf16 v[172:175], v[52:55], v[84:87], v[172:175]
ds_read_b64_tr_b16 v[76:77], v24 offset:16384
v_fma_f32 v27, v29, v29, v27
v_mfma_f32_16x16x32_bf16 v[176:179], v[52:55], v[88:91], v[176:179]
ds_read_b64_tr_b16 v[78:79], v24 offset:17408
v_fma_f32 v28, v30, v30, v28
v_mfma_f32_16x16x32_bf16 v[180:183], v[52:55], v[92:95], v[180:183]
v_lshlrev_b32 v29, 16, v115
v_and_b32 v30, s59, v115
v_mfma_f32_16x16x32_bf16 v[184:187], v[56:59], v[80:83], v[184:187]
v_add_f32 v25, v25, v29
v_mfma_f32_16x16x32_bf16 v[188:191], v[56:59], v[84:87], v[188:191]
v_add_f32 v26, v26, v30
v_mfma_f32_16x16x32_bf16 v[192:195], v[56:59], v[88:91], v[192:195]
v_fma_f32 v27, v29, v29, v27
v_mfma_f32_16x16x32_bf16 v[196:199], v[56:59], v[92:95], v[196:199]
v_fma_f32 v28, v30, v30, v28
s_waitcnt lgkmcnt(0)
s_waitcnt vmcnt(6)
s_waitcnt vmcnt(0)
s_barrier
v_mfma_f32_16x16x32_bf16 v[120:123], v[60:63], v[96:99], v[120:123]
ds_read_b128 v[80:83], v14 offset:24576
v_lshlrev_b32 v29, 16, v116
v_mfma_f32_16x16x32_bf16 v[124:127], v[60:63], v[100:103], v[124:127]
ds_read_b128 v[84:87], v14 offset:26624
v_and_b32 v30, s59, v116
v_mfma_f32_16x16x32_bf16 v[128:131], v[60:63], v[104:107], v[128:131]
ds_read_b128 v[88:91], v14 offset:28672
v_add_f32 v25, v25, v29
v_mfma_f32_16x16x32_bf16 v[132:135], v[60:63], v[108:111], v[132:135]
ds_read_b128 v[92:95], v14 offset:30720
v_add_f32 v26, v26, v30
v_mfma_f32_16x16x32_bf16 v[200:203], v[60:63], v[36:39], v[200:203]
ds_read_b64_tr_b16 v[40:41], v16 offset:24576
v_fma_f32 v27, v29, v29, v27
v_mfma_f32_16x16x32_bf16 v[136:139], v[64:67], v[96:99], v[136:139]
ds_read_b64_tr_b16 v[42:43], v16 offset:25088
v_fma_f32 v28, v30, v30, v28
v_mfma_f32_16x16x32_bf16 v[140:143], v[64:67], v[100:103], v[140:143]
ds_read_b128 v[112:115], v31 offset:24576
v_lshlrev_b32 v29, 16, v117
v_mfma_f32_16x16x32_bf16 v[144:147], v[64:67], v[104:107], v[144:147]
ds_read_b64_tr_b16 v[44:45], v21 offset:32768
v_and_b32 v30, s59, v117
v_mfma_f32_16x16x32_bf16 v[148:151], v[64:67], v[108:111], v[148:151]
ds_read_b64_tr_b16 v[46:47], v21 offset:33792
v_add_f32 v25, v25, v29
v_mfma_f32_16x16x32_bf16 v[204:207], v[64:67], v[36:39], v[204:207]
ds_read_b64_tr_b16 v[48:49], v22 offset:32768
v_add_f32 v26, v26, v30
v_mfma_f32_16x16x32_bf16 v[152:155], v[68:71], v[96:99], v[152:155]
ds_read_b64_tr_b16 v[50:51], v22 offset:33792
v_fma_f32 v27, v29, v29, v27
v_mfma_f32_16x16x32_bf16 v[156:159], v[68:71], v[100:103], v[156:159]
ds_read_b64_tr_b16 v[52:53], v23 offset:32768
v_fma_f32 v28, v30, v30, v28
v_mfma_f32_16x16x32_bf16 v[160:163], v[68:71], v[104:107], v[160:163]
ds_read_b64_tr_b16 v[54:55], v23 offset:33792
v_lshlrev_b32 v29, 16, v118
v_mfma_f32_16x16x32_bf16 v[164:167], v[68:71], v[108:111], v[164:167]
ds_read_b64_tr_b16 v[56:57], v24 offset:32768
v_and_b32 v30, s59, v118
v_mfma_f32_16x16x32_bf16 v[208:211], v[68:71], v[36:39], v[208:211]
ds_read_b64_tr_b16 v[58:59], v24 offset:33792
v_add_f32 v25, v25, v29
v_mfma_f32_16x16x32_bf16 v[168:171], v[72:75], v[96:99], v[168:171]
v_add_f32 v26, v26, v30
v_mfma_f32_16x16x32_bf16 v[172:175], v[72:75], v[100:103], v[172:175]
v_fma_f32 v27, v29, v29, v27
v_mfma_f32_16x16x32_bf16 v[176:179], v[72:75], v[104:107], v[176:179]
v_fma_f32 v28, v30, v30, v28
v_mfma_f32_16x16x32_bf16 v[180:183], v[72:75], v[108:111], v[180:183]
v_lshlrev_b32 v29, 16, v119
v_mfma_f32_16x16x32_bf16 v[212:215], v[72:75], v[36:39], v[212:215]
v_and_b32 v30, s59, v119
v_mfma_f32_16x16x32_bf16 v[184:187], v[76:79], v[96:99], v[184:187]
v_add_f32 v25, v25, v29
v_mfma_f32_16x16x32_bf16 v[188:191], v[76:79], v[100:103], v[188:191]
v_add_f32 v26, v26, v30
v_mfma_f32_16x16x32_bf16 v[192:195], v[76:79], v[104:107], v[192:195]
v_fma_f32 v27, v29, v29, v27
v_mfma_f32_16x16x32_bf16 v[196:199], v[76:79], v[108:111], v[196:199]
v_fma_f32 v28, v30, v30, v28
v_mfma_f32_16x16x32_bf16 v[216:219], v[76:79], v[36:39], v[216:219]
s_waitcnt lgkmcnt(0)
s_barrier
v_mfma_f32_16x16x32_bf16 v[120:123], v[40:43], v[80:83], v[120:123]
ds_read_b128 v[96:99], v15 offset:24576
v_lshlrev_b32 v29, 16, v112
v_and_b32 v30, s59, v112
v_mfma_f32_16x16x32_bf16 v[124:127], v[40:43], v[84:87], v[124:127]
ds_read_b128 v[100:103], v15 offset:26624
v_add_f32 v25, v25, v29
v_mfma_f32_16x16x32_bf16 v[128:131], v[40:43], v[88:91], v[128:131]
ds_read_b128 v[104:107], v15 offset:28672
v_add_f32 v26, v26, v30
v_mfma_f32_16x16x32_bf16 v[132:135], v[40:43], v[92:95], v[132:135]
ds_read_b128 v[108:111], v15 offset:30720
v_fma_f32 v27, v29, v29, v27
v_mfma_f32_16x16x32_bf16 v[136:139], v[44:47], v[80:83], v[136:139]
ds_read_b64_tr_b16 v[60:61], v16 offset:28672
v_fma_f32 v28, v30, v30, v28
v_mfma_f32_16x16x32_bf16 v[140:143], v[44:47], v[84:87], v[140:143]
ds_read_b64_tr_b16 v[62:63], v16 offset:29184
v_lshlrev_b32 v29, 16, v113
v_and_b32 v30, s59, v113
v_mfma_f32_16x16x32_bf16 v[144:147], v[44:47], v[88:91], v[144:147]
ds_read_b128 v[116:119], v32 offset:24576
v_add_f32 v25, v25, v29
v_mfma_f32_16x16x32_bf16 v[148:151], v[44:47], v[92:95], v[148:151]
ds_read_b64_tr_b16 v[64:65], v17 offset:0
v_add_f32 v26, v26, v30
v_mfma_f32_16x16x32_bf16 v[152:155], v[48:51], v[80:83], v[152:155]
ds_read_b64_tr_b16 v[66:67], v17 offset:1024
v_fma_f32 v27, v29, v29, v27
v_mfma_f32_16x16x32_bf16 v[156:159], v[48:51], v[84:87], v[156:159]
ds_read_b64_tr_b16 v[68:69], v18 offset:0
v_fma_f32 v28, v30, v30, v28
v_mfma_f32_16x16x32_bf16 v[160:163], v[48:51], v[88:91], v[160:163]
ds_read_b64_tr_b16 v[70:71], v18 offset:1024
v_lshlrev_b32 v29, 16, v114
v_and_b32 v30, s59, v114
v_mfma_f32_16x16x32_bf16 v[164:167], v[48:51], v[92:95], v[164:167]
ds_read_b64_tr_b16 v[72:73], v19 offset:0
v_add_f32 v25, v25, v29
v_mfma_f32_16x16x32_bf16 v[168:171], v[52:55], v[80:83], v[168:171]
ds_read_b64_tr_b16 v[74:75], v19 offset:1024
v_add_f32 v26, v26, v30
v_mfma_f32_16x16x32_bf16 v[172:175], v[52:55], v[84:87], v[172:175]
ds_read_b64_tr_b16 v[76:77], v20 offset:0
v_fma_f32 v27, v29, v29, v27
v_mfma_f32_16x16x32_bf16 v[176:179], v[52:55], v[88:91], v[176:179]
ds_read_b64_tr_b16 v[78:79], v20 offset:1024
v_fma_f32 v28, v30, v30, v28
v_mfma_f32_16x16x32_bf16 v[180:183], v[52:55], v[92:95], v[180:183]
v_lshlrev_b32 v29, 16, v115
v_and_b32 v30, s59, v115
v_mfma_f32_16x16x32_bf16 v[184:187], v[56:59], v[80:83], v[184:187]
v_add_f32 v25, v25, v29
v_mfma_f32_16x16x32_bf16 v[188:191], v[56:59], v[84:87], v[188:191]
v_add_f32 v26, v26, v30
v_mfma_f32_16x16x32_bf16 v[192:195], v[56:59], v[88:91], v[192:195]
v_fma_f32 v27, v29, v29, v27
v_mfma_f32_16x16x32_bf16 v[196:199], v[56:59], v[92:95], v[196:199]
v_fma_f32 v28, v30, v30, v28
s_waitcnt lgkmcnt(0)
s_barrier
v_mfma_f32_16x16x32_bf16 v[120:123], v[60:63], v[96:99], v[120:123]
v_lshlrev_b32 v29, 16, v116
v_mfma_f32_16x16x32_bf16 v[124:127], v[60:63], v[100:103], v[124:127]
v_and_b32 v30, s59, v116
v_mfma_f32_16x16x32_bf16 v[128:131], v[60:63], v[104:107], v[128:131]
v_add_f32 v25, v25, v29
v_mfma_f32_16x16x32_bf16 v[132:135], v[60:63], v[108:111], v[132:135]
v_add_f32 v26, v26, v30
v_mfma_f32_16x16x32_bf16 v[200:203], v[60:63], v[36:39], v[200:203]
v_fma_f32 v27, v29, v29, v27
v_mfma_f32_16x16x32_bf16 v[136:139], v[64:67], v[96:99], v[136:139]
v_fma_f32 v28, v30, v30, v28
v_mfma_f32_16x16x32_bf16 v[140:143], v[64:67], v[100:103], v[140:143]
v_lshlrev_b32 v29, 16, v117
v_mfma_f32_16x16x32_bf16 v[144:147], v[64:67], v[104:107], v[144:147]
v_and_b32 v30, s59, v117
v_mfma_f32_16x16x32_bf16 v[148:151], v[64:67], v[108:111], v[148:151]
v_add_f32 v25, v25, v29
v_mfma_f32_16x16x32_bf16 v[204:207], v[64:67], v[36:39], v[204:207]
v_add_f32 v26, v26, v30
v_mfma_f32_16x16x32_bf16 v[152:155], v[68:71], v[96:99], v[152:155]
v_fma_f32 v27, v29, v29, v27
v_mfma_f32_16x16x32_bf16 v[156:159], v[68:71], v[100:103], v[156:159]
v_fma_f32 v28, v30, v30, v28
v_mfma_f32_16x16x32_bf16 v[160:163], v[68:71], v[104:107], v[160:163]
v_lshlrev_b32 v29, 16, v118
v_mfma_f32_16x16x32_bf16 v[164:167], v[68:71], v[108:111], v[164:167]
v_and_b32 v30, s59, v118
v_mfma_f32_16x16x32_bf16 v[208:211], v[68:71], v[36:39], v[208:211]
v_add_f32 v25, v25, v29
v_mfma_f32_16x16x32_bf16 v[168:171], v[72:75], v[96:99], v[168:171]
v_add_f32 v26, v26, v30
v_mfma_f32_16x16x32_bf16 v[172:175], v[72:75], v[100:103], v[172:175]
v_fma_f32 v27, v29, v29, v27
v_mfma_f32_16x16x32_bf16 v[176:179], v[72:75], v[104:107], v[176:179]
v_fma_f32 v28, v30, v30, v28
v_mfma_f32_16x16x32_bf16 v[180:183], v[72:75], v[108:111], v[180:183]
v_lshlrev_b32 v29, 16, v119
v_mfma_f32_16x16x32_bf16 v[212:215], v[72:75], v[36:39], v[212:215]
v_and_b32 v30, s59, v119
v_mfma_f32_16x16x32_bf16 v[184:187], v[76:79], v[96:99], v[184:187]
v_add_f32 v25, v25, v29
v_mfma_f32_16x16x32_bf16 v[188:191], v[76:79], v[100:103], v[188:191]
v_add_f32 v26, v26, v30
v_mfma_f32_16x16x32_bf16 v[192:195], v[76:79], v[104:107], v[192:195]
v_fma_f32 v27, v29, v29, v27
v_mfma_f32_16x16x32_bf16 v[196:199], v[76:79], v[108:111], v[196:199]
v_fma_f32 v28, v30, v30, v28
v_mfma_f32_16x16x32_bf16 v[216:219], v[76:79], v[36:39], v[216:219]
parallel_sum__mha_block__geglu_ffn__prompt_kernel_Atail:
s_nop 7
s_mov_b64 exec, 3
v_cmp_ne_u32 vcc, 0x01010101, v9
s_mov_b64 exec, -1
s_nop 2
s_cmp_eq_u64 vcc, 0
s_cbranch_scc1 parallel_sum__mha_block__geglu_ffn__prompt_kernel_clrokA
s_mov_b32 s83, 100000
s_mov_b32 s4, 0x3
s_mov_b32 s5, 0x0
s_mov_b64 exec, s[4:5]
poll1:
buffer_load_dword v9, v8, s[96:99], 0 offen sc1
s_waitcnt vmcnt(0)
v_cmp_ne_u32 vcc, 0x01010101, v9
s_nop 3
s_cmp_eq_u64 vcc, 0
s_cbranch_scc1 poll1_ok
s_sleep 2
s_sub_u32 s83, s83, 1
s_cmp_lg_u32 s83, 0
s_cbranch_scc1 poll1
poll1_ok:
s_mov_b64 exec, -1
parallel_sum__mha_block__geglu_ffn__prompt_kernel_clrokA:
v_add_f32 v25, v25, v26
v_add_f32 v27, v27, v28
v_mov_b32 v4, v25
s_nop 1
v_permlane32_swap_b32 v25, v4
v_add_f32 v25, v25, v4
v_mov_b32 v4, v25
s_nop 1
v_permlane16_swap_b32 v25, v4
v_add_f32 v25, v25, v4
v_mov_b32 v4, v27
s_nop 1
v_permlane32_swap_b32 v27, v4
v_add_f32 v27, v27, v4
v_mov_b32 v4, v27
s_nop 1
v_permlane16_swap_b32 v27, v4
v_add_f32 v27, v27, v4
v_mul_f32 v25, 0x3b000000, v25
v_mul_f32 v27, 0x3b000000, v27
v_fma_f32 v27, -v25, v25, v27
v_max_f32 v27, 0, v27
v_add_f32 v27, 0x3727c5ac, v27
v_rsq_f32 v26, v27
v_sqrt_f32 v29, v27
v_sub_f32 v28, 0, v25
s_lshl_b32 s33, s31, 6
s_lshl_b32 s34, s32, 4
s_add_u32 s33, s33, s34
v_add_u32 v4, s33, v2
v_lshlrev_b32 v4, 2, v4
v_add_u32 v4, 155648, v4
ds_write_b32 v4, v26
ds_write_b32 v4, v28 offset:512
ds_write_b32 v4, v29 offset:1024
s_mul_i32 s33, s32, 320
s_mul_i32 s34, s58, 1280
s_add_u32 s33, s33, s34
s_add_u32 s33, s33, 157184
v_lshlrev_b32 v5, 4, v3
v_add_u32 v5, s33, v5
v_lshlrev_b32 v6, 2, v2
v_add_u32 v6, s33, v6
s_nop 7
s_mov_b32 s4, 0x00010001
s_mov_b32 s5, 0x00010001
s_mov_b64 exec, s[4:5]
ds_write_b128 v5, v[200:203] offset:0
ds_write_b128 v5, v[204:207] offset:64
ds_write_b128 v5, v[208:211] offset:128
ds_write_b128 v5, v[212:215] offset:192
ds_write_b128 v5, v[216:219] offset:256
s_mov_b64 exec, -1
s_waitcnt lgkmcnt(0)
s_barrier
v_lshlrev_b32 v232, 4, v1
s_lshl_b32 s33, s31, 6
v_add_u32 v4, s33, v2
v_lshlrev_b32 v4, 2, v4
v_add_u32 v4, 155648, v4
ds_read_b32 v220, v4 offset:0
ds_read_b32 v224, v4 offset:512
ds_read_b32 v52, v4 offset:1024
ds_read_b32 v221, v4 offset:64
ds_read_b32 v225, v4 offset:576
ds_read_b32 v53, v4 offset:1088
ds_read_b32 v222, v4 offset:128
ds_read_b32 v226, v4 offset:640
ds_read_b32 v54, v4 offset:1152
ds_read_b32 v223, v4 offset:192
ds_read_b32 v227, v4 offset:704
ds_read_b32 v55, v4 offset:1216
s_mul_i32 s33, s32, 320
v_lshlrev_b32 v5, 4, v3
v_add_u32 v5, s33, v5
v_add_u32 v5, 157184, v5
ds_read_b128 v[48:51], v5 offset:0
ds_read_b128 v[200:203], v5 offset:1280
s_waitcnt lgkmcnt(0)
v_add_f32 v48, v48, v200
v_add_f32 v49, v49, v201
v_add_f32 v50, v50, v202
v_add_f32 v51, v51, v203
s_cmp_lt_u32 s30, 8
s_cselect_b32 s44, 0x3eb8aa3b, 1.0
v_mul_f32 v233, s44, v220
v_pk_fma_f32 v[120:121], v[224:225], v[48:49], v[120:121] op_sel:[0,0,0] op_sel_hi:[0,1,1]
v_pk_fma_f32 v[122:123], v[224:225], v[50:51], v[122:123] op_sel:[0,0,0] op_sel_hi:[0,1,1]
v_pk_mul_f32 v[120:121], v[120:121], v[232:233] op_sel:[0,1] op_sel_hi:[1,1]
v_pk_mul_f32 v[122:123], v[122:123], v[232:233] op_sel:[0,1] op_sel_hi:[1,1]
v_cvt_pk_bf16_f32 v40, v120, v121
v_cvt_pk_bf16_f32 v41, v122, v123
v_mul_f32 v233, s44, v221
v_pk_fma_f32 v[124:125], v[224:225], v[48:49], v[124:125] op_sel:[1,0,0] op_sel_hi:[1,1,1]
v_pk_fma_f32 v[126:127], v[224:225], v[50:51], v[126:127] op_sel:[1,0,0] op_sel_hi:[1,1,1]
v_pk_mul_f32 v[124:125], v[124:125], v[232:233] op_sel:[0,1] op_sel_hi:[1,1]
v_pk_mul_f32 v[126:127], v[126:127], v[232:233] op_sel:[0,1] op_sel_hi:[1,1]
v_cvt_pk_bf16_f32 v42, v124, v125
v_cvt_pk_bf16_f32 v43, v126, v127
v_mul_f32 v233, s44, v222
v_pk_fma_f32 v[128:129], v[226:227], v[48:49], v[128:129] op_sel:[0,0,0] op_sel_hi:[0,1,1]
v_pk_fma_f32 v[130:131], v[226:227], v[50:51], v[130:131] op_sel:[0,0,0] op_sel_hi:[0,1,1]
v_pk_mul_f32 v[128:129], v[128:129], v[232:233] op_sel:[0,1] op_sel_hi:[1,1]
v_pk_mul_f32 v[130:131], v[130:131], v[232:233] op_sel:[0,1] op_sel_hi:[1,1]
v_cvt_pk_bf16_f32 v44, v128, v129
v_cvt_pk_bf16_f32 v45, v130, v131
v_mul_f32 v233, s44, v223
v_pk_fma_f32 v[132:133], v[226:227], v[48:49], v[132:133] op_sel:[1,0,0] op_sel_hi:[1,1,1]
v_pk_fma_f32 v[134:135], v[226:227], v[50:51], v[134:135] op_sel:[1,0,0] op_sel_hi:[1,1,1]
v_pk_mul_f32 v[132:133], v[132:133], v[232:233] op_sel:[0,1] op_sel_hi:[1,1]
v_pk_mul_f32 v[134:135], v[134:135], v[232:233] op_sel:[0,1] op_sel_hi:[1,1]
v_cvt_pk_bf16_f32 v46, v132, v133
v_cvt_pk_bf16_f32 v47, v134, v135
s_and_b32 s33, s30, 7
s_lshl_b32 s33, s33, 2
s_add_u32 s33, s33, s32
s_lshl_b32 s33, s33, 16
s_cmp_lt_u32 s30, 8
s_cselect_b32 s34, 0, 2097152
s_add_u32 s33, s33, s34
s_lshl_b32 s34, s29, 2
s_lshl_b32 s45, s31, 1
s_add_u32 s34, s34, s45
s_lshl_b32 s34, s34, 10
s_add_u32 s33, s33, s34
v_permlane16_swap_b32 v40, v42
v_permlane16_swap_b32 v41, v43
buffer_store_dwordx4 v[40:43], v232, s[24:27], s33 offen offset:0 sc1
v_permlane16_swap_b32 v44, v46
v_permlane16_swap_b32 v45, v47
buffer_store_dwordx4 v[44:47], v232, s[24:27], s33 offen offset:1024 sc1
ds_read_b128 v[56:59], v5 offset:64
ds_read_b128 v[204:207], v5 offset:1344
ds_read_b128 v[64:67], v5 offset:192
ds_read_b128 v[212:215], v5 offset:1472
ds_read_b128 v[60:63], v5 offset:128
ds_read_b128 v[208:211], v5 offset:1408
ds_read_b128 v[68:71], v5 offset:256
ds_read_b128 v[216:219], v5 offset:1536
s_waitcnt lgkmcnt(6)
v_add_f32 v56, v56, v204
v_add_f32 v57, v57, v205
v_add_f32 v58, v58, v206
v_add_f32 v59, v59, v207
s_waitcnt lgkmcnt(4)
v_add_f32 v64, v64, v212
v_add_f32 v65, v65, v213
v_add_f32 v66, v66, v214
v_add_f32 v67, v67, v215
s_waitcnt lgkmcnt(2)
v_add_f32 v60, v60, v208
v_add_f32 v61, v61, v209
v_add_f32 v62, v62, v210
v_add_f32 v63, v63, v211
s_waitcnt lgkmcnt(0)
v_add_f32 v68, v68, v216
v_add_f32 v69, v69, v217
v_add_f32 v70, v70, v218
v_add_f32 v71, v71, v219
s_mov_b32 s46, 0xc0135761
s_mov_b32 s47, 0xbdd2d3e8
v_mov_b32 v72, s46
s_lshl_b32 s33, s29, 2
s_lshl_b32 s34, s31, 1
s_add_u32 s33, s33, s34
s_mul_i32 s33, s33, 147456
s_lshl_b32 s34, s30, 3
s_lshl_b32 s45, s32, 1
s_add_u32 s34, s34, s45
s_lshl_b32 s34, s34, 10
s_add_u32 s33, s33, s34
s_add_u32 s33, s33, 6291456
s_mov_b32 s100, s33
v_pk_fma_f32 v[136:137], v[224:225], v[56:57], v[136:137] op_sel:[0,0,0] op_sel_hi:[0,1,1]
v_pk_fma_f32 v[138:139], v[224:225], v[58:59], v[138:139] op_sel:[0,0,0] op_sel_hi:[0,1,1]
v_pk_fma_f32 v[168:169], v[224:225], v[64:65], v[168:169] op_sel:[0,0,0] op_sel_hi:[0,1,1]
v_pk_fma_f32 v[170:171], v[224:225], v[66:67], v[170:171] op_sel:[0,0,0] op_sel_hi:[0,1,1]
v_pk_mul_f32 v[136:137], v[136:137], v[220:221] op_sel:[0,0] op_sel_hi:[1,0]
v_pk_mul_f32 v[138:139], v[138:139], v[220:221] op_sel:[0,0] op_sel_hi:[1,0]
v_pk_mul_f32 v[84:85], v[136:137], v[136:137] op_sel:[0,0] op_sel_hi:[1,1]
v_pk_mul_f32 v[86:87], v[138:139], v[138:139] op_sel:[0,0] op_sel_hi:[1,1]
v_pk_fma_f32 v[84:85], v[84:85], s[46:47], s[46:47] op_sel:[0,1,0] op_sel_hi:[1,1,0]
v_pk_fma_f32 v[86:87], v[86:87], s[46:47], s[46:47] op_sel:[0,1,0] op_sel_hi:[1,1,0]
v_pk_mul_f32 v[84:85], v[84:85], v[136:137] op_sel:[0,0] op_sel_hi:[1,1]
v_pk_mul_f32 v[86:87], v[86:87], v[138:139] op_sel:[0,0] op_sel_hi:[1,1]
v_exp_f32 v84, v84
v_exp_f32 v85, v85
v_exp_f32 v86, v86
v_exp_f32 v87, v87
v_pk_mul_f32 v[168:169], v[168:169], v[136:137] op_sel:[0,0] op_sel_hi:[1,1]
v_pk_mul_f32 v[170:171], v[170:171], v[138:139] op_sel:[0,0] op_sel_hi:[1,1]
v_pk_fma_f32 v[84:85], v[84:85], v[52:53], v[52:53] op_sel:[0,0,0] op_sel_hi:[1,0,0]
v_pk_fma_f32 v[86:87], v[86:87], v[52:53], v[52:53] op_sel:[0,0,0] op_sel_hi:[1,0,0]
v_rcp_f32 v84, v84
v_rcp_f32 v85, v85
v_rcp_f32 v86, v86
v_rcp_f32 v87, v87
s_nop 0
v_pk_mul_f32 v[168:169], v[168:169], v[84:85] op_sel:[0,0] op_sel_hi:[1,1]
v_pk_mul_f32 v[170:171], v[170:171], v[86:87] op_sel:[0,0] op_sel_hi:[1,1]
v_cvt_pk_bf16_f32 v240, v168, v169
v_cvt_pk_bf16_f32 v241, v170, v171
v_pk_fma_f32 v[140:141], v[224:225], v[56:57], v[140:141] op_sel:[1,0,0] op_sel_hi:[1,1,1]
v_pk_fma_f32 v[142:143], v[224:225], v[58:59], v[142:143] op_sel:[1,0,0] op_sel_hi:[1,1,1]
v_pk_fma_f32 v[172:173], v[224:225], v[64:65], v[172:173] op_sel:[1,0,0] op_sel_hi:[1,1,1]
v_pk_fma_f32 v[174:175], v[224:225], v[66:67], v[174:175] op_sel:[1,0,0] op_sel_hi:[1,1,1]
v_pk_mul_f32 v[140:141], v[140:141], v[220:221] op_sel:[0,1] op_sel_hi:[1,1]
v_pk_mul_f32 v[142:143], v[142:143], v[220:221] op_sel:[0,1] op_sel_hi:[1,1]
v_pk_mul_f32 v[84:85], v[140:141], v[140:141] op_sel:[0,0] op_sel_hi:[1,1]
v_pk_mul_f32 v[86:87], v[142:143], v[142:143] op_sel:[0,0] op_sel_hi:[1,1]
v_pk_fma_f32 v[84:85], v[84:85], s[46:47], s[46:47] op_sel:[0,1,0] op_sel_hi:[1,1,0]
v_pk_fma_f32 v[86:87], v[86:87], s[46:47], s[46:47] op_sel:[0,1,0] op_sel_hi:[1,1,0]
v_pk_mul_f32 v[84:85], v[84:85], v[140:141] op_sel:[0,0] op_sel_hi:[1,1]
v_pk_mul_f32 v[86:87], v[86:87], v[142:143] op_sel:[0,0] op_sel_hi:[1,1]
v_exp_f32 v84, v84
v_exp_f32 v85, v85
v_exp_f32 v86, v86
v_exp_f32 v87, v87
v_pk_mul_f32 v[172:173], v[172:173], v[140:141] op_sel:[0,0] op_sel_hi:[1,1]
v_pk_mul_f32 v[174:175], v[174:175], v[142:143] op_sel:[0,0] op_sel_hi:[1,1]
v_pk_fma_f32 v[84:85], v[84:85], v[52:53], v[52:53] op_sel:[0,1,1] op_sel_hi:[1,1,1]
v_pk_fma_f32 v[86:87], v[86:87], v[52:53], v[52:53] op_sel:[0,1,1] op_sel_hi:[1,1,1]
v_rcp_f32 v84, v84
v_rcp_f32 v85, v85
v_rcp_f32 v86, v86
v_rcp_f32 v87, v87
s_nop 0
v_pk_mul_f32 v[172:173], v[172:173], v[84:85] op_sel:[0,0] op_sel_hi:[1,1]
v_pk_mul_f32 v[174:175], v[174:175], v[86:87] op_sel:[0,0] op_sel_hi:[1,1]
v_cvt_pk_bf16_f32 v242, v172, v173
v_cvt_pk_bf16_f32 v243, v174, v175
s_nop 0
v_permlane16_swap_b32 v240, v242
v_permlane16_swap_b32 v241, v243
v_pk_fma_f32 v[152:153], v[224:225], v[60:61], v[152:153] op_sel:[0,0,0] op_sel_hi:[0,1,1]
v_pk_fma_f32 v[154:155], v[224:225], v[62:63], v[154:155] op_sel:[0,0,0] op_sel_hi:[0,1,1]
v_pk_fma_f32 v[184:185], v[224:225], v[68:69], v[184:185] op_sel:[0,0,0] op_sel_hi:[0,1,1]
v_pk_fma_f32 v[186:187], v[224:225], v[70:71], v[186:187] op_sel:[0,0,0] op_sel_hi:[0,1,1]
v_pk_mul_f32 v[152:153], v[152:153], v[220:221] op_sel:[0,0] op_sel_hi:[1,0]
v_pk_mul_f32 v[154:155], v[154:155], v[220:221] op_sel:[0,0] op_sel_hi:[1,0]
v_pk_mul_f32 v[84:85], v[152:153], v[152:153] op_sel:[0,0] op_sel_hi:[1,1]
v_pk_mul_f32 v[86:87], v[154:155], v[154:155] op_sel:[0,0] op_sel_hi:[1,1]
v_pk_fma_f32 v[84:85], v[84:85], s[46:47], s[46:47] op_sel:[0,1,0] op_sel_hi:[1,1,0]
v_pk_fma_f32 v[86:87], v[86:87], s[46:47], s[46:47] op_sel:[0,1,0] op_sel_hi:[1,1,0]
v_pk_mul_f32 v[84:85], v[84:85], v[152:153] op_sel:[0,0] op_sel_hi:[1,1]
v_pk_mul_f32 v[86:87], v[86:87], v[154:155] op_sel:[0,0] op_sel_hi:[1,1]
v_exp_f32 v84, v84
v_exp_f32 v85, v85
v_exp_f32 v86, v86
v_exp_f32 v87, v87
v_pk_mul_f32 v[184:185], v[184:185], v[152:153] op_sel:[0,0] op_sel_hi:[1,1]
v_pk_mul_f32 v[186:187], v[186:187], v[154:155] op_sel:[0,0] op_sel_hi:[1,1]
v_pk_fma_f32 v[84:85], v[84:85], v[52:53], v[52:53] op_sel:[0,0,0] op_sel_hi:[1,0,0]
v_pk_fma_f32 v[86:87], v[86:87], v[52:53], v[52:53] op_sel:[0,0,0] op_sel_hi:[1,0,0]
v_rcp_f32 v84, v84
v_rcp_f32 v85, v85
v_rcp_f32 v86, v86
v_rcp_f32 v87, v87
s_nop 0
v_pk_mul_f32 v[184:185], v[184:185], v[84:85] op_sel:[0,0] op_sel_hi:[1,1]
v_pk_mul_f32 v[186:187], v[186:187], v[86:87] op_sel:[0,0] op_sel_hi:[1,1]
v_cvt_pk_bf16_f32 v244, v184, v185
v_cvt_pk_bf16_f32 v245, v186, v187
v_pk_fma_f32 v[156:157], v[224:225], v[60:61], v[156:157] op_sel:[1,0,0] op_sel_hi:[1,1,1]
v_pk_fma_f32 v[158:159], v[224:225], v[62:63], v[158:159] op_sel:[1,0,0] op_sel_hi:[1,1,1]
v_pk_fma_f32 v[188:189], v[224:225], v[68:69], v[188:189] op_sel:[1,0,0] op_sel_hi:[1,1,1]
v_pk_fma_f32 v[190:191], v[224:225], v[70:71], v[190:191] op_sel:[1,0,0] op_sel_hi:[1,1,1]
v_pk_mul_f32 v[156:157], v[156:157], v[220:221] op_sel:[0,1] op_sel_hi:[1,1]
v_pk_mul_f32 v[158:159], v[158:159], v[220:221] op_sel:[0,1] op_sel_hi:[1,1]
v_pk_mul_f32 v[84:85], v[156:157], v[156:157] op_sel:[0,0] op_sel_hi:[1,1]
v_pk_mul_f32 v[86:87], v[158:159], v[158:159] op_sel:[0,0] op_sel_hi:[1,1]
v_pk_fma_f32 v[84:85], v[84:85], s[46:47], s[46:47] op_sel:[0,1,0] op_sel_hi:[1,1,0]
v_pk_fma_f32 v[86:87], v[86:87], s[46:47], s[46:47] op_sel:[0,1,0] op_sel_hi:[1,1,0]
v_pk_mul_f32 v[84:85], v[84:85], v[156:157] op_sel:[0,0] op_sel_hi:[1,1]
v_pk_mul_f32 v[86:87], v[86:87], v[158:159] op_sel:[0,0] op_sel_hi:[1,1]
v_exp_f32 v84, v84
v_exp_f32 v85, v85
v_exp_f32 v86, v86
v_exp_f32 v87, v87
v_pk_mul_f32 v[188:189], v[188:189], v[156:157] op_sel:[0,0] op_sel_hi:[1,1]
v_pk_mul_f32 v[190:191], v[190:191], v[158:159] op_sel:[0,0] op_sel_hi:[1,1]
v_pk_fma_f32 v[84:85], v[84:85], v[52:53], v[52:53] op_sel:[0,1,1] op_sel_hi:[1,1,1]
v_pk_fma_f32 v[86:87], v[86:87], v[52:53], v[52:53] op_sel:[0,1,1] op_sel_hi:[1,1,1]
v_rcp_f32 v84, v84
v_rcp_f32 v85, v85
v_rcp_f32 v86, v86
v_rcp_f32 v87, v87
s_nop 0
v_pk_mul_f32 v[188:189], v[188:189], v[84:85] op_sel:[0,0] op_sel_hi:[1,1]
v_pk_mul_f32 v[190:191], v[190:191], v[86:87] op_sel:[0,0] op_sel_hi:[1,1]
v_cvt_pk_bf16_f32 v246, v188, v189
v_cvt_pk_bf16_f32 v247, v190, v191
s_nop 0
v_permlane16_swap_b32 v244, v246
v_permlane16_swap_b32 v245, v247
v_pk_fma_f32 v[144:145], v[226:227], v[56:57], v[144:145] op_sel:[0,0,0] op_sel_hi:[0,1,1]
v_pk_fma_f32 v[146:147], v[226:227], v[58:59], v[146:147] op_sel:[0,0,0] op_sel_hi:[0,1,1]
v_pk_fma_f32 v[176:177], v[226:227], v[64:65], v[176:177] op_sel:[0,0,0] op_sel_hi:[0,1,1]
v_pk_fma_f32 v[178:179], v[226:227], v[66:67], v[178:179] op_sel:[0,0,0] op_sel_hi:[0,1,1]
v_pk_mul_f32 v[144:145], v[144:145], v[222:223] op_sel:[0,0] op_sel_hi:[1,0]
v_pk_mul_f32 v[146:147], v[146:147], v[222:223] op_sel:[0,0] op_sel_hi:[1,0]
v_pk_mul_f32 v[84:85], v[144:145], v[144:145] op_sel:[0,0] op_sel_hi:[1,1]
v_pk_mul_f32 v[86:87], v[146:147], v[146:147] op_sel:[0,0] op_sel_hi:[1,1]
v_pk_fma_f32 v[84:85], v[84:85], s[46:47], s[46:47] op_sel:[0,1,0] op_sel_hi:[1,1,0]
v_pk_fma_f32 v[86:87], v[86:87], s[46:47], s[46:47] op_sel:[0,1,0] op_sel_hi:[1,1,0]
v_pk_mul_f32 v[84:85], v[84:85], v[144:145] op_sel:[0,0] op_sel_hi:[1,1]
v_pk_mul_f32 v[86:87], v[86:87], v[146:147] op_sel:[0,0] op_sel_hi:[1,1]
v_exp_f32 v84, v84
v_exp_f32 v85, v85
v_exp_f32 v86, v86
v_exp_f32 v87, v87
v_pk_mul_f32 v[176:177], v[176:177], v[144:145] op_sel:[0,0] op_sel_hi:[1,1]
v_pk_mul_f32 v[178:179], v[178:179], v[146:147] op_sel:[0,0] op_sel_hi:[1,1]
v_pk_fma_f32 v[84:85], v[84:85], v[54:55], v[54:55] op_sel:[0,0,0] op_sel_hi:[1,0,0]
v_pk_fma_f32 v[86:87], v[86:87], v[54:55], v[54:55] op_sel:[0,0,0] op_sel_hi:[1,0,0]
v_rcp_f32 v84, v84
v_rcp_f32 v85, v85
v_rcp_f32 v86, v86
v_rcp_f32 v87, v87
s_nop 0
v_pk_mul_f32 v[176:177], v[176:177], v[84:85] op_sel:[0,0] op_sel_hi:[1,1]
v_pk_mul_f32 v[178:179], v[178:179], v[86:87] op_sel:[0,0] op_sel_hi:[1,1]
v_cvt_pk_bf16_f32 v248, v176, v177
v_cvt_pk_bf16_f32 v249, v178, v179
v_pk_fma_f32 v[148:149], v[226:227], v[56:57], v[148:149] op_sel:[1,0,0] op_sel_hi:[1,1,1]
v_pk_fma_f32 v[150:151], v[226:227], v[58:59], v[150:151] op_sel:[1,0,0] op_sel_hi:[1,1,1]
v_pk_fma_f32 v[180:181], v[226:227], v[64:65], v[180:181] op_sel:[1,0,0] op_sel_hi:[1,1,1]
v_pk_fma_f32 v[182:183], v[226:227], v[66:67], v[182:183] op_sel:[1,0,0] op_sel_hi:[1,1,1]
v_pk_mul_f32 v[148:149], v[148:149], v[222:223] op_sel:[0,1] op_sel_hi:[1,1]
v_pk_mul_f32 v[150:151], v[150:151], v[222:223] op_sel:[0,1] op_sel_hi:[1,1]
v_pk_mul_f32 v[84:85], v[148:149], v[148:149] op_sel:[0,0] op_sel_hi:[1,1]
v_pk_mul_f32 v[86:87], v[150:151], v[150:151] op_sel:[0,0] op_sel_hi:[1,1]
v_pk_fma_f32 v[84:85], v[84:85], s[46:47], s[46:47] op_sel:[0,1,0] op_sel_hi:[1,1,0]
v_pk_fma_f32 v[86:87], v[86:87], s[46:47], s[46:47] op_sel:[0,1,0] op_sel_hi:[1,1,0]
v_pk_mul_f32 v[84:85], v[84:85], v[148:149] op_sel:[0,0] op_sel_hi:[1,1]
v_pk_mul_f32 v[86:87], v[86:87], v[150:151] op_sel:[0,0] op_sel_hi:[1,1]
v_exp_f32 v84, v84
v_exp_f32 v85, v85
v_exp_f32 v86, v86
v_exp_f32 v87, v87
v_pk_mul_f32 v[180:181], v[180:181], v[148:149] op_sel:[0,0] op_sel_hi:[1,1]
v_pk_mul_f32 v[182:183], v[182:183], v[150:151] op_sel:[0,0] op_sel_hi:[1,1]
v_pk_fma_f32 v[84:85], v[84:85], v[54:55], v[54:55] op_sel:[0,1,1] op_sel_hi:[1,1,1]
v_pk_fma_f32 v[86:87], v[86:87], v[54:55], v[54:55] op_sel:[0,1,1] op_sel_hi:[1,1,1]
v_rcp_f32 v84, v84
v_rcp_f32 v85, v85
v_rcp_f32 v86, v86
v_rcp_f32 v87, v87
s_nop 0
v_pk_mul_f32 v[180:181], v[180:181], v[84:85] op_sel:[0,0] op_sel_hi:[1,1]
v_pk_mul_f32 v[182:183], v[182:183], v[86:87] op_sel:[0,0] op_sel_hi:[1,1]
v_cvt_pk_bf16_f32 v250, v180, v181
v_cvt_pk_bf16_f32 v251, v182, v183
s_nop 0
v_permlane16_swap_b32 v248, v250
v_permlane16_swap_b32 v249, v251
s_waitcnt vmcnt(0)
s_barrier
s_cmp_lg_u32 s28, 0
s_cbranch_scc1 parallel_sum__mha_block__geglu_ffn__prompt_kernel_pq
v_mov_b32 v8, 0
v_mov_b32 v9, 1
s_mov_b64 exec, 1
buffer_atomic_add v9, v8, s[24:27], s94 offen sc1
s_mov_b64 exec, -1
parallel_sum__mha_block__geglu_ffn__prompt_kernel_pq:
v_pk_fma_f32 v[160:161], v[226:227], v[60:61], v[160:161] op_sel:[0,0,0] op_sel_hi:[0,1,1]
v_pk_fma_f32 v[162:163], v[226:227], v[62:63], v[162:163] op_sel:[0,0,0] op_sel_hi:[0,1,1]
v_pk_fma_f32 v[192:193], v[226:227], v[68:69], v[192:193] op_sel:[0,0,0] op_sel_hi:[0,1,1]
v_pk_fma_f32 v[194:195], v[226:227], v[70:71], v[194:195] op_sel:[0,0,0] op_sel_hi:[0,1,1]
v_pk_mul_f32 v[160:161], v[160:161], v[222:223] op_sel:[0,0] op_sel_hi:[1,0]
v_pk_mul_f32 v[162:163], v[162:163], v[222:223] op_sel:[0,0] op_sel_hi:[1,0]
v_pk_mul_f32 v[84:85], v[160:161], v[160:161] op_sel:[0,0] op_sel_hi:[1,1]
v_pk_mul_f32 v[86:87], v[162:163], v[162:163] op_sel:[0,0] op_sel_hi:[1,1]
v_pk_fma_f32 v[84:85], v[84:85], s[46:47], s[46:47] op_sel:[0,1,0] op_sel_hi:[1,1,0]
v_pk_fma_f32 v[86:87], v[86:87], s[46:47], s[46:47] op_sel:[0,1,0] op_sel_hi:[1,1,0]
v_pk_mul_f32 v[84:85], v[84:85], v[160:161] op_sel:[0,0] op_sel_hi:[1,1]
v_pk_mul_f32 v[86:87], v[86:87], v[162:163] op_sel:[0,0] op_sel_hi:[1,1]
v_exp_f32 v84, v84
v_exp_f32 v85, v85
v_exp_f32 v86, v86
v_exp_f32 v87, v87
v_pk_mul_f32 v[192:193], v[192:193], v[160:161] op_sel:[0,0] op_sel_hi:[1,1]
v_pk_mul_f32 v[194:195], v[194:195], v[162:163] op_sel:[0,0] op_sel_hi:[1,1]
v_pk_fma_f32 v[84:85], v[84:85], v[54:55], v[54:55] op_sel:[0,0,0] op_sel_hi:[1,0,0]
v_pk_fma_f32 v[86:87], v[86:87], v[54:55], v[54:55] op_sel:[0,0,0] op_sel_hi:[1,0,0]
v_rcp_f32 v84, v84
v_rcp_f32 v85, v85
v_rcp_f32 v86, v86
v_rcp_f32 v87, v87
s_nop 0
v_pk_mul_f32 v[192:193], v[192:193], v[84:85] op_sel:[0,0] op_sel_hi:[1,1]
v_pk_mul_f32 v[194:195], v[194:195], v[86:87] op_sel:[0,0] op_sel_hi:[1,1]
v_cvt_pk_bf16_f32 v252, v192, v193
v_cvt_pk_bf16_f32 v253, v194, v195
v_pk_fma_f32 v[164:165], v[226:227], v[60:61], v[164:165] op_sel:[1,0,0] op_sel_hi:[1,1,1]
v_pk_fma_f32 v[166:167], v[226:227], v[62:63], v[166:167] op_sel:[1,0,0] op_sel_hi:[1,1,1]
v_pk_fma_f32 v[196:197], v[226:227], v[68:69], v[196:197] op_sel:[1,0,0] op_sel_hi:[1,1,1]
v_pk_fma_f32 v[198:199], v[226:227], v[70:71], v[198:199] op_sel:[1,0,0] op_sel_hi:[1,1,1]
v_pk_mul_f32 v[164:165], v[164:165], v[222:223] op_sel:[0,1] op_sel_hi:[1,1]
v_pk_mul_f32 v[166:167], v[166:167], v[222:223] op_sel:[0,1] op_sel_hi:[1,1]
v_pk_mul_f32 v[84:85], v[164:165], v[164:165] op_sel:[0,0] op_sel_hi:[1,1]
v_pk_mul_f32 v[86:87], v[166:167], v[166:167] op_sel:[0,0] op_sel_hi:[1,1]
v_pk_fma_f32 v[84:85], v[84:85], s[46:47], s[46:47] op_sel:[0,1,0] op_sel_hi:[1,1,0]
v_pk_fma_f32 v[86:87], v[86:87], s[46:47], s[46:47] op_sel:[0,1,0] op_sel_hi:[1,1,0]
v_pk_mul_f32 v[84:85], v[84:85], v[164:165] op_sel:[0,0] op_sel_hi:[1,1]
v_pk_mul_f32 v[86:87], v[86:87], v[166:167] op_sel:[0,0] op_sel_hi:[1,1]
v_exp_f32 v84, v84
v_exp_f32 v85, v85
v_exp_f32 v86, v86
v_exp_f32 v87, v87
v_pk_mul_f32 v[196:197], v[196:197], v[164:165] op_sel:[0,0] op_sel_hi:[1,1]
v_pk_mul_f32 v[198:199], v[198:199], v[166:167] op_sel:[0,0] op_sel_hi:[1,1]
v_pk_fma_f32 v[84:85], v[84:85], v[54:55], v[54:55] op_sel:[0,1,1] op_sel_hi:[1,1,1]
v_pk_fma_f32 v[86:87], v[86:87], v[54:55], v[54:55] op_sel:[0,1,1] op_sel_hi:[1,1,1]
v_rcp_f32 v84, v84
v_rcp_f32 v85, v85
v_rcp_f32 v86, v86
v_rcp_f32 v87, v87
s_nop 0
v_pk_mul_f32 v[196:197], v[196:197], v[84:85] op_sel:[0,0] op_sel_hi:[1,1]
v_pk_mul_f32 v[198:199], v[198:199], v[86:87] op_sel:[0,0] op_sel_hi:[1,1]
v_cvt_pk_bf16_f32 v254, v196, v197
v_cvt_pk_bf16_f32 v255, v198, v199
s_nop 0
v_permlane16_swap_b32 v252, v254
v_permlane16_swap_b32 v253, v255
s_cmp_ge_u32 s28, 4
s_cbranch_scc1 parallel_sum__mha_block__geglu_ffn__prompt_kernel_hpass
s_lshl_b32 s34, s28, 13
s_add_u32 s34, s34, 131072
v_add_u32 v4, s34, v232
ds_write_b128 v4, v[240:243] offset:0
ds_write_b128 v4, v[244:247] offset:1024
ds_write_b128 v4, v[248:251] offset:2048
ds_write_b128 v4, v[252:255] offset:3072
s_waitcnt lgkmcnt(0)
parallel_sum__mha_block__geglu_ffn__prompt_kernel_hpass:
s_mov_b32 s101, 0
s_branch parallel_sum__mha_block__geglu_ffn__prompt_kernel_p2
parallel_sum__mha_block__geglu_ffn__prompt_kernel_typeB:
s_cmp_eq_u32 s58, 1
s_cbranch_scc1 parallel_sum__mha_block__geglu_ffn__prompt_kernel_B1
s_waitcnt vmcnt(9)
s_waitcnt vmcnt(7)
s_waitcnt lgkmcnt(0)
s_barrier
ds_read_b128 v[80:83], v14 offset:0
ds_read_b128 v[84:87], v14 offset:2048
ds_read_b128 v[88:91], v14 offset:4096
ds_read_b128 v[92:95], v14 offset:6144
ds_read_b64_tr_b16 v[40:41], v16 offset:0
ds_read_b64_tr_b16 v[42:43], v16 offset:512
ds_read_b128 v[112:115], v31 offset:0
ds_read_b64_tr_b16 v[44:45], v17 offset:0
ds_read_b64_tr_b16 v[46:47], v17 offset:1024
ds_read_b64_tr_b16 v[48:49], v18 offset:0
ds_read_b64_tr_b16 v[50:51], v18 offset:1024
ds_read_b64_tr_b16 v[52:53], v19 offset:0
ds_read_b64_tr_b16 v[54:55], v19 offset:1024
ds_read_b64_tr_b16 v[56:57], v20 offset:0
ds_read_b64_tr_b16 v[58:59], v20 offset:1024
s_waitcnt lgkmcnt(0)
s_waitcnt vmcnt(5)
s_barrier
s_lshl_b32 s33, s28, 13
v_lshlrev_b32 v4, 7, v1
v_add_u32 v4, s33, v4
s_mov_b32 s33, parallel_sum__mha_block__geglu_ffn__prompt_kernel_end-parallel_sum__mha_block__geglu_ffn__prompt_kernel_pc-4
v_min_u32 v4, s33, v4
global_load_dword v235, v4, s[78:79]
v_mfma_f32_16x16x32_bf16 v[120:123], v[40:43], v[80:83], 0
ds_read_b128 v[96:99], v15 offset:0
v_lshlrev_b32 v29, 16, v112
v_mfma_f32_16x16x32_bf16 v[124:127], v[40:43], v[84:87], 0
ds_read_b128 v[100:103], v15 offset:2048
v_and_b32 v30, s59, v112
v_mfma_f32_16x16x32_bf16 v[128:131], v[40:43], v[88:91], 0
ds_read_b128 v[104:107], v15 offset:4096
v_add_f32 v25, v25, v29
s_add_u32 m0, s42, 49152
s_add_u32 s75, s75, s46
buffer_load_dwordx4 v13, s[16:19], s75 offen sc1 lds
v_mfma_f32_16x16x32_bf16 v[132:135], v[40:43], v[92:95], 0
ds_read_b128 v[108:111], v15 offset:6144
v_add_f32 v26, v26, v30
v_mfma_f32_16x16x32_bf16 v[200:203], v[40:43], v[36:39], 0
ds_read_b64_tr_b16 v[60:61], v16 offset:4096
v_fma_f32 v27, v29, v29, v27
v_mfma_f32_16x16x32_bf16 v[136:139], v[80:83], v[44:47], 0
ds_read_b64_tr_b16 v[62:63], v16 offset:4608
v_fma_f32 v28, v30, v30, v28
v_mfma_f32_16x16x32_bf16 v[140:143], v[84:87], v[44:47], 0
ds_read_b128 v[116:119], v32 offset:0
v_lshlrev_b32 v29, 16, v113
v_mfma_f32_16x16x32_bf16 v[144:147], v[88:91], v[44:47], 0
ds_read_b64_tr_b16 v[64:65], v17 offset:16384
v_and_b32 v30, s59, v113
s_add_u32 m0, s42, 57344
s_add_u32 s76, s76, s46
buffer_load_dwordx4 v13, s[20:23], s76 offen sc1 lds
v_mfma_f32_16x16x32_bf16 v[148:151], v[92:95], v[44:47], 0
ds_read_b64_tr_b16 v[66:67], v17 offset:17408
v_add_f32 v25, v25, v29
v_mfma_f32_16x16x32_bf16 v[204:207], v[36:39], v[44:47], 0
ds_read_b64_tr_b16 v[68:69], v18 offset:16384
v_add_f32 v26, v26, v30
v_mfma_f32_16x16x32_bf16 v[152:155], v[80:83], v[48:51], 0
ds_read_b64_tr_b16 v[70:71], v18 offset:17408
v_fma_f32 v27, v29, v29, v27
v_mfma_f32_16x16x32_bf16 v[156:159], v[84:87], v[48:51], 0
ds_read_b64_tr_b16 v[72:73], v19 offset:16384
v_fma_f32 v28, v30, v30, v28
v_mfma_f32_16x16x32_bf16 v[160:163], v[88:91], v[48:51], 0
ds_read_b64_tr_b16 v[74:75], v19 offset:17408
v_lshlrev_b32 v29, 16, v114
s_add_u32 m0, s40, 49152
s_add_u32 s82, s36, 256
buffer_load_dwordx4 v10, s[8:11], s82 offen sc1 lds
v_mfma_f32_16x16x32_bf16 v[164:167], v[92:95], v[48:51], 0
ds_read_b64_tr_b16 v[76:77], v20 offset:16384
v_and_b32 v30, s59, v114
v_mfma_f32_16x16x32_bf16 v[208:211], v[36:39], v[48:51], 0
ds_read_b64_tr_b16 v[78:79], v20 offset:17408
v_add_f32 v25, v25, v29
v_mfma_f32_16x16x32_bf16 v[168:171], v[80:83], v[52:55], 0
v_add_f32 v26, v26, v30
v_mfma_f32_16x16x32_bf16 v[172:175], v[84:87], v[52:55], 0
v_fma_f32 v27, v29, v29, v27
v_mfma_f32_16x16x32_bf16 v[176:179], v[88:91], v[52:55], 0
v_fma_f32 v28, v30, v30, v28
s_add_u32 m0, s40, 50176
s_add_u32 s33, s37, 393216
buffer_load_dwordx4 v11, s[8:11], s82 offen sc1 lds
s_add_u32 m0, s41, 49152
s_nop 0
buffer_load_dwordx4 v12, s[12:15], s33 offen sc1 lds
v_mfma_f32_16x16x32_bf16 v[180:183], v[92:95], v[52:55], 0
v_lshlrev_b32 v29, 16, v115
v_mfma_f32_16x16x32_bf16 v[212:215], v[36:39], v[52:55], 0
v_and_b32 v30, s59, v115
v_mfma_f32_16x16x32_bf16 v[184:187], v[80:83], v[56:59], 0
v_add_f32 v25, v25, v29
v_mfma_f32_16x16x32_bf16 v[188:191], v[84:87], v[56:59], 0
v_add_f32 v26, v26, v30
v_mfma_f32_16x16x32_bf16 v[192:195], v[88:91], v[56:59], 0
v_fma_f32 v27, v29, v29, v27
v_mfma_f32_16x16x32_bf16 v[196:199], v[92:95], v[56:59], 0
v_fma_f32 v28, v30, v30, v28
v_mfma_f32_16x16x32_bf16 v[216:219], v[36:39], v[56:59], 0
s_waitcnt lgkmcnt(0)
s_waitcnt vmcnt(6)
s_barrier
v_mfma_f32_16x16x32_bf16 v[120:123], v[60:63], v[96:99], v[120:123]
ds_read_b128 v[80:83], v14 offset:24576
v_lshlrev_b32 v29, 16, v116
v_and_b32 v30, s59, v116
v_mfma_f32_16x16x32_bf16 v[124:127], v[60:63], v[100:103], v[124:127]
ds_read_b128 v[84:87], v14 offset:26624
v_add_f32 v25, v25, v29
v_mfma_f32_16x16x32_bf16 v[128:131], v[60:63], v[104:107], v[128:131]
ds_read_b128 v[88:91], v14 offset:28672
v_add_f32 v26, v26, v30
s_add_u32 m0, s42, 65536
s_add_u32 s75, s75, s46
buffer_load_dwordx4 v13, s[16:19], s75 offen sc1 lds
v_mfma_f32_16x16x32_bf16 v[132:135], v[60:63], v[108:111], v[132:135]
ds_read_b128 v[92:95], v14 offset:30720
v_fma_f32 v27, v29, v29, v27
v_mfma_f32_16x16x32_bf16 v[136:139], v[96:99], v[64:67], v[136:139]
ds_read_b64_tr_b16 v[40:41], v16 offset:24576
v_fma_f32 v28, v30, v30, v28
v_mfma_f32_16x16x32_bf16 v[140:143], v[100:103], v[64:67], v[140:143]
ds_read_b64_tr_b16 v[42:43], v16 offset:25088
v_lshlrev_b32 v29, 16, v117
v_and_b32 v30, s59, v117
v_mfma_f32_16x16x32_bf16 v[144:147], v[104:107], v[64:67], v[144:147]
ds_read_b128 v[112:115], v31 offset:24576
v_add_f32 v25, v25, v29
s_add_u32 m0, s42, 73728
s_add_u32 s76, s76, s46
buffer_load_dwordx4 v13, s[20:23], s76 offen sc1 lds
v_mfma_f32_16x16x32_bf16 v[148:151], v[108:111], v[64:67], v[148:151]
ds_read_b64_tr_b16 v[44:45], v21 offset:0
v_add_f32 v26, v26, v30
v_mfma_f32_16x16x32_bf16 v[152:155], v[96:99], v[68:71], v[152:155]
ds_read_b64_tr_b16 v[46:47], v21 offset:1024
v_fma_f32 v27, v29, v29, v27
v_mfma_f32_16x16x32_bf16 v[156:159], v[100:103], v[68:71], v[156:159]
ds_read_b64_tr_b16 v[48:49], v22 offset:0
v_fma_f32 v28, v30, v30, v28
v_mfma_f32_16x16x32_bf16 v[160:163], v[104:107], v[68:71], v[160:163]
ds_read_b64_tr_b16 v[50:51], v22 offset:1024
v_lshlrev_b32 v29, 16, v118
v_and_b32 v30, s59, v118
s_add_u32 m0, s42, 0
s_add_u32 s75, s75, s46
buffer_load_dwordx4 v13, s[16:19], s75 offen sc1 lds
v_mfma_f32_16x16x32_bf16 v[164:167], v[108:111], v[68:71], v[164:167]
ds_read_b64_tr_b16 v[52:53], v23 offset:0
v_add_f32 v25, v25, v29
v_mfma_f32_16x16x32_bf16 v[168:171], v[96:99], v[72:75], v[168:171]
ds_read_b64_tr_b16 v[54:55], v23 offset:1024
v_add_f32 v26, v26, v30
v_mfma_f32_16x16x32_bf16 v[172:175], v[100:103], v[72:75], v[172:175]
ds_read_b64_tr_b16 v[56:57], v24 offset:0
v_fma_f32 v27, v29, v29, v27
v_mfma_f32_16x16x32_bf16 v[176:179], v[104:107], v[72:75], v[176:179]
ds_read_b64_tr_b16 v[58:59], v24 offset:1024
v_fma_f32 v28, v30, v30, v28
s_add_u32 m0, s42, 8192
s_add_u32 s76, s76, s46
buffer_load_dwordx4 v13, s[20:23], s76 offen sc1 lds
v_mfma_f32_16x16x32_bf16 v[180:183], v[108:111], v[72:75], v[180:183]
v_lshlrev_b32 v29, 16, v119
v_and_b32 v30, s59, v119
v_mfma_f32_16x16x32_bf16 v[184:187], v[96:99], v[76:79], v[184:187]
v_add_f32 v25, v25, v29
v_mfma_f32_16x16x32_bf16 v[188:191], v[100:103], v[76:79], v[188:191]
v_add_f32 v26, v26, v30
v_mfma_f32_16x16x32_bf16 v[192:195], v[104:107], v[76:79], v[192:195]
v_fma_f32 v27, v29, v29, v27
v_mfma_f32_16x16x32_bf16 v[196:199], v[108:111], v[76:79], v[196:199]
v_fma_f32 v28, v30, v30, v28
s_waitcnt lgkmcnt(0)
s_waitcnt vmcnt(7)
s_barrier
v_mfma_f32_16x16x32_bf16 v[120:123], v[40:43], v[80:83], v[120:123]
ds_read_b128 v[96:99], v15 offset:24576
v_lshlrev_b32 v29, 16, v112
v_mfma_f32_16x16x32_bf16 v[124:127], v[40:43], v[84:87], v[124:127]
ds_read_b128 v[100:103], v15 offset:26624
v_and_b32 v30, s59, v112
v_mfma_f32_16x16x32_bf16 v[128:131], v[40:43], v[88:91], v[128:131]
ds_read_b128 v[104:107], v15 offset:28672
v_add_f32 v25, v25, v29
s_add_u32 m0, s42, 16384
s_add_u32 s75, s75, s46
buffer_load_dwordx4 v13, s[16:19], s75 offen sc1 lds
v_mfma_f32_16x16x32_bf16 v[132:135], v[40:43], v[92:95], v[132:135]
ds_read_b128 v[108:111], v15 offset:30720
v_add_f32 v26, v26, v30
v_mfma_f32_16x16x32_bf16 v[200:203], v[40:43], v[36:39], v[200:203]
ds_read_b64_tr_b16 v[60:61], v16 offset:28672
v_fma_f32 v27, v29, v29, v27
v_mfma_f32_16x16x32_bf16 v[136:139], v[80:83], v[44:47], v[136:139]
ds_read_b64_tr_b16 v[62:63], v16 offset:29184
v_fma_f32 v28, v30, v30, v28
v_mfma_f32_16x16x32_bf16 v[140:143], v[84:87], v[44:47], v[140:143]
ds_read_b128 v[116:119], v32 offset:24576
v_lshlrev_b32 v29, 16, v113
v_mfma_f32_16x16x32_bf16 v[144:147], v[88:91], v[44:47], v[144:147]
ds_read_b64_tr_b16 v[64:65], v21 offset:16384
v_and_b32 v30, s59, v113
s_add_u32 m0, s42, 24576
s_add_u32 s76, s76, s46
buffer_load_dwordx4 v13, s[20:23], s76 offen sc1 lds
v_mfma_f32_16x16x32_bf16 v[148:151], v[92:95], v[44:47], v[148:151]
ds_read_b64_tr_b16 v[66:67], v21 offset:17408
v_add_f32 v25, v25, v29
v_mfma_f32_16x16x32_bf16 v[204:207], v[36:39], v[44:47], v[204:207]
ds_read_b64_tr_b16 v[68:69], v22 offset:16384
v_add_f32 v26, v26, v30
v_mfma_f32_16x16x32_bf16 v[152:155], v[80:83], v[48:51], v[152:155]
ds_read_b64_tr_b16 v[70:71], v22 offset:17408
v_fma_f32 v27, v29, v29, v27
v_mfma_f32_16x16x32_bf16 v[156:159], v[84:87], v[48:51], v[156:159]
ds_read_b64_tr_b16 v[72:73], v23 offset:16384
v_fma_f32 v28, v30, v30, v28
v_mfma_f32_16x16x32_bf16 v[160:163], v[88:91], v[48:51], v[160:163]
ds_read_b64_tr_b16 v[74:75], v23 offset:17408
v_lshlrev_b32 v29, 16, v114
s_add_u32 m0, s40, 0
s_add_u32 s82, s36, 384
buffer_load_dwordx4 v10, s[8:11], s82 offen sc1 lds
v_mfma_f32_16x16x32_bf16 v[164:167], v[92:95], v[48:51], v[164:167]
ds_read_b64_tr_b16 v[76:77], v24 offset:16384
v_and_b32 v30, s59, v114
v_mfma_f32_16x16x32_bf16 v[208:211], v[36:39], v[48:51], v[208:211]
ds_read_b64_tr_b16 v[78:79], v24 offset:17408
v_add_f32 v25, v25, v29
v_mfma_f32_16x16x32_bf16 v[168:171], v[80:83], v[52:55], v[168:171]
v_add_f32 v26, v26, v30
v_mfma_f32_16x16x32_bf16 v[172:175], v[84:87], v[52:55], v[172:175]
v_fma_f32 v27, v29, v29, v27
v_mfma_f32_16x16x32_bf16 v[176:179], v[88:91], v[52:55], v[176:179]
v_fma_f32 v28, v30, v30, v28
s_add_u32 m0, s40, 1024
s_add_u32 s33, s37, 589824
buffer_load_dwordx4 v11, s[8:11], s82 offen sc1 lds
s_add_u32 m0, s41, 0
s_nop 0
buffer_load_dwordx4 v12, s[12:15], s33 offen sc1 lds
v_mfma_f32_16x16x32_bf16 v[180:183], v[92:95], v[52:55], v[180:183]
v_lshlrev_b32 v29, 16, v115
v_mfma_f32_16x16x32_bf16 v[212:215], v[36:39], v[52:55], v[212:215]
v_and_b32 v30, s59, v115
v_mfma_f32_16x16x32_bf16 v[184:187], v[80:83], v[56:59], v[184:187]
v_add_f32 v25, v25, v29
v_mfma_f32_16x16x32_bf16 v[188:191], v[84:87], v[56:59], v[188:191]
v_add_f32 v26, v26, v30
v_mfma_f32_16x16x32_bf16 v[192:195], v[88:91], v[56:59], v[192:195]
v_fma_f32 v27, v29, v29, v27
v_mfma_f32_16x16x32_bf16 v[196:199], v[92:95], v[56:59], v[196:199]
v_fma_f32 v28, v30, v30, v28
v_mfma_f32_16x16x32_bf16 v[216:219], v[36:39], v[56:59], v[216:219]
s_waitcnt lgkmcnt(0)
s_waitcnt vmcnt(7)
s_barrier
v_mfma_f32_16x16x32_bf16 v[120:123], v[60:63], v[96:99], v[120:123]
ds_read_b128 v[80:83], v14 offset:49152
v_lshlrev_b32 v29, 16, v116
v_and_b32 v30, s59, v116
v_mfma_f32_16x16x32_bf16 v[124:127], v[60:63], v[100:103], v[124:127]
ds_read_b128 v[84:87], v14 offset:51200
v_add_f32 v25, v25, v29
v_mfma_f32_16x16x32_bf16 v[128:131], v[60:63], v[104:107], v[128:131]
ds_read_b128 v[88:91], v14 offset:53248
v_add_f32 v26, v26, v30
s_add_u32 m0, s42, 32768
s_add_u32 s75, s75, s46
buffer_load_dwordx4 v13, s[16:19], s75 offen sc1 lds
v_mfma_f32_16x16x32_bf16 v[132:135], v[60:63], v[108:111], v[132:135]
ds_read_b128 v[92:95], v14 offset:55296
v_fma_f32 v27, v29, v29, v27
v_mfma_f32_16x16x32_bf16 v[136:139], v[96:99], v[64:67], v[136:139]
ds_read_b64_tr_b16 v[40:41], v16 offset:49152
v_fma_f32 v28, v30, v30, v28
v_mfma_f32_16x16x32_bf16 v[140:143], v[100:103], v[64:67], v[140:143]
ds_read_b64_tr_b16 v[42:43], v16 offset:49664
v_lshlrev_b32 v29, 16, v117
v_and_b32 v30, s59, v117
v_mfma_f32_16x16x32_bf16 v[144:147], v[104:107], v[64:67], v[144:147]
ds_read_b128 v[112:115], v31 offset:49152
v_add_f32 v25, v25, v29
s_add_u32 m0, s42, 40960
s_add_u32 s76, s76, s46
buffer_load_dwordx4 v13, s[20:23], s76 offen sc1 lds
v_mfma_f32_16x16x32_bf16 v[148:151], v[108:111], v[64:67], v[148:151]
ds_read_b64_tr_b16 v[44:45], v21 offset:32768
v_add_f32 v26, v26, v30
v_mfma_f32_16x16x32_bf16 v[152:155], v[96:99], v[68:71], v[152:155]
ds_read_b64_tr_b16 v[46:47], v21 offset:33792
v_fma_f32 v27, v29, v29, v27
v_mfma_f32_16x16x32_bf16 v[156:159], v[100:103], v[68:71], v[156:159]
ds_read_b64_tr_b16 v[48:49], v22 offset:32768
v_fma_f32 v28, v30, v30, v28
v_mfma_f32_16x16x32_bf16 v[160:163], v[104:107], v[68:71], v[160:163]
ds_read_b64_tr_b16 v[50:51], v22 offset:33792
v_lshlrev_b32 v29, 16, v118
v_and_b32 v30, s59, v118
s_add_u32 m0, s42, 49152
s_add_u32 s75, s75, s46
buffer_load_dwordx4 v13, s[16:19], s75 offen sc1 lds
v_mfma_f32_16x16x32_bf16 v[164:167], v[108:111], v[68:71], v[164:167]
ds_read_b64_tr_b16 v[52:53], v23 offset:32768
v_add_f32 v25, v25, v29
v_mfma_f32_16x16x32_bf16 v[168:171], v[96:99], v[72:75], v[168:171]
ds_read_b64_tr_b16 v[54:55], v23 offset:33792
v_add_f32 v26, v26, v30
v_mfma_f32_16x16x32_bf16 v[172:175], v[100:103], v[72:75], v[172:175]
ds_read_b64_tr_b16 v[56:57], v24 offset:32768
v_fma_f32 v27, v29, v29, v27
v_mfma_f32_16x16x32_bf16 v[176:179], v[104:107], v[72:75], v[176:179]
ds_read_b64_tr_b16 v[58:59], v24 offset:33792
v_fma_f32 v28, v30, v30, v28
s_add_u32 m0, s42, 57344
s_add_u32 s76, s76, s46
buffer_load_dwordx4 v13, s[20:23], s76 offen sc1 lds
v_mfma_f32_16x16x32_bf16 v[180:183], v[108:111], v[72:75], v[180:183]
v_lshlrev_b32 v29, 16, v119
v_and_b32 v30, s59, v119
v_mfma_f32_16x16x32_bf16 v[184:187], v[96:99], v[76:79], v[184:187]
v_add_f32 v25, v25, v29
v_mfma_f32_16x16x32_bf16 v[188:191], v[100:103], v[76:79], v[188:191]
v_add_f32 v26, v26, v30
v_mfma_f32_16x16x32_bf16 v[192:195], v[104:107], v[76:79], v[192:195]
v_fma_f32 v27, v29, v29, v27
v_mfma_f32_16x16x32_bf16 v[196:199], v[108:111], v[76:79], v[196:199]
v_fma_f32 v28, v30, v30, v28
s_waitcnt lgkmcnt(0)
s_waitcnt vmcnt(9)
s_barrier
s_cmp_ge_u32 s2, 8
s_cbranch_scc1 parallel_sum__mha_block__geglu_ffn__prompt_kernel_B0_sig
s_cmp_lg_u32 s28, 7
s_cbranch_scc1 parallel_sum__mha_block__geglu_ffn__prompt_kernel_B0_sig
v_mov_b32 v4, s2
v_mov_b32 v5, 1
s_mov_b64 exec, 1
buffer_store_byte v5, v4, s[96:99], 0 offen sc1
s_mov_b64 exec, -1
parallel_sum__mha_block__geglu_ffn__prompt_kernel_B0_sig:
v_mfma_f32_16x16x32_bf16 v[120:123], v[40:43], v[80:83], v[120:123]
ds_read_b128 v[96:99], v15 offset:49152
v_lshlrev_b32 v29, 16, v112
v_mfma_f32_16x16x32_bf16 v[124:127], v[40:43], v[84:87], v[124:127]
ds_read_b128 v[100:103], v15 offset:51200
v_and_b32 v30, s59, v112
v_mfma_f32_16x16x32_bf16 v[128:131], v[40:43], v[88:91], v[128:131]
ds_read_b128 v[104:107], v15 offset:53248
v_add_f32 v25, v25, v29
s_add_u32 m0, s42, 65536
s_add_u32 s75, s75, s46
buffer_load_dwordx4 v13, s[16:19], s75 offen sc1 lds
v_mfma_f32_16x16x32_bf16 v[132:135], v[40:43], v[92:95], v[132:135]
ds_read_b128 v[108:111], v15 offset:55296
v_add_f32 v26, v26, v30
v_mfma_f32_16x16x32_bf16 v[200:203], v[40:43], v[36:39], v[200:203]
ds_read_b64_tr_b16 v[60:61], v16 offset:53248
v_fma_f32 v27, v29, v29, v27
v_mfma_f32_16x16x32_bf16 v[136:139], v[80:83], v[44:47], v[136:139]
ds_read_b64_tr_b16 v[62:63], v16 offset:53760
v_fma_f32 v28, v30, v30, v28
v_mfma_f32_16x16x32_bf16 v[140:143], v[84:87], v[44:47], v[140:143]
ds_read_b128 v[116:119], v32 offset:49152
v_lshlrev_b32 v29, 16, v113
v_mfma_f32_16x16x32_bf16 v[144:147], v[88:91], v[44:47], v[144:147]
ds_read_b64_tr_b16 v[64:65], v17 offset:0
v_and_b32 v30, s59, v113
s_add_u32 m0, s42, 73728
s_add_u32 s76, s76, s46
buffer_load_dwordx4 v13, s[20:23], s76 offen sc1 lds
v_mfma_f32_16x16x32_bf16 v[148:151], v[92:95], v[44:47], v[148:151]
ds_read_b64_tr_b16 v[66:67], v17 offset:1024
v_add_f32 v25, v25, v29
v_mfma_f32_16x16x32_bf16 v[204:207], v[36:39], v[44:47], v[204:207]
ds_read_b64_tr_b16 v[68:69], v18 offset:0
v_add_f32 v26, v26, v30
v_mfma_f32_16x16x32_bf16 v[152:155], v[80:83], v[48:51], v[152:155]
ds_read_b64_tr_b16 v[70:71], v18 offset:1024
v_fma_f32 v27, v29, v29, v27
v_mfma_f32_16x16x32_bf16 v[156:159], v[84:87], v[48:51], v[156:159]
ds_read_b64_tr_b16 v[72:73], v19 offset:0
v_fma_f32 v28, v30, v30, v28
v_mfma_f32_16x16x32_bf16 v[160:163], v[88:91], v[48:51], v[160:163]
ds_read_b64_tr_b16 v[74:75], v19 offset:1024
v_lshlrev_b32 v29, 16, v114
s_add_u32 m0, s40, 24576
s_add_u32 s82, s36, 512
buffer_load_dwordx4 v10, s[8:11], s82 offen sc1 lds
v_mfma_f32_16x16x32_bf16 v[164:167], v[92:95], v[48:51], v[164:167]
ds_read_b64_tr_b16 v[76:77], v20 offset:0
v_and_b32 v30, s59, v114
v_mfma_f32_16x16x32_bf16 v[208:211], v[36:39], v[48:51], v[208:211]
ds_read_b64_tr_b16 v[78:79], v20 offset:1024
v_add_f32 v25, v25, v29
v_mfma_f32_16x16x32_bf16 v[168:171], v[80:83], v[52:55], v[168:171]
v_add_f32 v26, v26, v30
v_mfma_f32_16x16x32_bf16 v[172:175], v[84:87], v[52:55], v[172:175]
v_fma_f32 v27, v29, v29, v27
v_mfma_f32_16x16x32_bf16 v[176:179], v[88:91], v[52:55], v[176:179]
v_fma_f32 v28, v30, v30, v28
s_add_u32 m0, s40, 25600
s_add_u32 s33, s37, 786432
buffer_load_dwordx4 v11, s[8:11], s82 offen sc1 lds
s_add_u32 m0, s41, 24576
s_nop 0
buffer_load_dwordx4 v12, s[12:15], s33 offen sc1 lds
v_mfma_f32_16x16x32_bf16 v[180:183], v[92:95], v[52:55], v[180:183]
v_lshlrev_b32 v29, 16, v115
v_mfma_f32_16x16x32_bf16 v[212:215], v[36:39], v[52:55], v[212:215]
v_and_b32 v30, s59, v115
v_mfma_f32_16x16x32_bf16 v[184:187], v[80:83], v[56:59], v[184:187]
v_add_f32 v25, v25, v29
v_mfma_f32_16x16x32_bf16 v[188:191], v[84:87], v[56:59], v[188:191]
v_add_f32 v26, v26, v30
v_mfma_f32_16x16x32_bf16 v[192:195], v[88:91], v[56:59], v[192:195]
v_fma_f32 v27, v29, v29, v27
v_mfma_f32_16x16x32_bf16 v[196:199], v[92:95], v[56:59], v[196:199]
v_fma_f32 v28, v30, v30, v28
v_mfma_f32_16x16x32_bf16 v[216:219], v[36:39], v[56:59], v[216:219]
s_waitcnt lgkmcnt(0)
s_waitcnt vmcnt(12)
s_waitcnt vmcnt(9)
s_barrier
v_mfma_f32_16x16x32_bf16 v[120:123], v[60:63], v[96:99], v[120:123]
ds_read_b128 v[80:83], v14 offset:0
v_lshlrev_b32 v29, 16, v116
v_and_b32 v30, s59, v116
v_mfma_f32_16x16x32_bf16 v[124:127], v[60:63], v[100:103], v[124:127]
ds_read_b128 v[84:87], v14 offset:2048
v_add_f32 v25, v25, v29
v_mfma_f32_16x16x32_bf16 v[128:131], v[60:63], v[104:107], v[128:131]
ds_read_b128 v[88:91], v14 offset:4096
v_add_f32 v26, v26, v30
s_add_u32 m0, s42, 0
s_add_u32 s75, s75, s46
buffer_load_dwordx4 v13, s[16:19], s75 offen sc1 lds
v_mfma_f32_16x16x32_bf16 v[132:135], v[60:63], v[108:111], v[132:135]
ds_read_b128 v[92:95], v14 offset:6144
v_fma_f32 v27, v29, v29, v27
v_mfma_f32_16x16x32_bf16 v[136:139], v[96:99], v[64:67], v[136:139]
ds_read_b64_tr_b16 v[40:41], v16 offset:0
v_fma_f32 v28, v30, v30, v28
v_mfma_f32_16x16x32_bf16 v[140:143], v[100:103], v[64:67], v[140:143]
ds_read_b64_tr_b16 v[42:43], v16 offset:512
v_lshlrev_b32 v29, 16, v117
v_and_b32 v30, s59, v117
v_mfma_f32_16x16x32_bf16 v[144:147], v[104:107], v[64:67], v[144:147]
ds_read_b128 v[112:115], v31 offset:0
v_add_f32 v25, v25, v29
v_mfma_f32_16x16x32_bf16 v[148:151], v[108:111], v[64:67], v[148:151]
ds_read_b64_tr_b16 v[44:45], v17 offset:16384
v_add_f32 v26, v26, v30
v_mfma_f32_16x16x32_bf16 v[152:155], v[96:99], v[68:71], v[152:155]
ds_read_b64_tr_b16 v[46:47], v17 offset:17408
v_fma_f32 v27, v29, v29, v27
v_mfma_f32_16x16x32_bf16 v[156:159], v[100:103], v[68:71], v[156:159]
ds_read_b64_tr_b16 v[48:49], v18 offset:16384
v_fma_f32 v28, v30, v30, v28
v_mfma_f32_16x16x32_bf16 v[160:163], v[104:107], v[68:71], v[160:163]
ds_read_b64_tr_b16 v[50:51], v18 offset:17408
v_lshlrev_b32 v29, 16, v118
v_and_b32 v30, s59, v118
v_mfma_f32_16x16x32_bf16 v[164:167], v[108:111], v[68:71], v[164:167]
ds_read_b64_tr_b16 v[52:53], v19 offset:16384
v_add_f32 v25, v25, v29
s_add_u32 m0, s42, 8192
s_add_u32 s76, s76, s46
buffer_load_dwordx4 v13, s[20:23], s76 offen sc1 lds
v_mfma_f32_16x16x32_bf16 v[168:171], v[96:99], v[72:75], v[168:171]
ds_read_b64_tr_b16 v[54:55], v19 offset:17408
v_add_f32 v26, v26, v30
v_mfma_f32_16x16x32_bf16 v[172:175], v[100:103], v[72:75], v[172:175]
ds_read_b64_tr_b16 v[56:57], v20 offset:16384
v_fma_f32 v27, v29, v29, v27
v_mfma_f32_16x16x32_bf16 v[176:179], v[104:107], v[72:75], v[176:179]
ds_read_b64_tr_b16 v[58:59], v20 offset:17408
v_fma_f32 v28, v30, v30, v28
v_mfma_f32_16x16x32_bf16 v[180:183], v[108:111], v[72:75], v[180:183]
v_lshlrev_b32 v29, 16, v119
v_and_b32 v30, s59, v119
v_mfma_f32_16x16x32_bf16 v[184:187], v[96:99], v[76:79], v[184:187]
v_add_f32 v25, v25, v29
v_mfma_f32_16x16x32_bf16 v[188:191], v[100:103], v[76:79], v[188:191]
v_add_f32 v26, v26, v30
v_mfma_f32_16x16x32_bf16 v[192:195], v[104:107], v[76:79], v[192:195]
v_fma_f32 v27, v29, v29, v27
v_mfma_f32_16x16x32_bf16 v[196:199], v[108:111], v[76:79], v[196:199]
v_fma_f32 v28, v30, v30, v28
s_waitcnt lgkmcnt(0)
s_waitcnt vmcnt(9)
s_barrier
v_mfma_f32_16x16x32_bf16 v[120:123], v[40:43], v[80:83], v[120:123]
ds_read_b128 v[96:99], v15 offset:0
v_lshlrev_b32 v29, 16, v112
v_mfma_f32_16x16x32_bf16 v[124:127], v[40:43], v[84:87], v[124:127]
ds_read_b128 v[100:103], v15 offset:2048
v_and_b32 v30, s59, v112
v_mfma_f32_16x16x32_bf16 v[128:131], v[40:43], v[88:91], v[128:131]
ds_read_b128 v[104:107], v15 offset:4096
v_add_f32 v25, v25, v29
s_add_u32 m0, s42, 16384
s_add_u32 s75, s75, s46
buffer_load_dwordx4 v13, s[16:19], s75 offen sc1 lds
v_mfma_f32_16x16x32_bf16 v[132:135], v[40:43], v[92:95], v[132:135]
ds_read_b128 v[108:111], v15 offset:6144
v_add_f32 v26, v26, v30
v_mfma_f32_16x16x32_bf16 v[200:203], v[40:43], v[36:39], v[200:203]
ds_read_b64_tr_b16 v[60:61], v16 offset:4096
v_fma_f32 v27, v29, v29, v27
v_mfma_f32_16x16x32_bf16 v[136:139], v[80:83], v[44:47], v[136:139]
ds_read_b64_tr_b16 v[62:63], v16 offset:4608
v_fma_f32 v28, v30, v30, v28
v_mfma_f32_16x16x32_bf16 v[140:143], v[84:87], v[44:47], v[140:143]
ds_read_b128 v[116:119], v32 offset:0
v_lshlrev_b32 v29, 16, v113
v_mfma_f32_16x16x32_bf16 v[144:147], v[88:91], v[44:47], v[144:147]
ds_read_b64_tr_b16 v[64:65], v21 offset:0
v_and_b32 v30, s59, v113
s_add_u32 m0, s42, 24576
s_add_u32 s76, s76, s46
buffer_load_dwordx4 v13, s[20:23], s76 offen sc1 lds
v_mfma_f32_16x16x32_bf16 v[148:151], v[92:95], v[44:47], v[148:151]
ds_read_b64_tr_b16 v[66:67], v21 offset:1024
v_add_f32 v25, v25, v29
v_mfma_f32_16x16x32_bf16 v[204:207], v[36:39], v[44:47], v[204:207]
ds_read_b64_tr_b16 v[68:69], v22 offset:0
v_add_f32 v26, v26, v30
v_mfma_f32_16x16x32_bf16 v[152:155], v[80:83], v[48:51], v[152:155]
ds_read_b64_tr_b16 v[70:71], v22 offset:1024
v_fma_f32 v27, v29, v29, v27
v_mfma_f32_16x16x32_bf16 v[156:159], v[84:87], v[48:51], v[156:159]
ds_read_b64_tr_b16 v[72:73], v23 offset:0
v_fma_f32 v28, v30, v30, v28
v_mfma_f32_16x16x32_bf16 v[160:163], v[88:91], v[48:51], v[160:163]
ds_read_b64_tr_b16 v[74:75], v23 offset:1024
v_lshlrev_b32 v29, 16, v114
s_add_u32 m0, s40, 49152
s_add_u32 s82, s36, 640
buffer_load_dwordx4 v10, s[8:11], s82 offen sc1 lds
v_mfma_f32_16x16x32_bf16 v[164:167], v[92:95], v[48:51], v[164:167]
ds_read_b64_tr_b16 v[76:77], v24 offset:0
v_and_b32 v30, s59, v114
v_mfma_f32_16x16x32_bf16 v[208:211], v[36:39], v[48:51], v[208:211]
ds_read_b64_tr_b16 v[78:79], v24 offset:1024
v_add_f32 v25, v25, v29
v_mfma_f32_16x16x32_bf16 v[168:171], v[80:83], v[52:55], v[168:171]
v_add_f32 v26, v26, v30
v_mfma_f32_16x16x32_bf16 v[172:175], v[84:87], v[52:55], v[172:175]
v_fma_f32 v27, v29, v29, v27
v_mfma_f32_16x16x32_bf16 v[176:179], v[88:91], v[52:55], v[176:179]
v_fma_f32 v28, v30, v30, v28
s_add_u32 m0, s40, 50176
s_add_u32 s33, s37, 983040
buffer_load_dwordx4 v11, s[8:11], s82 offen sc1 lds
s_add_u32 m0, s41, 49152
s_nop 0
buffer_load_dwordx4 v12, s[12:15], s33 offen sc1 lds
v_mfma_f32_16x16x32_bf16 v[180:183], v[92:95], v[52:55], v[180:183]
v_lshlrev_b32 v29, 16, v115
v_mfma_f32_16x16x32_bf16 v[212:215], v[36:39], v[52:55], v[212:215]
v_and_b32 v30, s59, v115
v_mfma_f32_16x16x32_bf16 v[184:187], v[80:83], v[56:59], v[184:187]
v_add_f32 v25, v25, v29
v_mfma_f32_16x16x32_bf16 v[188:191], v[84:87], v[56:59], v[188:191]
v_add_f32 v26, v26, v30
v_mfma_f32_16x16x32_bf16 v[192:195], v[88:91], v[56:59], v[192:195]
v_fma_f32 v27, v29, v29, v27
v_mfma_f32_16x16x32_bf16 v[196:199], v[92:95], v[56:59], v[196:199]
v_fma_f32 v28, v30, v30, v28
v_mfma_f32_16x16x32_bf16 v[216:219], v[36:39], v[56:59], v[216:219]
s_waitcnt lgkmcnt(0)
s_waitcnt vmcnt(12)
s_waitcnt vmcnt(7)
s_barrier
v_mfma_f32_16x16x32_bf16 v[120:123], v[60:63], v[96:99], v[120:123]
ds_read_b128 v[80:83], v14 offset:24576
v_lshlrev_b32 v29, 16, v116
v_and_b32 v30, s59, v116
v_mfma_f32_16x16x32_bf16 v[124:127], v[60:63], v[100:103], v[124:127]
ds_read_b128 v[84:87], v14 offset:26624
v_add_f32 v25, v25, v29
v_mfma_f32_16x16x32_bf16 v[128:131], v[60:63], v[104:107], v[128:131]
ds_read_b128 v[88:91], v14 offset:28672
v_add_f32 v26, v26, v30
s_add_u32 m0, s42, 32768
s_add_u32 s75, s75, s46
buffer_load_dwordx4 v13, s[16:19], s75 offen sc1 lds
v_mfma_f32_16x16x32_bf16 v[132:135], v[60:63], v[108:111], v[132:135]
ds_read_b128 v[92:95], v14 offset:30720
v_fma_f32 v27, v29, v29, v27
v_mfma_f32_16x16x32_bf16 v[136:139], v[96:99], v[64:67], v[136:139]
ds_read_b64_tr_b16 v[40:41], v16 offset:24576
v_fma_f32 v28, v30, v30, v28
v_mfma_f32_16x16x32_bf16 v[140:143], v[100:103], v[64:67], v[140:143]
ds_read_b64_tr_b16 v[42:43], v16 offset:25088
v_lshlrev_b32 v29, 16, v117
v_and_b32 v30, s59, v117
v_mfma_f32_16x16x32_bf16 v[144:147], v[104:107], v[64:67], v[144:147]
ds_read_b128 v[112:115], v31 offset:24576
v_add_f32 v25, v25, v29
v_mfma_f32_16x16x32_bf16 v[148:151], v[108:111], v[64:67], v[148:151]
ds_read_b64_tr_b16 v[44:45], v21 offset:16384
v_add_f32 v26, v26, v30
v_mfma_f32_16x16x32_bf16 v[152:155], v[96:99], v[68:71], v[152:155]
ds_read_b64_tr_b16 v[46:47], v21 offset:17408
v_fma_f32 v27, v29, v29, v27
v_mfma_f32_16x16x32_bf16 v[156:159], v[100:103], v[68:71], v[156:159]
ds_read_b64_tr_b16 v[48:49], v22 offset:16384
v_fma_f32 v28, v30, v30, v28
v_mfma_f32_16x16x32_bf16 v[160:163], v[104:107], v[68:71], v[160:163]
ds_read_b64_tr_b16 v[50:51], v22 offset:17408
v_lshlrev_b32 v29, 16, v118
v_and_b32 v30, s59, v118
v_mfma_f32_16x16x32_bf16 v[164:167], v[108:111], v[68:71], v[164:167]
ds_read_b64_tr_b16 v[52:53], v23 offset:16384
v_add_f32 v25, v25, v29
s_add_u32 m0, s42, 40960
s_add_u32 s76, s76, s46
buffer_load_dwordx4 v13, s[20:23], s76 offen sc1 lds
v_mfma_f32_16x16x32_bf16 v[168:171], v[96:99], v[72:75], v[168:171]
ds_read_b64_tr_b16 v[54:55], v23 offset:17408
v_add_f32 v26, v26, v30
v_mfma_f32_16x16x32_bf16 v[172:175], v[100:103], v[72:75], v[172:175]
ds_read_b64_tr_b16 v[56:57], v24 offset:16384
v_fma_f32 v27, v29, v29, v27
v_mfma_f32_16x16x32_bf16 v[176:179], v[104:107], v[72:75], v[176:179]
ds_read_b64_tr_b16 v[58:59], v24 offset:17408
v_fma_f32 v28, v30, v30, v28
v_mfma_f32_16x16x32_bf16 v[180:183], v[108:111], v[72:75], v[180:183]
v_lshlrev_b32 v29, 16, v119
v_and_b32 v30, s59, v119
v_mfma_f32_16x16x32_bf16 v[184:187], v[96:99], v[76:79], v[184:187]
v_add_f32 v25, v25, v29
v_mfma_f32_16x16x32_bf16 v[188:191], v[100:103], v[76:79], v[188:191]
v_add_f32 v26, v26, v30
v_mfma_f32_16x16x32_bf16 v[192:195], v[104:107], v[76:79], v[192:195]
v_fma_f32 v27, v29, v29, v27
v_mfma_f32_16x16x32_bf16 v[196:199], v[108:111], v[76:79], v[196:199]
v_fma_f32 v28, v30, v30, v28
s_waitcnt lgkmcnt(0)
s_barrier
v_mfma_f32_16x16x32_bf16 v[120:123], v[40:43], v[80:83], v[120:123]
ds_read_b128 v[96:99], v15 offset:24576
v_lshlrev_b32 v29, 16, v112
v_mfma_f32_16x16x32_bf16 v[124:127], v[40:43], v[84:87], v[124:127]
ds_read_b128 v[100:103], v15 offset:26624
v_and_b32 v30, s59, v112
v_mfma_f32_16x16x32_bf16 v[128:131], v[40:43], v[88:91], v[128:131]
ds_read_b128 v[104:107], v15 offset:28672
v_add_f32 v25, v25, v29
s_add_u32 m0, s42, 49152
s_add_u32 s75, s75, s46
buffer_load_dwordx4 v13, s[16:19], s75 offen sc1 lds
v_mfma_f32_16x16x32_bf16 v[132:135], v[40:43], v[92:95], v[132:135]
ds_read_b128 v[108:111], v15 offset:30720
v_add_f32 v26, v26, v30
v_mfma_f32_16x16x32_bf16 v[200:203], v[40:43], v[36:39], v[200:203]
ds_read_b64_tr_b16 v[60:61], v16 offset:28672
v_fma_f32 v27, v29, v29, v27
v_mfma_f32_16x16x32_bf16 v[136:139], v[80:83], v[44:47], v[136:139]
ds_read_b64_tr_b16 v[62:63], v16 offset:29184
v_fma_f32 v28, v30, v30, v28
v_mfma_f32_16x16x32_bf16 v[140:143], v[84:87], v[44:47], v[140:143]
ds_read_b128 v[116:119], v32 offset:24576
v_lshlrev_b32 v29, 16, v113
v_mfma_f32_16x16x32_bf16 v[144:147], v[88:91], v[44:47], v[144:147]
ds_read_b64_tr_b16 v[64:65], v21 offset:32768
v_and_b32 v30, s59, v113
s_add_u32 m0, s42, 57344
s_add_u32 s76, s76, s46
buffer_load_dwordx4 v13, s[20:23], s76 offen sc1 lds
v_mfma_f32_16x16x32_bf16 v[148:151], v[92:95], v[44:47], v[148:151]
ds_read_b64_tr_b16 v[66:67], v21 offset:33792
v_add_f32 v25, v25, v29
v_mfma_f32_16x16x32_bf16 v[204:207], v[36:39], v[44:47], v[204:207]
ds_read_b64_tr_b16 v[68:69], v22 offset:32768
v_add_f32 v26, v26, v30
v_mfma_f32_16x16x32_bf16 v[152:155], v[80:83], v[48:51], v[152:155]
ds_read_b64_tr_b16 v[70:71], v22 offset:33792
v_fma_f32 v27, v29, v29, v27
v_mfma_f32_16x16x32_bf16 v[156:159], v[84:87], v[48:51], v[156:159]
ds_read_b64_tr_b16 v[72:73], v23 offset:32768
v_fma_f32 v28, v30, v30, v28
v_mfma_f32_16x16x32_bf16 v[160:163], v[88:91], v[48:51], v[160:163]
ds_read_b64_tr_b16 v[74:75], v23 offset:33792
v_lshlrev_b32 v29, 16, v114
s_add_u32 m0, s40, 0
s_add_u32 s82, s36, 768
buffer_load_dwordx4 v10, s[8:11], s82 offen sc1 lds
v_mfma_f32_16x16x32_bf16 v[164:167], v[92:95], v[48:51], v[164:167]
ds_read_b64_tr_b16 v[76:77], v24 offset:32768
v_and_b32 v30, s59, v114
v_mfma_f32_16x16x32_bf16 v[208:211], v[36:39], v[48:51], v[208:211]
ds_read_b64_tr_b16 v[78:79], v24 offset:33792
v_add_f32 v25, v25, v29
v_mfma_f32_16x16x32_bf16 v[168:171], v[80:83], v[52:55], v[168:171]
v_add_f32 v26, v26, v30
v_mfma_f32_16x16x32_bf16 v[172:175], v[84:87], v[52:55], v[172:175]
v_fma_f32 v27, v29, v29, v27
v_mfma_f32_16x16x32_bf16 v[176:179], v[88:91], v[52:55], v[176:179]
v_fma_f32 v28, v30, v30, v28
s_add_u32 m0, s40, 1024
s_add_u32 s33, s37, 1179648
buffer_load_dwordx4 v11, s[8:11], s82 offen sc1 lds
s_add_u32 m0, s41, 0
s_nop 0
buffer_load_dwordx4 v12, s[12:15], s33 offen sc1 lds
v_mfma_f32_16x16x32_bf16 v[180:183], v[92:95], v[52:55], v[180:183]
v_lshlrev_b32 v29, 16, v115
v_mfma_f32_16x16x32_bf16 v[212:215], v[36:39], v[52:55], v[212:215]
v_and_b32 v30, s59, v115
v_mfma_f32_16x16x32_bf16 v[184:187], v[80:83], v[56:59], v[184:187]
v_add_f32 v25, v25, v29
v_mfma_f32_16x16x32_bf16 v[188:191], v[84:87], v[56:59], v[188:191]
v_add_f32 v26, v26, v30
v_mfma_f32_16x16x32_bf16 v[192:195], v[88:91], v[56:59], v[192:195]
v_fma_f32 v27, v29, v29, v27
v_mfma_f32_16x16x32_bf16 v[196:199], v[92:95], v[56:59], v[196:199]
v_fma_f32 v28, v30, v30, v28
v_mfma_f32_16x16x32_bf16 v[216:219], v[36:39], v[56:59], v[216:219]
s_waitcnt lgkmcnt(0)
s_waitcnt vmcnt(12)
s_waitcnt vmcnt(7)
s_barrier
v_mfma_f32_16x16x32_bf16 v[120:123], v[60:63], v[96:99], v[120:123]
ds_read_b128 v[80:83], v14 offset:49152
v_lshlrev_b32 v29, 16, v116
v_and_b32 v30, s59, v116
v_mfma_f32_16x16x32_bf16 v[124:127], v[60:63], v[100:103], v[124:127]
ds_read_b128 v[84:87], v14 offset:51200
v_add_f32 v25, v25, v29
v_mfma_f32_16x16x32_bf16 v[128:131], v[60:63], v[104:107], v[128:131]
ds_read_b128 v[88:91], v14 offset:53248
v_add_f32 v26, v26, v30
s_add_u32 m0, s42, 65536
s_add_u32 s75, s75, s46
buffer_load_dwordx4 v13, s[16:19], s75 offen sc1 lds
v_mfma_f32_16x16x32_bf16 v[132:135], v[60:63], v[108:111], v[132:135]
ds_read_b128 v[92:95], v14 offset:55296
v_fma_f32 v27, v29, v29, v27
v_mfma_f32_16x16x32_bf16 v[136:139], v[96:99], v[64:67], v[136:139]
ds_read_b64_tr_b16 v[40:41], v16 offset:49152
v_fma_f32 v28, v30, v30, v28
v_mfma_f32_16x16x32_bf16 v[140:143], v[100:103], v[64:67], v[140:143]
ds_read_b64_tr_b16 v[42:43], v16 offset:49664
v_lshlrev_b32 v29, 16, v117
v_and_b32 v30, s59, v117
v_mfma_f32_16x16x32_bf16 v[144:147], v[104:107], v[64:67], v[144:147]
ds_read_b128 v[112:115], v31 offset:49152
v_add_f32 v25, v25, v29
v_mfma_f32_16x16x32_bf16 v[148:151], v[108:111], v[64:67], v[148:151]
ds_read_b64_tr_b16 v[44:45], v17 offset:0
v_add_f32 v26, v26, v30
v_mfma_f32_16x16x32_bf16 v[152:155], v[96:99], v[68:71], v[152:155]
ds_read_b64_tr_b16 v[46:47], v17 offset:1024
v_fma_f32 v27, v29, v29, v27
v_mfma_f32_16x16x32_bf16 v[156:159], v[100:103], v[68:71], v[156:159]
ds_read_b64_tr_b16 v[48:49], v18 offset:0
v_fma_f32 v28, v30, v30, v28
v_mfma_f32_16x16x32_bf16 v[160:163], v[104:107], v[68:71], v[160:163]
ds_read_b64_tr_b16 v[50:51], v18 offset:1024
v_lshlrev_b32 v29, 16, v118
v_and_b32 v30, s59, v118
v_mfma_f32_16x16x32_bf16 v[164:167], v[108:111], v[68:71], v[164:167]
ds_read_b64_tr_b16 v[52:53], v19 offset:0
v_add_f32 v25, v25, v29
s_add_u32 m0, s42, 73728
s_add_u32 s76, s76, s46
buffer_load_dwordx4 v13, s[20:23], s76 offen sc1 lds
v_mfma_f32_16x16x32_bf16 v[168:171], v[96:99], v[72:75], v[168:171]
ds_read_b64_tr_b16 v[54:55], v19 offset:1024
v_add_f32 v26, v26, v30
v_mfma_f32_16x16x32_bf16 v[172:175], v[100:103], v[72:75], v[172:175]
ds_read_b64_tr_b16 v[56:57], v20 offset:0
v_fma_f32 v27, v29, v29, v27
v_mfma_f32_16x16x32_bf16 v[176:179], v[104:107], v[72:75], v[176:179]
ds_read_b64_tr_b16 v[58:59], v20 offset:1024
v_fma_f32 v28, v30, v30, v28
v_mfma_f32_16x16x32_bf16 v[180:183], v[108:111], v[72:75], v[180:183]
v_lshlrev_b32 v29, 16, v119
v_and_b32 v30, s59, v119
v_mfma_f32_16x16x32_bf16 v[184:187], v[96:99], v[76:79], v[184:187]
v_add_f32 v25, v25, v29
v_mfma_f32_16x16x32_bf16 v[188:191], v[100:103], v[76:79], v[188:191]
v_add_f32 v26, v26, v30
v_mfma_f32_16x16x32_bf16 v[192:195], v[104:107], v[76:79], v[192:195]
v_fma_f32 v27, v29, v29, v27
v_mfma_f32_16x16x32_bf16 v[196:199], v[108:111], v[76:79], v[196:199]
v_fma_f32 v28, v30, v30, v28
s_waitcnt lgkmcnt(0)
s_barrier
v_lshlrev_b32 v8, 2, v1
s_mov_b64 exec, 3
buffer_load_dword v9, v8, s[96:99], 0 offen sc1
s_mov_b64 exec, -1
v_mfma_f32_16x16x32_bf16 v[120:123], v[40:43], v[80:83], v[120:123]
ds_read_b128 v[96:99], v15 offset:49152
v_lshlrev_b32 v29, 16, v112
v_mfma_f32_16x16x32_bf16 v[124:127], v[40:43], v[84:87], v[124:127]
ds_read_b128 v[100:103], v15 offset:51200
v_and_b32 v30, s59, v112
v_mfma_f32_16x16x32_bf16 v[128:131], v[40:43], v[88:91], v[128:131]
ds_read_b128 v[104:107], v15 offset:53248
v_add_f32 v25, v25, v29
s_add_u32 m0, s42, 0
s_add_u32 s75, s75, s46
buffer_load_dwordx4 v13, s[16:19], s75 offen sc1 lds
v_mfma_f32_16x16x32_bf16 v[132:135], v[40:43], v[92:95], v[132:135]
ds_read_b128 v[108:111], v15 offset:55296
v_add_f32 v26, v26, v30
v_mfma_f32_16x16x32_bf16 v[200:203], v[40:43], v[36:39], v[200:203]
ds_read_b64_tr_b16 v[60:61], v16 offset:53248
v_fma_f32 v27, v29, v29, v27
v_mfma_f32_16x16x32_bf16 v[136:139], v[80:83], v[44:47], v[136:139]
ds_read_b64_tr_b16 v[62:63], v16 offset:53760
v_fma_f32 v28, v30, v30, v28
v_mfma_f32_16x16x32_bf16 v[140:143], v[84:87], v[44:47], v[140:143]
ds_read_b128 v[116:119], v32 offset:49152
v_lshlrev_b32 v29, 16, v113
v_mfma_f32_16x16x32_bf16 v[144:147], v[88:91], v[44:47], v[144:147]
ds_read_b64_tr_b16 v[64:65], v17 offset:16384
v_and_b32 v30, s59, v113
s_add_u32 m0, s42, 8192
s_add_u32 s76, s76, s46
buffer_load_dwordx4 v13, s[20:23], s76 offen sc1 lds
v_mfma_f32_16x16x32_bf16 v[148:151], v[92:95], v[44:47], v[148:151]
ds_read_b64_tr_b16 v[66:67], v17 offset:17408
v_add_f32 v25, v25, v29
v_mfma_f32_16x16x32_bf16 v[204:207], v[36:39], v[44:47], v[204:207]
ds_read_b64_tr_b16 v[68:69], v18 offset:16384
v_add_f32 v26, v26, v30
v_mfma_f32_16x16x32_bf16 v[152:155], v[80:83], v[48:51], v[152:155]
ds_read_b64_tr_b16 v[70:71], v18 offset:17408
v_fma_f32 v27, v29, v29, v27
v_mfma_f32_16x16x32_bf16 v[156:159], v[84:87], v[48:51], v[156:159]
ds_read_b64_tr_b16 v[72:73], v19 offset:16384
v_fma_f32 v28, v30, v30, v28
v_mfma_f32_16x16x32_bf16 v[160:163], v[88:91], v[48:51], v[160:163]
ds_read_b64_tr_b16 v[74:75], v19 offset:17408
v_lshlrev_b32 v29, 16, v114
s_add_u32 m0, s40, 24576
s_add_u32 s82, s36, 896
buffer_load_dwordx4 v10, s[8:11], s82 offen sc1 lds
v_mfma_f32_16x16x32_bf16 v[164:167], v[92:95], v[48:51], v[164:167]
ds_read_b64_tr_b16 v[76:77], v20 offset:16384
v_and_b32 v30, s59, v114
v_mfma_f32_16x16x32_bf16 v[208:211], v[36:39], v[48:51], v[208:211]
ds_read_b64_tr_b16 v[78:79], v20 offset:17408
v_add_f32 v25, v25, v29
v_mfma_f32_16x16x32_bf16 v[168:171], v[80:83], v[52:55], v[168:171]
v_add_f32 v26, v26, v30
v_mfma_f32_16x16x32_bf16 v[172:175], v[84:87], v[52:55], v[172:175]
v_fma_f32 v27, v29, v29, v27
v_mfma_f32_16x16x32_bf16 v[176:179], v[88:91], v[52:55], v[176:179]
v_fma_f32 v28, v30, v30, v28
s_add_u32 m0, s40, 25600
s_add_u32 s33, s37, 1376256
buffer_load_dwordx4 v11, s[8:11], s82 offen sc1 lds
s_add_u32 m0, s41, 24576
s_nop 0
buffer_load_dwordx4 v12, s[12:15], s33 offen sc1 lds
v_mfma_f32_16x16x32_bf16 v[180:183], v[92:95], v[52:55], v[180:183]
v_lshlrev_b32 v29, 16, v115
v_mfma_f32_16x16x32_bf16 v[212:215], v[36:39], v[52:55], v[212:215]
v_and_b32 v30, s59, v115
v_mfma_f32_16x16x32_bf16 v[184:187], v[80:83], v[56:59], v[184:187]
v_add_f32 v25, v25, v29
v_mfma_f32_16x16x32_bf16 v[188:191], v[84:87], v[56:59], v[188:191]
v_add_f32 v26, v26, v30
v_mfma_f32_16x16x32_bf16 v[192:195], v[88:91], v[56:59], v[192:195]
v_fma_f32 v27, v29, v29, v27
v_mfma_f32_16x16x32_bf16 v[196:199], v[92:95], v[56:59], v[196:199]
v_fma_f32 v28, v30, v30, v28
v_mfma_f32_16x16x32_bf16 v[216:219], v[36:39], v[56:59], v[216:219]
s_waitcnt lgkmcnt(0)
s_waitcnt vmcnt(13)
s_waitcnt vmcnt(8)
s_barrier
v_mfma_f32_16x16x32_bf16 v[120:123], v[60:63], v[96:99], v[120:123]
ds_read_b128 v[80:83], v14 offset:0
v_lshlrev_b32 v29, 16, v116
v_and_b32 v30, s59, v116
v_mfma_f32_16x16x32_bf16 v[124:127], v[60:63], v[100:103], v[124:127]
ds_read_b128 v[84:87], v14 offset:2048
v_add_f32 v25, v25, v29
v_mfma_f32_16x16x32_bf16 v[128:131], v[60:63], v[104:107], v[128:131]
ds_read_b128 v[88:91], v14 offset:4096
v_add_f32 v26, v26, v30
v_mfma_f32_16x16x32_bf16 v[132:135], v[60:63], v[108:111], v[132:135]
ds_read_b128 v[92:95], v14 offset:6144
v_fma_f32 v27, v29, v29, v27
v_mfma_f32_16x16x32_bf16 v[136:139], v[96:99], v[64:67], v[136:139]
ds_read_b64_tr_b16 v[40:41], v16 offset:0
v_fma_f32 v28, v30, v30, v28
v_mfma_f32_16x16x32_bf16 v[140:143], v[100:103], v[64:67], v[140:143]
ds_read_b64_tr_b16 v[42:43], v16 offset:512
v_lshlrev_b32 v29, 16, v117
v_and_b32 v30, s59, v117
v_mfma_f32_16x16x32_bf16 v[144:147], v[104:107], v[64:67], v[144:147]
ds_read_b128 v[112:115], v31 offset:0
v_add_f32 v25, v25, v29
v_mfma_f32_16x16x32_bf16 v[148:151], v[108:111], v[64:67], v[148:151]
ds_read_b64_tr_b16 v[44:45], v21 offset:0
v_add_f32 v26, v26, v30
v_mfma_f32_16x16x32_bf16 v[152:155], v[96:99], v[68:71], v[152:155]
ds_read_b64_tr_b16 v[46:47], v21 offset:1024
v_fma_f32 v27, v29, v29, v27
v_mfma_f32_16x16x32_bf16 v[156:159], v[100:103], v[68:71], v[156:159]
ds_read_b64_tr_b16 v[48:49], v22 offset:0
v_fma_f32 v28, v30, v30, v28
v_mfma_f32_16x16x32_bf16 v[160:163], v[104:107], v[68:71], v[160:163]
ds_read_b64_tr_b16 v[50:51], v22 offset:1024
v_lshlrev_b32 v29, 16, v118
v_and_b32 v30, s59, v118
v_mfma_f32_16x16x32_bf16 v[164:167], v[108:111], v[68:71], v[164:167]
ds_read_b64_tr_b16 v[52:53], v23 offset:0
v_add_f32 v25, v25, v29
v_mfma_f32_16x16x32_bf16 v[168:171], v[96:99], v[72:75], v[168:171]
ds_read_b64_tr_b16 v[54:55], v23 offset:1024
v_add_f32 v26, v26, v30
v_mfma_f32_16x16x32_bf16 v[172:175], v[100:103], v[72:75], v[172:175]
ds_read_b64_tr_b16 v[56:57], v24 offset:0
v_fma_f32 v27, v29, v29, v27
v_mfma_f32_16x16x32_bf16 v[176:179], v[104:107], v[72:75], v[176:179]
ds_read_b64_tr_b16 v[58:59], v24 offset:1024
v_fma_f32 v28, v30, v30, v28
v_mfma_f32_16x16x32_bf16 v[180:183], v[108:111], v[72:75], v[180:183]
v_lshlrev_b32 v29, 16, v119
v_and_b32 v30, s59, v119
v_mfma_f32_16x16x32_bf16 v[184:187], v[96:99], v[76:79], v[184:187]
v_add_f32 v25, v25, v29
v_mfma_f32_16x16x32_bf16 v[188:191], v[100:103], v[76:79], v[188:191]
v_add_f32 v26, v26, v30
v_mfma_f32_16x16x32_bf16 v[192:195], v[104:107], v[76:79], v[192:195]
v_fma_f32 v27, v29, v29, v27
v_mfma_f32_16x16x32_bf16 v[196:199], v[108:111], v[76:79], v[196:199]
v_fma_f32 v28, v30, v30, v28
s_waitcnt lgkmcnt(0)
s_barrier
v_mfma_f32_16x16x32_bf16 v[120:123], v[40:43], v[80:83], v[120:123]
ds_read_b128 v[96:99], v15 offset:0
v_lshlrev_b32 v29, 16, v112
v_mfma_f32_16x16x32_bf16 v[124:127], v[40:43], v[84:87], v[124:127]
ds_read_b128 v[100:103], v15 offset:2048
v_and_b32 v30, s59, v112
v_mfma_f32_16x16x32_bf16 v[128:131], v[40:43], v[88:91], v[128:131]
ds_read_b128 v[104:107], v15 offset:4096
v_add_f32 v25, v25, v29
v_mfma_f32_16x16x32_bf16 v[132:135], v[40:43], v[92:95], v[132:135]
ds_read_b128 v[108:111], v15 offset:6144
v_add_f32 v26, v26, v30
v_mfma_f32_16x16x32_bf16 v[200:203], v[40:43], v[36:39], v[200:203]
ds_read_b64_tr_b16 v[60:61], v16 offset:4096
v_fma_f32 v27, v29, v29, v27
v_mfma_f32_16x16x32_bf16 v[136:139], v[80:83], v[44:47], v[136:139]
ds_read_b64_tr_b16 v[62:63], v16 offset:4608
v_fma_f32 v28, v30, v30, v28
v_mfma_f32_16x16x32_bf16 v[140:143], v[84:87], v[44:47], v[140:143]
ds_read_b128 v[116:119], v32 offset:0
v_lshlrev_b32 v29, 16, v113
v_mfma_f32_16x16x32_bf16 v[144:147], v[88:91], v[44:47], v[144:147]
ds_read_b64_tr_b16 v[64:65], v21 offset:16384
v_and_b32 v30, s59, v113
v_mfma_f32_16x16x32_bf16 v[148:151], v[92:95], v[44:47], v[148:151]
ds_read_b64_tr_b16 v[66:67], v21 offset:17408
v_add_f32 v25, v25, v29
v_mfma_f32_16x16x32_bf16 v[204:207], v[36:39], v[44:47], v[204:207]
ds_read_b64_tr_b16 v[68:69], v22 offset:16384
v_add_f32 v26, v26, v30
v_mfma_f32_16x16x32_bf16 v[152:155], v[80:83], v[48:51], v[152:155]
ds_read_b64_tr_b16 v[70:71], v22 offset:17408
v_fma_f32 v27, v29, v29, v27
v_mfma_f32_16x16x32_bf16 v[156:159], v[84:87], v[48:51], v[156:159]
ds_read_b64_tr_b16 v[72:73], v23 offset:16384
v_fma_f32 v28, v30, v30, v28
v_mfma_f32_16x16x32_bf16 v[160:163], v[88:91], v[48:51], v[160:163]
ds_read_b64_tr_b16 v[74:75], v23 offset:17408
v_lshlrev_b32 v29, 16, v114
v_mfma_f32_16x16x32_bf16 v[164:167], v[92:95], v[48:51], v[164:167]
ds_read_b64_tr_b16 v[76:77], v24 offset:16384
v_and_b32 v30, s59, v114
v_mfma_f32_16x16x32_bf16 v[208:211], v[36:39], v[48:51], v[208:211]
ds_read_b64_tr_b16 v[78:79], v24 offset:17408
v_add_f32 v25, v25, v29
v_mfma_f32_16x16x32_bf16 v[168:171], v[80:83], v[52:55], v[168:171]
v_add_f32 v26, v26, v30
v_mfma_f32_16x16x32_bf16 v[172:175], v[84:87], v[52:55], v[172:175]
v_fma_f32 v27, v29, v29, v27
v_mfma_f32_16x16x32_bf16 v[176:179], v[88:91], v[52:55], v[176:179]
v_fma_f32 v28, v30, v30, v28
v_mfma_f32_16x16x32_bf16 v[180:183], v[92:95], v[52:55], v[180:183]
v_lshlrev_b32 v29, 16, v115
v_mfma_f32_16x16x32_bf16 v[212:215], v[36:39], v[52:55], v[212:215]
v_and_b32 v30, s59, v115
v_mfma_f32_16x16x32_bf16 v[184:187], v[80:83], v[56:59], v[184:187]
v_add_f32 v25, v25, v29
v_mfma_f32_16x16x32_bf16 v[188:191], v[84:87], v[56:59], v[188:191]
v_add_f32 v26, v26, v30
v_mfma_f32_16x16x32_bf16 v[192:195], v[88:91], v[56:59], v[192:195]
v_fma_f32 v27, v29, v29, v27
v_mfma_f32_16x16x32_bf16 v[196:199], v[92:95], v[56:59], v[196:199]
v_fma_f32 v28, v30, v30, v28
v_mfma_f32_16x16x32_bf16 v[216:219], v[36:39], v[56:59], v[216:219]
s_waitcnt lgkmcnt(0)
s_waitcnt vmcnt(6)
s_waitcnt vmcnt(0)
s_barrier
v_mfma_f32_16x16x32_bf16 v[120:123], v[60:63], v[96:99], v[120:123]
ds_read_b128 v[80:83], v14 offset:24576
v_lshlrev_b32 v29, 16, v116
v_and_b32 v30, s59, v116
v_mfma_f32_16x16x32_bf16 v[124:127], v[60:63], v[100:103], v[124:127]
ds_read_b128 v[84:87], v14 offset:26624
v_add_f32 v25, v25, v29
v_mfma_f32_16x16x32_bf16 v[128:131], v[60:63], v[104:107], v[128:131]
ds_read_b128 v[88:91], v14 offset:28672
v_add_f32 v26, v26, v30
v_mfma_f32_16x16x32_bf16 v[132:135], v[60:63], v[108:111], v[132:135]
ds_read_b128 v[92:95], v14 offset:30720
v_fma_f32 v27, v29, v29, v27
v_mfma_f32_16x16x32_bf16 v[136:139], v[96:99], v[64:67], v[136:139]
ds_read_b64_tr_b16 v[40:41], v16 offset:24576
v_fma_f32 v28, v30, v30, v28
v_mfma_f32_16x16x32_bf16 v[140:143], v[100:103], v[64:67], v[140:143]
ds_read_b64_tr_b16 v[42:43], v16 offset:25088
v_lshlrev_b32 v29, 16, v117
v_and_b32 v30, s59, v117
v_mfma_f32_16x16x32_bf16 v[144:147], v[104:107], v[64:67], v[144:147]
ds_read_b128 v[112:115], v31 offset:24576
v_add_f32 v25, v25, v29
v_mfma_f32_16x16x32_bf16 v[148:151], v[108:111], v[64:67], v[148:151]
ds_read_b64_tr_b16 v[44:45], v21 offset:32768
v_add_f32 v26, v26, v30
v_mfma_f32_16x16x32_bf16 v[152:155], v[96:99], v[68:71], v[152:155]
ds_read_b64_tr_b16 v[46:47], v21 offset:33792
v_fma_f32 v27, v29, v29, v27
v_mfma_f32_16x16x32_bf16 v[156:159], v[100:103], v[68:71], v[156:159]
ds_read_b64_tr_b16 v[48:49], v22 offset:32768
v_fma_f32 v28, v30, v30, v28
v_mfma_f32_16x16x32_bf16 v[160:163], v[104:107], v[68:71], v[160:163]
ds_read_b64_tr_b16 v[50:51], v22 offset:33792
v_lshlrev_b32 v29, 16, v118
v_and_b32 v30, s59, v118
v_mfma_f32_16x16x32_bf16 v[164:167], v[108:111], v[68:71], v[164:167]
ds_read_b64_tr_b16 v[52:53], v23 offset:32768
v_add_f32 v25, v25, v29
v_mfma_f32_16x16x32_bf16 v[168:171], v[96:99], v[72:75], v[168:171]
ds_read_b64_tr_b16 v[54:55], v23 offset:33792
v_add_f32 v26, v26, v30
v_mfma_f32_16x16x32_bf16 v[172:175], v[100:103], v[72:75], v[172:175]
ds_read_b64_tr_b16 v[56:57], v24 offset:32768
v_fma_f32 v27, v29, v29, v27
v_mfma_f32_16x16x32_bf16 v[176:179], v[104:107], v[72:75], v[176:179]
ds_read_b64_tr_b16 v[58:59], v24 offset:33792
v_fma_f32 v28, v30, v30, v28
v_mfma_f32_16x16x32_bf16 v[180:183], v[108:111], v[72:75], v[180:183]
v_lshlrev_b32 v29, 16, v119
v_and_b32 v30, s59, v119
v_mfma_f32_16x16x32_bf16 v[184:187], v[96:99], v[76:79], v[184:187]
v_add_f32 v25, v25, v29
v_mfma_f32_16x16x32_bf16 v[188:191], v[100:103], v[76:79], v[188:191]
v_add_f32 v26, v26, v30
v_mfma_f32_16x16x32_bf16 v[192:195], v[104:107], v[76:79], v[192:195]
v_fma_f32 v27, v29, v29, v27
v_mfma_f32_16x16x32_bf16 v[196:199], v[108:111], v[76:79], v[196:199]
v_fma_f32 v28, v30, v30, v28
s_waitcnt lgkmcnt(0)
s_barrier
v_mfma_f32_16x16x32_bf16 v[120:123], v[40:43], v[80:83], v[120:123]
ds_read_b128 v[96:99], v15 offset:24576
v_lshlrev_b32 v29, 16, v112
v_mfma_f32_16x16x32_bf16 v[124:127], v[40:43], v[84:87], v[124:127]
ds_read_b128 v[100:103], v15 offset:26624
v_and_b32 v30, s59, v112
v_mfma_f32_16x16x32_bf16 v[128:131], v[40:43], v[88:91], v[128:131]
ds_read_b128 v[104:107], v15 offset:28672
v_add_f32 v25, v25, v29
v_mfma_f32_16x16x32_bf16 v[132:135], v[40:43], v[92:95], v[132:135]
ds_read_b128 v[108:111], v15 offset:30720
v_add_f32 v26, v26, v30
v_mfma_f32_16x16x32_bf16 v[200:203], v[40:43], v[36:39], v[200:203]
ds_read_b64_tr_b16 v[60:61], v16 offset:28672
v_fma_f32 v27, v29, v29, v27
v_mfma_f32_16x16x32_bf16 v[136:139], v[80:83], v[44:47], v[136:139]
ds_read_b64_tr_b16 v[62:63], v16 offset:29184
v_fma_f32 v28, v30, v30, v28
v_mfma_f32_16x16x32_bf16 v[140:143], v[84:87], v[44:47], v[140:143]
ds_read_b128 v[116:119], v32 offset:24576
v_lshlrev_b32 v29, 16, v113
v_mfma_f32_16x16x32_bf16 v[144:147], v[88:91], v[44:47], v[144:147]
ds_read_b64_tr_b16 v[64:65], v17 offset:0
v_and_b32 v30, s59, v113
v_mfma_f32_16x16x32_bf16 v[148:151], v[92:95], v[44:47], v[148:151]
ds_read_b64_tr_b16 v[66:67], v17 offset:1024
v_add_f32 v25, v25, v29
v_mfma_f32_16x16x32_bf16 v[204:207], v[36:39], v[44:47], v[204:207]
ds_read_b64_tr_b16 v[68:69], v18 offset:0
v_add_f32 v26, v26, v30
v_mfma_f32_16x16x32_bf16 v[152:155], v[80:83], v[48:51], v[152:155]
ds_read_b64_tr_b16 v[70:71], v18 offset:1024
v_fma_f32 v27, v29, v29, v27
v_mfma_f32_16x16x32_bf16 v[156:159], v[84:87], v[48:51], v[156:159]
ds_read_b64_tr_b16 v[72:73], v19 offset:0
v_fma_f32 v28, v30, v30, v28
v_mfma_f32_16x16x32_bf16 v[160:163], v[88:91], v[48:51], v[160:163]
ds_read_b64_tr_b16 v[74:75], v19 offset:1024
v_lshlrev_b32 v29, 16, v114
v_mfma_f32_16x16x32_bf16 v[164:167], v[92:95], v[48:51], v[164:167]
ds_read_b64_tr_b16 v[76:77], v20 offset:0
v_and_b32 v30, s59, v114
v_mfma_f32_16x16x32_bf16 v[208:211], v[36:39], v[48:51], v[208:211]
ds_read_b64_tr_b16 v[78:79], v20 offset:1024
v_add_f32 v25, v25, v29
v_mfma_f32_16x16x32_bf16 v[168:171], v[80:83], v[52:55], v[168:171]
v_add_f32 v26, v26, v30
v_mfma_f32_16x16x32_bf16 v[172:175], v[84:87], v[52:55], v[172:175]
v_fma_f32 v27, v29, v29, v27
v_mfma_f32_16x16x32_bf16 v[176:179], v[88:91], v[52:55], v[176:179]
v_fma_f32 v28, v30, v30, v28
v_mfma_f32_16x16x32_bf16 v[180:183], v[92:95], v[52:55], v[180:183]
v_lshlrev_b32 v29, 16, v115
v_mfma_f32_16x16x32_bf16 v[212:215], v[36:39], v[52:55], v[212:215]
v_and_b32 v30, s59, v115
v_mfma_f32_16x16x32_bf16 v[184:187], v[80:83], v[56:59], v[184:187]
v_add_f32 v25, v25, v29
v_mfma_f32_16x16x32_bf16 v[188:191], v[84:87], v[56:59], v[188:191]
v_add_f32 v26, v26, v30
v_mfma_f32_16x16x32_bf16 v[192:195], v[88:91], v[56:59], v[192:195]
v_fma_f32 v27, v29, v29, v27
v_mfma_f32_16x16x32_bf16 v[196:199], v[92:95], v[56:59], v[196:199]
v_fma_f32 v28, v30, v30, v28
v_mfma_f32_16x16x32_bf16 v[216:219], v[36:39], v[56:59], v[216:219]
s_waitcnt lgkmcnt(0)
s_barrier
v_mfma_f32_16x16x32_bf16 v[120:123], v[60:63], v[96:99], v[120:123]
v_lshlrev_b32 v29, 16, v116
v_and_b32 v30, s59, v116
v_mfma_f32_16x16x32_bf16 v[124:127], v[60:63], v[100:103], v[124:127]
v_add_f32 v25, v25, v29
v_mfma_f32_16x16x32_bf16 v[128:131], v[60:63], v[104:107], v[128:131]
v_add_f32 v26, v26, v30
v_mfma_f32_16x16x32_bf16 v[132:135], v[60:63], v[108:111], v[132:135]
v_fma_f32 v27, v29, v29, v27
v_mfma_f32_16x16x32_bf16 v[136:139], v[96:99], v[64:67], v[136:139]
v_fma_f32 v28, v30, v30, v28
v_mfma_f32_16x16x32_bf16 v[140:143], v[100:103], v[64:67], v[140:143]
v_lshlrev_b32 v29, 16, v117
v_and_b32 v30, s59, v117
v_mfma_f32_16x16x32_bf16 v[144:147], v[104:107], v[64:67], v[144:147]
v_add_f32 v25, v25, v29
v_mfma_f32_16x16x32_bf16 v[148:151], v[108:111], v[64:67], v[148:151]
v_add_f32 v26, v26, v30
v_mfma_f32_16x16x32_bf16 v[152:155], v[96:99], v[68:71], v[152:155]
v_fma_f32 v27, v29, v29, v27
v_mfma_f32_16x16x32_bf16 v[156:159], v[100:103], v[68:71], v[156:159]
v_fma_f32 v28, v30, v30, v28
v_mfma_f32_16x16x32_bf16 v[160:163], v[104:107], v[68:71], v[160:163]
v_lshlrev_b32 v29, 16, v118
v_and_b32 v30, s59, v118
v_mfma_f32_16x16x32_bf16 v[164:167], v[108:111], v[68:71], v[164:167]
v_add_f32 v25, v25, v29
v_mfma_f32_16x16x32_bf16 v[168:171], v[96:99], v[72:75], v[168:171]
v_add_f32 v26, v26, v30
v_mfma_f32_16x16x32_bf16 v[172:175], v[100:103], v[72:75], v[172:175]
v_fma_f32 v27, v29, v29, v27
v_mfma_f32_16x16x32_bf16 v[176:179], v[104:107], v[72:75], v[176:179]
v_fma_f32 v28, v30, v30, v28
v_mfma_f32_16x16x32_bf16 v[180:183], v[108:111], v[72:75], v[180:183]
v_lshlrev_b32 v29, 16, v119
v_and_b32 v30, s59, v119
v_mfma_f32_16x16x32_bf16 v[184:187], v[96:99], v[76:79], v[184:187]
v_add_f32 v25, v25, v29
v_mfma_f32_16x16x32_bf16 v[188:191], v[100:103], v[76:79], v[188:191]
v_add_f32 v26, v26, v30
v_mfma_f32_16x16x32_bf16 v[192:195], v[104:107], v[76:79], v[192:195]
v_fma_f32 v27, v29, v29, v27
v_mfma_f32_16x16x32_bf16 v[196:199], v[108:111], v[76:79], v[196:199]
v_fma_f32 v28, v30, v30, v28
s_branch parallel_sum__mha_block__geglu_ffn__prompt_kernel_Btail
parallel_sum__mha_block__geglu_ffn__prompt_kernel_B1:
s_waitcnt vmcnt(9)
s_waitcnt vmcnt(7)
s_waitcnt lgkmcnt(0)
s_barrier
ds_read_b128 v[80:83], v14 offset:0
ds_read_b128 v[84:87], v14 offset:2048
ds_read_b128 v[88:91], v14 offset:4096
ds_read_b128 v[92:95], v14 offset:6144
ds_read_b64_tr_b16 v[40:41], v16 offset:0
ds_read_b64_tr_b16 v[42:43], v16 offset:512
ds_read_b128 v[112:115], v31 offset:0
ds_read_b64_tr_b16 v[44:45], v17 offset:0
ds_read_b64_tr_b16 v[46:47], v17 offset:1024
ds_read_b64_tr_b16 v[48:49], v18 offset:0
ds_read_b64_tr_b16 v[50:51], v18 offset:1024
ds_read_b64_tr_b16 v[52:53], v19 offset:0
ds_read_b64_tr_b16 v[54:55], v19 offset:1024
ds_read_b64_tr_b16 v[56:57], v20 offset:0
ds_read_b64_tr_b16 v[58:59], v20 offset:1024
s_waitcnt lgkmcnt(0)
s_waitcnt vmcnt(5)
s_barrier
s_lshl_b32 s33, s28, 13
v_lshlrev_b32 v4, 7, v1
v_add_u32 v4, s33, v4
s_mov_b32 s33, parallel_sum__mha_block__geglu_ffn__prompt_kernel_end-parallel_sum__mha_block__geglu_ffn__prompt_kernel_pc-4
v_min_u32 v4, s33, v4
global_load_dword v235, v4, s[78:79]
v_mfma_f32_16x16x32_bf16 v[120:123], v[40:43], v[80:83], 0
ds_read_b128 v[96:99], v15 offset:0
v_lshlrev_b32 v29, 16, v112
v_and_b32 v30, s59, v112
v_mfma_f32_16x16x32_bf16 v[124:127], v[40:43], v[84:87], 0
ds_read_b128 v[100:103], v15 offset:2048
v_add_f32 v25, v25, v29
v_mfma_f32_16x16x32_bf16 v[128:131], v[40:43], v[88:91], 0
ds_read_b128 v[104:107], v15 offset:4096
v_add_f32 v26, v26, v30
s_add_u32 m0, s42, 49152
s_add_u32 s75, s75, s46
buffer_load_dwordx4 v13, s[16:19], s75 offen sc1 lds
v_mfma_f32_16x16x32_bf16 v[132:135], v[40:43], v[92:95], 0
ds_read_b128 v[108:111], v15 offset:6144
v_fma_f32 v27, v29, v29, v27
v_mfma_f32_16x16x32_bf16 v[136:139], v[80:83], v[44:47], 0
ds_read_b64_tr_b16 v[60:61], v16 offset:4096
v_fma_f32 v28, v30, v30, v28
v_mfma_f32_16x16x32_bf16 v[140:143], v[84:87], v[44:47], 0
ds_read_b64_tr_b16 v[62:63], v16 offset:4608
v_lshlrev_b32 v29, 16, v113
v_and_b32 v30, s59, v113
v_mfma_f32_16x16x32_bf16 v[144:147], v[88:91], v[44:47], 0
ds_read_b128 v[116:119], v32 offset:0
v_add_f32 v25, v25, v29
s_add_u32 m0, s42, 57344
s_add_u32 s76, s76, s46
buffer_load_dwordx4 v13, s[20:23], s76 offen sc1 lds
v_mfma_f32_16x16x32_bf16 v[148:151], v[92:95], v[44:47], 0
ds_read_b64_tr_b16 v[64:65], v17 offset:16384
v_add_f32 v26, v26, v30
v_mfma_f32_16x16x32_bf16 v[152:155], v[80:83], v[48:51], 0
ds_read_b64_tr_b16 v[66:67], v17 offset:17408
v_fma_f32 v27, v29, v29, v27
v_mfma_f32_16x16x32_bf16 v[156:159], v[84:87], v[48:51], 0
ds_read_b64_tr_b16 v[68:69], v18 offset:16384
v_fma_f32 v28, v30, v30, v28
v_mfma_f32_16x16x32_bf16 v[160:163], v[88:91], v[48:51], 0
ds_read_b64_tr_b16 v[70:71], v18 offset:17408
v_lshlrev_b32 v29, 16, v114
v_and_b32 v30, s59, v114
s_add_u32 m0, s40, 49152
s_add_u32 s82, s36, 256
buffer_load_dwordx4 v10, s[8:11], s82 offen sc1 lds
v_mfma_f32_16x16x32_bf16 v[164:167], v[92:95], v[48:51], 0
ds_read_b64_tr_b16 v[72:73], v19 offset:16384
v_add_f32 v25, v25, v29
v_mfma_f32_16x16x32_bf16 v[168:171], v[80:83], v[52:55], 0
ds_read_b64_tr_b16 v[74:75], v19 offset:17408
v_add_f32 v26, v26, v30
v_mfma_f32_16x16x32_bf16 v[172:175], v[84:87], v[52:55], 0
ds_read_b64_tr_b16 v[76:77], v20 offset:16384
v_fma_f32 v27, v29, v29, v27
v_mfma_f32_16x16x32_bf16 v[176:179], v[88:91], v[52:55], 0
ds_read_b64_tr_b16 v[78:79], v20 offset:17408
v_fma_f32 v28, v30, v30, v28
s_add_u32 m0, s40, 50176
s_add_u32 s33, s37, 393216
buffer_load_dwordx4 v11, s[8:11], s82 offen sc1 lds
s_add_u32 m0, s41, 49152
s_nop 0
buffer_load_dwordx4 v12, s[12:15], s33 offen sc1 lds
v_mfma_f32_16x16x32_bf16 v[180:183], v[92:95], v[52:55], 0
v_lshlrev_b32 v29, 16, v115
v_and_b32 v30, s59, v115
v_mfma_f32_16x16x32_bf16 v[184:187], v[80:83], v[56:59], 0
v_add_f32 v25, v25, v29
v_mfma_f32_16x16x32_bf16 v[188:191], v[84:87], v[56:59], 0
v_add_f32 v26, v26, v30
v_mfma_f32_16x16x32_bf16 v[192:195], v[88:91], v[56:59], 0
v_fma_f32 v27, v29, v29, v27
v_mfma_f32_16x16x32_bf16 v[196:199], v[92:95], v[56:59], 0
v_fma_f32 v28, v30, v30, v28
s_waitcnt lgkmcnt(0)
s_waitcnt vmcnt(6)
s_barrier
v_mfma_f32_16x16x32_bf16 v[120:123], v[60:63], v[96:99], v[120:123]
ds_read_b128 v[80:83], v14 offset:24576
v_lshlrev_b32 v29, 16, v116
v_mfma_f32_16x16x32_bf16 v[124:127], v[60:63], v[100:103], v[124:127]
ds_read_b128 v[84:87], v14 offset:26624
v_and_b32 v30, s59, v116
v_mfma_f32_16x16x32_bf16 v[128:131], v[60:63], v[104:107], v[128:131]
ds_read_b128 v[88:91], v14 offset:28672
v_add_f32 v25, v25, v29
s_add_u32 m0, s42, 65536
s_add_u32 s75, s75, s46
buffer_load_dwordx4 v13, s[16:19], s75 offen sc1 lds
v_mfma_f32_16x16x32_bf16 v[132:135], v[60:63], v[108:111], v[132:135]
ds_read_b128 v[92:95], v14 offset:30720
v_add_f32 v26, v26, v30
v_mfma_f32_16x16x32_bf16 v[200:203], v[60:63], v[36:39], 0
ds_read_b64_tr_b16 v[40:41], v16 offset:24576
v_fma_f32 v27, v29, v29, v27
v_mfma_f32_16x16x32_bf16 v[136:139], v[96:99], v[64:67], v[136:139]
ds_read_b64_tr_b16 v[42:43], v16 offset:25088
v_fma_f32 v28, v30, v30, v28
v_mfma_f32_16x16x32_bf16 v[140:143], v[100:103], v[64:67], v[140:143]
ds_read_b128 v[112:115], v31 offset:24576
v_lshlrev_b32 v29, 16, v117
v_mfma_f32_16x16x32_bf16 v[144:147], v[104:107], v[64:67], v[144:147]
ds_read_b64_tr_b16 v[44:45], v21 offset:0
v_and_b32 v30, s59, v117
s_add_u32 m0, s42, 73728
s_add_u32 s76, s76, s46
buffer_load_dwordx4 v13, s[20:23], s76 offen sc1 lds
v_mfma_f32_16x16x32_bf16 v[148:151], v[108:111], v[64:67], v[148:151]
ds_read_b64_tr_b16 v[46:47], v21 offset:1024
v_add_f32 v25, v25, v29
v_mfma_f32_16x16x32_bf16 v[204:207], v[36:39], v[64:67], 0
ds_read_b64_tr_b16 v[48:49], v22 offset:0
v_add_f32 v26, v26, v30
v_mfma_f32_16x16x32_bf16 v[152:155], v[96:99], v[68:71], v[152:155]
ds_read_b64_tr_b16 v[50:51], v22 offset:1024
v_fma_f32 v27, v29, v29, v27
v_mfma_f32_16x16x32_bf16 v[156:159], v[100:103], v[68:71], v[156:159]
ds_read_b64_tr_b16 v[52:53], v23 offset:0
v_fma_f32 v28, v30, v30, v28
v_mfma_f32_16x16x32_bf16 v[160:163], v[104:107], v[68:71], v[160:163]
ds_read_b64_tr_b16 v[54:55], v23 offset:1024
v_lshlrev_b32 v29, 16, v118
s_add_u32 m0, s42, 0
s_add_u32 s75, s75, s46
buffer_load_dwordx4 v13, s[16:19], s75 offen sc1 lds
v_mfma_f32_16x16x32_bf16 v[164:167], v[108:111], v[68:71], v[164:167]
ds_read_b64_tr_b16 v[56:57], v24 offset:0
v_and_b32 v30, s59, v118
v_mfma_f32_16x16x32_bf16 v[208:211], v[36:39], v[68:71], 0
ds_read_b64_tr_b16 v[58:59], v24 offset:1024
v_add_f32 v25, v25, v29
v_mfma_f32_16x16x32_bf16 v[168:171], v[96:99], v[72:75], v[168:171]
v_add_f32 v26, v26, v30
v_mfma_f32_16x16x32_bf16 v[172:175], v[100:103], v[72:75], v[172:175]
v_fma_f32 v27, v29, v29, v27
v_mfma_f32_16x16x32_bf16 v[176:179], v[104:107], v[72:75], v[176:179]
v_fma_f32 v28, v30, v30, v28
s_add_u32 m0, s42, 8192
s_add_u32 s76, s76, s46
buffer_load_dwordx4 v13, s[20:23], s76 offen sc1 lds
v_mfma_f32_16x16x32_bf16 v[180:183], v[108:111], v[72:75], v[180:183]
v_lshlrev_b32 v29, 16, v119
v_mfma_f32_16x16x32_bf16 v[212:215], v[36:39], v[72:75], 0
v_and_b32 v30, s59, v119
v_mfma_f32_16x16x32_bf16 v[184:187], v[96:99], v[76:79], v[184:187]
v_add_f32 v25, v25, v29
v_mfma_f32_16x16x32_bf16 v[188:191], v[100:103], v[76:79], v[188:191]
v_add_f32 v26, v26, v30
v_mfma_f32_16x16x32_bf16 v[192:195], v[104:107], v[76:79], v[192:195]
v_fma_f32 v27, v29, v29, v27
v_mfma_f32_16x16x32_bf16 v[196:199], v[108:111], v[76:79], v[196:199]
v_fma_f32 v28, v30, v30, v28
v_mfma_f32_16x16x32_bf16 v[216:219], v[36:39], v[76:79], 0
s_waitcnt lgkmcnt(0)
s_waitcnt vmcnt(7)
s_barrier
v_mfma_f32_16x16x32_bf16 v[120:123], v[40:43], v[80:83], v[120:123]
ds_read_b128 v[96:99], v15 offset:24576
v_lshlrev_b32 v29, 16, v112
v_and_b32 v30, s59, v112
v_mfma_f32_16x16x32_bf16 v[124:127], v[40:43], v[84:87], v[124:127]
ds_read_b128 v[100:103], v15 offset:26624
v_add_f32 v25, v25, v29
v_mfma_f32_16x16x32_bf16 v[128:131], v[40:43], v[88:91], v[128:131]
ds_read_b128 v[104:107], v15 offset:28672
v_add_f32 v26, v26, v30
s_add_u32 m0, s42, 16384
s_add_u32 s75, s75, s46
buffer_load_dwordx4 v13, s[16:19], s75 offen sc1 lds
v_mfma_f32_16x16x32_bf16 v[132:135], v[40:43], v[92:95], v[132:135]
ds_read_b128 v[108:111], v15 offset:30720
v_fma_f32 v27, v29, v29, v27
v_mfma_f32_16x16x32_bf16 v[136:139], v[80:83], v[44:47], v[136:139]
ds_read_b64_tr_b16 v[60:61], v16 offset:28672
v_fma_f32 v28, v30, v30, v28
v_mfma_f32_16x16x32_bf16 v[140:143], v[84:87], v[44:47], v[140:143]
ds_read_b64_tr_b16 v[62:63], v16 offset:29184
v_lshlrev_b32 v29, 16, v113
v_and_b32 v30, s59, v113
v_mfma_f32_16x16x32_bf16 v[144:147], v[88:91], v[44:47], v[144:147]
ds_read_b128 v[116:119], v32 offset:24576
v_add_f32 v25, v25, v29
s_add_u32 m0, s42, 24576
s_add_u32 s76, s76, s46
buffer_load_dwordx4 v13, s[20:23], s76 offen sc1 lds
v_mfma_f32_16x16x32_bf16 v[148:151], v[92:95], v[44:47], v[148:151]
ds_read_b64_tr_b16 v[64:65], v21 offset:16384
v_add_f32 v26, v26, v30
v_mfma_f32_16x16x32_bf16 v[152:155], v[80:83], v[48:51], v[152:155]
ds_read_b64_tr_b16 v[66:67], v21 offset:17408
v_fma_f32 v27, v29, v29, v27
v_mfma_f32_16x16x32_bf16 v[156:159], v[84:87], v[48:51], v[156:159]
ds_read_b64_tr_b16 v[68:69], v22 offset:16384
v_fma_f32 v28, v30, v30, v28
v_mfma_f32_16x16x32_bf16 v[160:163], v[88:91], v[48:51], v[160:163]
ds_read_b64_tr_b16 v[70:71], v22 offset:17408
v_lshlrev_b32 v29, 16, v114
v_and_b32 v30, s59, v114
s_add_u32 m0, s40, 0
s_add_u32 s82, s36, 384
buffer_load_dwordx4 v10, s[8:11], s82 offen sc1 lds
v_mfma_f32_16x16x32_bf16 v[164:167], v[92:95], v[48:51], v[164:167]
ds_read_b64_tr_b16 v[72:73], v23 offset:16384
v_add_f32 v25, v25, v29
v_mfma_f32_16x16x32_bf16 v[168:171], v[80:83], v[52:55], v[168:171]
ds_read_b64_tr_b16 v[74:75], v23 offset:17408
v_add_f32 v26, v26, v30
v_mfma_f32_16x16x32_bf16 v[172:175], v[84:87], v[52:55], v[172:175]
ds_read_b64_tr_b16 v[76:77], v24 offset:16384
v_fma_f32 v27, v29, v29, v27
v_mfma_f32_16x16x32_bf16 v[176:179], v[88:91], v[52:55], v[176:179]
ds_read_b64_tr_b16 v[78:79], v24 offset:17408
v_fma_f32 v28, v30, v30, v28
s_add_u32 m0, s40, 1024
s_add_u32 s33, s37, 589824
buffer_load_dwordx4 v11, s[8:11], s82 offen sc1 lds
s_add_u32 m0, s41, 0
s_nop 0
buffer_load_dwordx4 v12, s[12:15], s33 offen sc1 lds
v_mfma_f32_16x16x32_bf16 v[180:183], v[92:95], v[52:55], v[180:183]
v_lshlrev_b32 v29, 16, v115
v_and_b32 v30, s59, v115
v_mfma_f32_16x16x32_bf16 v[184:187], v[80:83], v[56:59], v[184:187]
v_add_f32 v25, v25, v29
v_mfma_f32_16x16x32_bf16 v[188:191], v[84:87], v[56:59], v[188:191]
v_add_f32 v26, v26, v30
v_mfma_f32_16x16x32_bf16 v[192:195], v[88:91], v[56:59], v[192:195]
v_fma_f32 v27, v29, v29, v27
v_mfma_f32_16x16x32_bf16 v[196:199], v[92:95], v[56:59], v[196:199]
v_fma_f32 v28, v30, v30, v28
s_waitcnt lgkmcnt(0)
s_waitcnt vmcnt(7)
s_barrier
v_mfma_f32_16x16x32_bf16 v[120:123], v[60:63], v[96:99], v[120:123]
ds_read_b128 v[80:83], v14 offset:49152
v_lshlrev_b32 v29, 16, v116
v_mfma_f32_16x16x32_bf16 v[124:127], v[60:63], v[100:103], v[124:127]
ds_read_b128 v[84:87], v14 offset:51200
v_and_b32 v30, s59, v116
v_mfma_f32_16x16x32_bf16 v[128:131], v[60:63], v[104:107], v[128:131]
ds_read_b128 v[88:91], v14 offset:53248
v_add_f32 v25, v25, v29
s_add_u32 m0, s42, 32768
s_add_u32 s75, s75, s46
buffer_load_dwordx4 v13, s[16:19], s75 offen sc1 lds
v_mfma_f32_16x16x32_bf16 v[132:135], v[60:63], v[108:111], v[132:135]
ds_read_b128 v[92:95], v14 offset:55296
v_add_f32 v26, v26, v30
v_mfma_f32_16x16x32_bf16 v[200:203], v[60:63], v[36:39], v[200:203]
ds_read_b64_tr_b16 v[40:41], v16 offset:49152
v_fma_f32 v27, v29, v29, v27
v_mfma_f32_16x16x32_bf16 v[136:139], v[96:99], v[64:67], v[136:139]
ds_read_b64_tr_b16 v[42:43], v16 offset:49664
v_fma_f32 v28, v30, v30, v28
v_mfma_f32_16x16x32_bf16 v[140:143], v[100:103], v[64:67], v[140:143]
ds_read_b128 v[112:115], v31 offset:49152
v_lshlrev_b32 v29, 16, v117
v_mfma_f32_16x16x32_bf16 v[144:147], v[104:107], v[64:67], v[144:147]
ds_read_b64_tr_b16 v[44:45], v21 offset:32768
v_and_b32 v30, s59, v117
s_add_u32 m0, s42, 40960
s_add_u32 s76, s76, s46
buffer_load_dwordx4 v13, s[20:23], s76 offen sc1 lds
v_mfma_f32_16x16x32_bf16 v[148:151], v[108:111], v[64:67], v[148:151]
ds_read_b64_tr_b16 v[46:47], v21 offset:33792
v_add_f32 v25, v25, v29
v_mfma_f32_16x16x32_bf16 v[204:207], v[36:39], v[64:67], v[204:207]
ds_read_b64_tr_b16 v[48:49], v22 offset:32768
v_add_f32 v26, v26, v30
v_mfma_f32_16x16x32_bf16 v[152:155], v[96:99], v[68:71], v[152:155]
ds_read_b64_tr_b16 v[50:51], v22 offset:33792
v_fma_f32 v27, v29, v29, v27
v_mfma_f32_16x16x32_bf16 v[156:159], v[100:103], v[68:71], v[156:159]
ds_read_b64_tr_b16 v[52:53], v23 offset:32768
v_fma_f32 v28, v30, v30, v28
v_mfma_f32_16x16x32_bf16 v[160:163], v[104:107], v[68:71], v[160:163]
ds_read_b64_tr_b16 v[54:55], v23 offset:33792
v_lshlrev_b32 v29, 16, v118
s_add_u32 m0, s42, 49152
s_add_u32 s75, s75, s46
buffer_load_dwordx4 v13, s[16:19], s75 offen sc1 lds
v_mfma_f32_16x16x32_bf16 v[164:167], v[108:111], v[68:71], v[164:167]
ds_read_b64_tr_b16 v[56:57], v24 offset:32768
v_and_b32 v30, s59, v118
v_mfma_f32_16x16x32_bf16 v[208:211], v[36:39], v[68:71], v[208:211]
ds_read_b64_tr_b16 v[58:59], v24 offset:33792
v_add_f32 v25, v25, v29
v_mfma_f32_16x16x32_bf16 v[168:171], v[96:99], v[72:75], v[168:171]
v_add_f32 v26, v26, v30
v_mfma_f32_16x16x32_bf16 v[172:175], v[100:103], v[72:75], v[172:175]
v_fma_f32 v27, v29, v29, v27
v_mfma_f32_16x16x32_bf16 v[176:179], v[104:107], v[72:75], v[176:179]
v_fma_f32 v28, v30, v30, v28
s_add_u32 m0, s42, 57344
s_add_u32 s76, s76, s46
buffer_load_dwordx4 v13, s[20:23], s76 offen sc1 lds
v_mfma_f32_16x16x32_bf16 v[180:183], v[108:111], v[72:75], v[180:183]
v_lshlrev_b32 v29, 16, v119
v_mfma_f32_16x16x32_bf16 v[212:215], v[36:39], v[72:75], v[212:215]
v_and_b32 v30, s59, v119
v_mfma_f32_16x16x32_bf16 v[184:187], v[96:99], v[76:79], v[184:187]
v_add_f32 v25, v25, v29
v_mfma_f32_16x16x32_bf16 v[188:191], v[100:103], v[76:79], v[188:191]
v_add_f32 v26, v26, v30
v_mfma_f32_16x16x32_bf16 v[192:195], v[104:107], v[76:79], v[192:195]
v_fma_f32 v27, v29, v29, v27
v_mfma_f32_16x16x32_bf16 v[196:199], v[108:111], v[76:79], v[196:199]
v_fma_f32 v28, v30, v30, v28
v_mfma_f32_16x16x32_bf16 v[216:219], v[36:39], v[76:79], v[216:219]
s_waitcnt lgkmcnt(0)
s_waitcnt vmcnt(9)
s_barrier
s_cmp_ge_u32 s2, 8
s_cbranch_scc1 parallel_sum__mha_block__geglu_ffn__prompt_kernel_B1_sig
s_cmp_lg_u32 s28, 7
s_cbranch_scc1 parallel_sum__mha_block__geglu_ffn__prompt_kernel_B1_sig
v_mov_b32 v4, s2
v_mov_b32 v5, 1
s_mov_b64 exec, 1
buffer_store_byte v5, v4, s[96:99], 0 offen sc1
s_mov_b64 exec, -1
parallel_sum__mha_block__geglu_ffn__prompt_kernel_B1_sig:
v_mfma_f32_16x16x32_bf16 v[120:123], v[40:43], v[80:83], v[120:123]
ds_read_b128 v[96:99], v15 offset:49152
v_lshlrev_b32 v29, 16, v112
v_and_b32 v30, s59, v112
v_mfma_f32_16x16x32_bf16 v[124:127], v[40:43], v[84:87], v[124:127]
ds_read_b128 v[100:103], v15 offset:51200
v_add_f32 v25, v25, v29
v_mfma_f32_16x16x32_bf16 v[128:131], v[40:43], v[88:91], v[128:131]
ds_read_b128 v[104:107], v15 offset:53248
v_add_f32 v26, v26, v30
s_add_u32 m0, s42, 65536
s_add_u32 s75, s75, s46
buffer_load_dwordx4 v13, s[16:19], s75 offen sc1 lds
v_mfma_f32_16x16x32_bf16 v[132:135], v[40:43], v[92:95], v[132:135]
ds_read_b128 v[108:111], v15 offset:55296
v_fma_f32 v27, v29, v29, v27
v_mfma_f32_16x16x32_bf16 v[136:139], v[80:83], v[44:47], v[136:139]
ds_read_b64_tr_b16 v[60:61], v16 offset:53248
v_fma_f32 v28, v30, v30, v28
v_mfma_f32_16x16x32_bf16 v[140:143], v[84:87], v[44:47], v[140:143]
ds_read_b64_tr_b16 v[62:63], v16 offset:53760
v_lshlrev_b32 v29, 16, v113
v_and_b32 v30, s59, v113
v_mfma_f32_16x16x32_bf16 v[144:147], v[88:91], v[44:47], v[144:147]
ds_read_b128 v[116:119], v32 offset:49152
v_add_f32 v25, v25, v29
s_add_u32 m0, s42, 73728
s_add_u32 s76, s76, s46
buffer_load_dwordx4 v13, s[20:23], s76 offen sc1 lds
v_mfma_f32_16x16x32_bf16 v[148:151], v[92:95], v[44:47], v[148:151]
ds_read_b64_tr_b16 v[64:65], v17 offset:0
v_add_f32 v26, v26, v30
v_mfma_f32_16x16x32_bf16 v[152:155], v[80:83], v[48:51], v[152:155]
ds_read_b64_tr_b16 v[66:67], v17 offset:1024
v_fma_f32 v27, v29, v29, v27
v_mfma_f32_16x16x32_bf16 v[156:159], v[84:87], v[48:51], v[156:159]
ds_read_b64_tr_b16 v[68:69], v18 offset:0
v_fma_f32 v28, v30, v30, v28
v_mfma_f32_16x16x32_bf16 v[160:163], v[88:91], v[48:51], v[160:163]
ds_read_b64_tr_b16 v[70:71], v18 offset:1024
v_lshlrev_b32 v29, 16, v114
v_and_b32 v30, s59, v114
s_add_u32 m0, s40, 24576
s_add_u32 s82, s36, 512
buffer_load_dwordx4 v10, s[8:11], s82 offen sc1 lds
v_mfma_f32_16x16x32_bf16 v[164:167], v[92:95], v[48:51], v[164:167]
ds_read_b64_tr_b16 v[72:73], v19 offset:0
v_add_f32 v25, v25, v29
v_mfma_f32_16x16x32_bf16 v[168:171], v[80:83], v[52:55], v[168:171]
ds_read_b64_tr_b16 v[74:75], v19 offset:1024
v_add_f32 v26, v26, v30
v_mfma_f32_16x16x32_bf16 v[172:175], v[84:87], v[52:55], v[172:175]
ds_read_b64_tr_b16 v[76:77], v20 offset:0
v_fma_f32 v27, v29, v29, v27
v_mfma_f32_16x16x32_bf16 v[176:179], v[88:91], v[52:55], v[176:179]
ds_read_b64_tr_b16 v[78:79], v20 offset:1024
v_fma_f32 v28, v30, v30, v28
s_add_u32 m0, s40, 25600
s_add_u32 s33, s37, 786432
buffer_load_dwordx4 v11, s[8:11], s82 offen sc1 lds
s_add_u32 m0, s41, 24576
s_nop 0
buffer_load_dwordx4 v12, s[12:15], s33 offen sc1 lds
v_mfma_f32_16x16x32_bf16 v[180:183], v[92:95], v[52:55], v[180:183]
v_lshlrev_b32 v29, 16, v115
v_and_b32 v30, s59, v115
v_mfma_f32_16x16x32_bf16 v[184:187], v[80:83], v[56:59], v[184:187]
v_add_f32 v25, v25, v29
v_mfma_f32_16x16x32_bf16 v[188:191], v[84:87], v[56:59], v[188:191]
v_add_f32 v26, v26, v30
v_mfma_f32_16x16x32_bf16 v[192:195], v[88:91], v[56:59], v[192:195]
v_fma_f32 v27, v29, v29, v27
v_mfma_f32_16x16x32_bf16 v[196:199], v[92:95], v[56:59], v[196:199]
v_fma_f32 v28, v30, v30, v28
s_waitcnt lgkmcnt(0)
s_waitcnt vmcnt(12)
s_waitcnt vmcnt(9)
s_barrier
v_mfma_f32_16x16x32_bf16 v[120:123], v[60:63], v[96:99], v[120:123]
ds_read_b128 v[80:83], v14 offset:0
v_lshlrev_b32 v29, 16, v116
v_mfma_f32_16x16x32_bf16 v[124:127], v[60:63], v[100:103], v[124:127]
ds_read_b128 v[84:87], v14 offset:2048
v_and_b32 v30, s59, v116
v_mfma_f32_16x16x32_bf16 v[128:131], v[60:63], v[104:107], v[128:131]
ds_read_b128 v[88:91], v14 offset:4096
v_add_f32 v25, v25, v29
s_add_u32 m0, s42, 0
s_add_u32 s75, s75, s46
buffer_load_dwordx4 v13, s[16:19], s75 offen sc1 lds
v_mfma_f32_16x16x32_bf16 v[132:135], v[60:63], v[108:111], v[132:135]
ds_read_b128 v[92:95], v14 offset:6144
v_add_f32 v26, v26, v30
v_mfma_f32_16x16x32_bf16 v[200:203], v[60:63], v[36:39], v[200:203]
ds_read_b64_tr_b16 v[40:41], v16 offset:0
v_fma_f32 v27, v29, v29, v27
v_mfma_f32_16x16x32_bf16 v[136:139], v[96:99], v[64:67], v[136:139]
ds_read_b64_tr_b16 v[42:43], v16 offset:512
v_fma_f32 v28, v30, v30, v28
v_mfma_f32_16x16x32_bf16 v[140:143], v[100:103], v[64:67], v[140:143]
ds_read_b128 v[112:115], v31 offset:0
v_lshlrev_b32 v29, 16, v117
v_mfma_f32_16x16x32_bf16 v[144:147], v[104:107], v[64:67], v[144:147]
ds_read_b64_tr_b16 v[44:45], v17 offset:16384
v_and_b32 v30, s59, v117
v_mfma_f32_16x16x32_bf16 v[148:151], v[108:111], v[64:67], v[148:151]
ds_read_b64_tr_b16 v[46:47], v17 offset:17408
v_add_f32 v25, v25, v29
v_mfma_f32_16x16x32_bf16 v[204:207], v[36:39], v[64:67], v[204:207]
ds_read_b64_tr_b16 v[48:49], v18 offset:16384
v_add_f32 v26, v26, v30
v_mfma_f32_16x16x32_bf16 v[152:155], v[96:99], v[68:71], v[152:155]
ds_read_b64_tr_b16 v[50:51], v18 offset:17408
v_fma_f32 v27, v29, v29, v27
v_mfma_f32_16x16x32_bf16 v[156:159], v[100:103], v[68:71], v[156:159]
ds_read_b64_tr_b16 v[52:53], v19 offset:16384
v_fma_f32 v28, v30, v30, v28
v_mfma_f32_16x16x32_bf16 v[160:163], v[104:107], v[68:71], v[160:163]
ds_read_b64_tr_b16 v[54:55], v19 offset:17408
v_lshlrev_b32 v29, 16, v118
v_mfma_f32_16x16x32_bf16 v[164:167], v[108:111], v[68:71], v[164:167]
ds_read_b64_tr_b16 v[56:57], v20 offset:16384
v_and_b32 v30, s59, v118
s_add_u32 m0, s42, 8192
s_add_u32 s76, s76, s46
buffer_load_dwordx4 v13, s[20:23], s76 offen sc1 lds
v_mfma_f32_16x16x32_bf16 v[208:211], v[36:39], v[68:71], v[208:211]
ds_read_b64_tr_b16 v[58:59], v20 offset:17408
v_add_f32 v25, v25, v29
v_mfma_f32_16x16x32_bf16 v[168:171], v[96:99], v[72:75], v[168:171]
v_add_f32 v26, v26, v30
v_mfma_f32_16x16x32_bf16 v[172:175], v[100:103], v[72:75], v[172:175]
v_fma_f32 v27, v29, v29, v27
v_mfma_f32_16x16x32_bf16 v[176:179], v[104:107], v[72:75], v[176:179]
v_fma_f32 v28, v30, v30, v28
v_mfma_f32_16x16x32_bf16 v[180:183], v[108:111], v[72:75], v[180:183]
v_lshlrev_b32 v29, 16, v119
v_mfma_f32_16x16x32_bf16 v[212:215], v[36:39], v[72:75], v[212:215]
v_and_b32 v30, s59, v119
v_mfma_f32_16x16x32_bf16 v[184:187], v[96:99], v[76:79], v[184:187]
v_add_f32 v25, v25, v29
v_mfma_f32_16x16x32_bf16 v[188:191], v[100:103], v[76:79], v[188:191]
v_add_f32 v26, v26, v30
v_mfma_f32_16x16x32_bf16 v[192:195], v[104:107], v[76:79], v[192:195]
v_fma_f32 v27, v29, v29, v27
v_mfma_f32_16x16x32_bf16 v[196:199], v[108:111], v[76:79], v[196:199]
v_fma_f32 v28, v30, v30, v28
v_mfma_f32_16x16x32_bf16 v[216:219], v[36:39], v[76:79], v[216:219]
s_waitcnt lgkmcnt(0)
s_waitcnt vmcnt(9)
s_barrier
v_mfma_f32_16x16x32_bf16 v[120:123], v[40:43], v[80:83], v[120:123]
ds_read_b128 v[96:99], v15 offset:0
v_lshlrev_b32 v29, 16, v112
v_and_b32 v30, s59, v112
v_mfma_f32_16x16x32_bf16 v[124:127], v[40:43], v[84:87], v[124:127]
ds_read_b128 v[100:103], v15 offset:2048
v_add_f32 v25, v25, v29
v_mfma_f32_16x16x32_bf16 v[128:131], v[40:43], v[88:91], v[128:131]
ds_read_b128 v[104:107], v15 offset:4096
v_add_f32 v26, v26, v30
s_add_u32 m0, s42, 16384
s_add_u32 s75, s75, s46
buffer_load_dwordx4 v13, s[16:19], s75 offen sc1 lds
v_mfma_f32_16x16x32_bf16 v[132:135], v[40:43], v[92:95], v[132:135]
ds_read_b128 v[108:111], v15 offset:6144
v_fma_f32 v27, v29, v29, v27
v_mfma_f32_16x16x32_bf16 v[136:139], v[80:83], v[44:47], v[136:139]
ds_read_b64_tr_b16 v[60:61], v16 offset:4096
v_fma_f32 v28, v30, v30, v28
v_mfma_f32_16x16x32_bf16 v[140:143], v[84:87], v[44:47], v[140:143]
ds_read_b64_tr_b16 v[62:63], v16 offset:4608
v_lshlrev_b32 v29, 16, v113
v_and_b32 v30, s59, v113
v_mfma_f32_16x16x32_bf16 v[144:147], v[88:91], v[44:47], v[144:147]
ds_read_b128 v[116:119], v32 offset:0
v_add_f32 v25, v25, v29
s_add_u32 m0, s42, 24576
s_add_u32 s76, s76, s46
buffer_load_dwordx4 v13, s[20:23], s76 offen sc1 lds
v_mfma_f32_16x16x32_bf16 v[148:151], v[92:95], v[44:47], v[148:151]
ds_read_b64_tr_b16 v[64:65], v21 offset:0
v_add_f32 v26, v26, v30
v_mfma_f32_16x16x32_bf16 v[152:155], v[80:83], v[48:51], v[152:155]
ds_read_b64_tr_b16 v[66:67], v21 offset:1024
v_fma_f32 v27, v29, v29, v27
v_mfma_f32_16x16x32_bf16 v[156:159], v[84:87], v[48:51], v[156:159]
ds_read_b64_tr_b16 v[68:69], v22 offset:0
v_fma_f32 v28, v30, v30, v28
v_mfma_f32_16x16x32_bf16 v[160:163], v[88:91], v[48:51], v[160:163]
ds_read_b64_tr_b16 v[70:71], v22 offset:1024
v_lshlrev_b32 v29, 16, v114
v_and_b32 v30, s59, v114
s_add_u32 m0, s40, 49152
s_add_u32 s82, s36, 640
buffer_load_dwordx4 v10, s[8:11], s82 offen sc1 lds
v_mfma_f32_16x16x32_bf16 v[164:167], v[92:95], v[48:51], v[164:167]
ds_read_b64_tr_b16 v[72:73], v23 offset:0
v_add_f32 v25, v25, v29
v_mfma_f32_16x16x32_bf16 v[168:171], v[80:83], v[52:55], v[168:171]
ds_read_b64_tr_b16 v[74:75], v23 offset:1024
v_add_f32 v26, v26, v30
v_mfma_f32_16x16x32_bf16 v[172:175], v[84:87], v[52:55], v[172:175]
ds_read_b64_tr_b16 v[76:77], v24 offset:0
v_fma_f32 v27, v29, v29, v27
v_mfma_f32_16x16x32_bf16 v[176:179], v[88:91], v[52:55], v[176:179]
ds_read_b64_tr_b16 v[78:79], v24 offset:1024
v_fma_f32 v28, v30, v30, v28
s_add_u32 m0, s40, 50176
s_add_u32 s33, s37, 983040
buffer_load_dwordx4 v11, s[8:11], s82 offen sc1 lds
s_add_u32 m0, s41, 49152
s_nop 0
buffer_load_dwordx4 v12, s[12:15], s33 offen sc1 lds
v_mfma_f32_16x16x32_bf16 v[180:183], v[92:95], v[52:55], v[180:183]
v_lshlrev_b32 v29, 16, v115
v_and_b32 v30, s59, v115
v_mfma_f32_16x16x32_bf16 v[184:187], v[80:83], v[56:59], v[184:187]
v_add_f32 v25, v25, v29
v_mfma_f32_16x16x32_bf16 v[188:191], v[84:87], v[56:59], v[188:191]
v_add_f32 v26, v26, v30
v_mfma_f32_16x16x32_bf16 v[192:195], v[88:91], v[56:59], v[192:195]
v_fma_f32 v27, v29, v29, v27
v_mfma_f32_16x16x32_bf16 v[196:199], v[92:95], v[56:59], v[196:199]
v_fma_f32 v28, v30, v30, v28
s_waitcnt lgkmcnt(0)
s_waitcnt vmcnt(12)
s_waitcnt vmcnt(7)
s_barrier
v_mfma_f32_16x16x32_bf16 v[120:123], v[60:63], v[96:99], v[120:123]
ds_read_b128 v[80:83], v14 offset:24576
v_lshlrev_b32 v29, 16, v116
v_mfma_f32_16x16x32_bf16 v[124:127], v[60:63], v[100:103], v[124:127]
ds_read_b128 v[84:87], v14 offset:26624
v_and_b32 v30, s59, v116
v_mfma_f32_16x16x32_bf16 v[128:131], v[60:63], v[104:107], v[128:131]
ds_read_b128 v[88:91], v14 offset:28672
v_add_f32 v25, v25, v29
s_add_u32 m0, s42, 32768
s_add_u32 s75, s75, s46
buffer_load_dwordx4 v13, s[16:19], s75 offen sc1 lds
v_mfma_f32_16x16x32_bf16 v[132:135], v[60:63], v[108:111], v[132:135]
ds_read_b128 v[92:95], v14 offset:30720
v_add_f32 v26, v26, v30
v_mfma_f32_16x16x32_bf16 v[200:203], v[60:63], v[36:39], v[200:203]
ds_read_b64_tr_b16 v[40:41], v16 offset:24576
v_fma_f32 v27, v29, v29, v27
v_mfma_f32_16x16x32_bf16 v[136:139], v[96:99], v[64:67], v[136:139]
ds_read_b64_tr_b16 v[42:43], v16 offset:25088
v_fma_f32 v28, v30, v30, v28
v_mfma_f32_16x16x32_bf16 v[140:143], v[100:103], v[64:67], v[140:143]
ds_read_b128 v[112:115], v31 offset:24576
v_lshlrev_b32 v29, 16, v117
v_mfma_f32_16x16x32_bf16 v[144:147], v[104:107], v[64:67], v[144:147]
ds_read_b64_tr_b16 v[44:45], v21 offset:16384
v_and_b32 v30, s59, v117
v_mfma_f32_16x16x32_bf16 v[148:151], v[108:111], v[64:67], v[148:151]
ds_read_b64_tr_b16 v[46:47], v21 offset:17408
v_add_f32 v25, v25, v29
v_mfma_f32_16x16x32_bf16 v[204:207], v[36:39], v[64:67], v[204:207]
ds_read_b64_tr_b16 v[48:49], v22 offset:16384
v_add_f32 v26, v26, v30
v_mfma_f32_16x16x32_bf16 v[152:155], v[96:99], v[68:71], v[152:155]
ds_read_b64_tr_b16 v[50:51], v22 offset:17408
v_fma_f32 v27, v29, v29, v27
v_mfma_f32_16x16x32_bf16 v[156:159], v[100:103], v[68:71], v[156:159]
ds_read_b64_tr_b16 v[52:53], v23 offset:16384
v_fma_f32 v28, v30, v30, v28
v_mfma_f32_16x16x32_bf16 v[160:163], v[104:107], v[68:71], v[160:163]
ds_read_b64_tr_b16 v[54:55], v23 offset:17408
v_lshlrev_b32 v29, 16, v118
v_mfma_f32_16x16x32_bf16 v[164:167], v[108:111], v[68:71], v[164:167]
ds_read_b64_tr_b16 v[56:57], v24 offset:16384
v_and_b32 v30, s59, v118
s_add_u32 m0, s42, 40960
s_add_u32 s76, s76, s46
buffer_load_dwordx4 v13, s[20:23], s76 offen sc1 lds
v_mfma_f32_16x16x32_bf16 v[208:211], v[36:39], v[68:71], v[208:211]
ds_read_b64_tr_b16 v[58:59], v24 offset:17408
v_add_f32 v25, v25, v29
v_mfma_f32_16x16x32_bf16 v[168:171], v[96:99], v[72:75], v[168:171]
v_add_f32 v26, v26, v30
v_mfma_f32_16x16x32_bf16 v[172:175], v[100:103], v[72:75], v[172:175]
v_fma_f32 v27, v29, v29, v27
v_mfma_f32_16x16x32_bf16 v[176:179], v[104:107], v[72:75], v[176:179]
v_fma_f32 v28, v30, v30, v28
v_mfma_f32_16x16x32_bf16 v[180:183], v[108:111], v[72:75], v[180:183]
v_lshlrev_b32 v29, 16, v119
v_mfma_f32_16x16x32_bf16 v[212:215], v[36:39], v[72:75], v[212:215]
v_and_b32 v30, s59, v119
v_mfma_f32_16x16x32_bf16 v[184:187], v[96:99], v[76:79], v[184:187]
v_add_f32 v25, v25, v29
v_mfma_f32_16x16x32_bf16 v[188:191], v[100:103], v[76:79], v[188:191]
v_add_f32 v26, v26, v30
v_mfma_f32_16x16x32_bf16 v[192:195], v[104:107], v[76:79], v[192:195]
v_fma_f32 v27, v29, v29, v27
v_mfma_f32_16x16x32_bf16 v[196:199], v[108:111], v[76:79], v[196:199]
v_fma_f32 v28, v30, v30, v28
v_mfma_f32_16x16x32_bf16 v[216:219], v[36:39], v[76:79], v[216:219]
s_waitcnt lgkmcnt(0)
s_barrier
v_mfma_f32_16x16x32_bf16 v[120:123], v[40:43], v[80:83], v[120:123]
ds_read_b128 v[96:99], v15 offset:24576
v_lshlrev_b32 v29, 16, v112
v_and_b32 v30, s59, v112
v_mfma_f32_16x16x32_bf16 v[124:127], v[40:43], v[84:87], v[124:127]
ds_read_b128 v[100:103], v15 offset:26624
v_add_f32 v25, v25, v29
v_mfma_f32_16x16x32_bf16 v[128:131], v[40:43], v[88:91], v[128:131]
ds_read_b128 v[104:107], v15 offset:28672
v_add_f32 v26, v26, v30
s_add_u32 m0, s42, 49152
s_add_u32 s75, s75, s46
buffer_load_dwordx4 v13, s[16:19], s75 offen sc1 lds
v_mfma_f32_16x16x32_bf16 v[132:135], v[40:43], v[92:95], v[132:135]
ds_read_b128 v[108:111], v15 offset:30720
v_fma_f32 v27, v29, v29, v27
v_mfma_f32_16x16x32_bf16 v[136:139], v[80:83], v[44:47], v[136:139]
ds_read_b64_tr_b16 v[60:61], v16 offset:28672
v_fma_f32 v28, v30, v30, v28
v_mfma_f32_16x16x32_bf16 v[140:143], v[84:87], v[44:47], v[140:143]
ds_read_b64_tr_b16 v[62:63], v16 offset:29184
v_lshlrev_b32 v29, 16, v113
v_and_b32 v30, s59, v113
v_mfma_f32_16x16x32_bf16 v[144:147], v[88:91], v[44:47], v[144:147]
ds_read_b128 v[116:119], v32 offset:24576
v_add_f32 v25, v25, v29
s_add_u32 m0, s42, 57344
s_add_u32 s76, s76, s46
buffer_load_dwordx4 v13, s[20:23], s76 offen sc1 lds
v_mfma_f32_16x16x32_bf16 v[148:151], v[92:95], v[44:47], v[148:151]
ds_read_b64_tr_b16 v[64:65], v21 offset:32768
v_add_f32 v26, v26, v30
v_mfma_f32_16x16x32_bf16 v[152:155], v[80:83], v[48:51], v[152:155]
ds_read_b64_tr_b16 v[66:67], v21 offset:33792
v_fma_f32 v27, v29, v29, v27
v_mfma_f32_16x16x32_bf16 v[156:159], v[84:87], v[48:51], v[156:159]
ds_read_b64_tr_b16 v[68:69], v22 offset:32768
v_fma_f32 v28, v30, v30, v28
v_mfma_f32_16x16x32_bf16 v[160:163], v[88:91], v[48:51], v[160:163]
ds_read_b64_tr_b16 v[70:71], v22 offset:33792
v_lshlrev_b32 v29, 16, v114
v_and_b32 v30, s59, v114
s_add_u32 m0, s40, 0
s_add_u32 s82, s36, 768
buffer_load_dwordx4 v10, s[8:11], s82 offen sc1 lds
v_mfma_f32_16x16x32_bf16 v[164:167], v[92:95], v[48:51], v[164:167]
ds_read_b64_tr_b16 v[72:73], v23 offset:32768
v_add_f32 v25, v25, v29
v_mfma_f32_16x16x32_bf16 v[168:171], v[80:83], v[52:55], v[168:171]
ds_read_b64_tr_b16 v[74:75], v23 offset:33792
v_add_f32 v26, v26, v30
v_mfma_f32_16x16x32_bf16 v[172:175], v[84:87], v[52:55], v[172:175]
ds_read_b64_tr_b16 v[76:77], v24 offset:32768
v_fma_f32 v27, v29, v29, v27
v_mfma_f32_16x16x32_bf16 v[176:179], v[88:91], v[52:55], v[176:179]
ds_read_b64_tr_b16 v[78:79], v24 offset:33792
v_fma_f32 v28, v30, v30, v28
s_add_u32 m0, s40, 1024
s_add_u32 s33, s37, 1179648
buffer_load_dwordx4 v11, s[8:11], s82 offen sc1 lds
s_add_u32 m0, s41, 0
s_nop 0
buffer_load_dwordx4 v12, s[12:15], s33 offen sc1 lds
v_mfma_f32_16x16x32_bf16 v[180:183], v[92:95], v[52:55], v[180:183]
v_lshlrev_b32 v29, 16, v115
v_and_b32 v30, s59, v115
v_mfma_f32_16x16x32_bf16 v[184:187], v[80:83], v[56:59], v[184:187]
v_add_f32 v25, v25, v29
v_mfma_f32_16x16x32_bf16 v[188:191], v[84:87], v[56:59], v[188:191]
v_add_f32 v26, v26, v30
v_mfma_f32_16x16x32_bf16 v[192:195], v[88:91], v[56:59], v[192:195]
v_fma_f32 v27, v29, v29, v27
v_mfma_f32_16x16x32_bf16 v[196:199], v[92:95], v[56:59], v[196:199]
v_fma_f32 v28, v30, v30, v28
s_waitcnt lgkmcnt(0)
s_waitcnt vmcnt(12)
s_waitcnt vmcnt(7)
s_barrier
v_mfma_f32_16x16x32_bf16 v[120:123], v[60:63], v[96:99], v[120:123]
ds_read_b128 v[80:83], v14 offset:49152
v_lshlrev_b32 v29, 16, v116
v_mfma_f32_16x16x32_bf16 v[124:127], v[60:63], v[100:103], v[124:127]
ds_read_b128 v[84:87], v14 offset:51200
v_and_b32 v30, s59, v116
v_mfma_f32_16x16x32_bf16 v[128:131], v[60:63], v[104:107], v[128:131]
ds_read_b128 v[88:91], v14 offset:53248
v_add_f32 v25, v25, v29
s_add_u32 m0, s42, 65536
s_add_u32 s75, s75, s46
buffer_load_dwordx4 v13, s[16:19], s75 offen sc1 lds
v_mfma_f32_16x16x32_bf16 v[132:135], v[60:63], v[108:111], v[132:135]
ds_read_b128 v[92:95], v14 offset:55296
v_add_f32 v26, v26, v30
v_mfma_f32_16x16x32_bf16 v[200:203], v[60:63], v[36:39], v[200:203]
ds_read_b64_tr_b16 v[40:41], v16 offset:49152
v_fma_f32 v27, v29, v29, v27
v_mfma_f32_16x16x32_bf16 v[136:139], v[96:99], v[64:67], v[136:139]
ds_read_b64_tr_b16 v[42:43], v16 offset:49664
v_fma_f32 v28, v30, v30, v28
v_mfma_f32_16x16x32_bf16 v[140:143], v[100:103], v[64:67], v[140:143]
ds_read_b128 v[112:115], v31 offset:49152
v_lshlrev_b32 v29, 16, v117
v_mfma_f32_16x16x32_bf16 v[144:147], v[104:107], v[64:67], v[144:147]
ds_read_b64_tr_b16 v[44:45], v17 offset:0
v_and_b32 v30, s59, v117
v_mfma_f32_16x16x32_bf16 v[148:151], v[108:111], v[64:67], v[148:151]
ds_read_b64_tr_b16 v[46:47], v17 offset:1024
v_add_f32 v25, v25, v29
v_mfma_f32_16x16x32_bf16 v[204:207], v[36:39], v[64:67], v[204:207]
ds_read_b64_tr_b16 v[48:49], v18 offset:0
v_add_f32 v26, v26, v30
v_mfma_f32_16x16x32_bf16 v[152:155], v[96:99], v[68:71], v[152:155]
ds_read_b64_tr_b16 v[50:51], v18 offset:1024
v_fma_f32 v27, v29, v29, v27
v_mfma_f32_16x16x32_bf16 v[156:159], v[100:103], v[68:71], v[156:159]
ds_read_b64_tr_b16 v[52:53], v19 offset:0
v_fma_f32 v28, v30, v30, v28
v_mfma_f32_16x16x32_bf16 v[160:163], v[104:107], v[68:71], v[160:163]
ds_read_b64_tr_b16 v[54:55], v19 offset:1024
v_lshlrev_b32 v29, 16, v118
v_mfma_f32_16x16x32_bf16 v[164:167], v[108:111], v[68:71], v[164:167]
ds_read_b64_tr_b16 v[56:57], v20 offset:0
v_and_b32 v30, s59, v118
s_add_u32 m0, s42, 73728
s_add_u32 s76, s76, s46
buffer_load_dwordx4 v13, s[20:23], s76 offen sc1 lds
v_mfma_f32_16x16x32_bf16 v[208:211], v[36:39], v[68:71], v[208:211]
ds_read_b64_tr_b16 v[58:59], v20 offset:1024
v_add_f32 v25, v25, v29
v_mfma_f32_16x16x32_bf16 v[168:171], v[96:99], v[72:75], v[168:171]
v_add_f32 v26, v26, v30
v_mfma_f32_16x16x32_bf16 v[172:175], v[100:103], v[72:75], v[172:175]
v_fma_f32 v27, v29, v29, v27
v_mfma_f32_16x16x32_bf16 v[176:179], v[104:107], v[72:75], v[176:179]
v_fma_f32 v28, v30, v30, v28
v_mfma_f32_16x16x32_bf16 v[180:183], v[108:111], v[72:75], v[180:183]
v_lshlrev_b32 v29, 16, v119
v_mfma_f32_16x16x32_bf16 v[212:215], v[36:39], v[72:75], v[212:215]
v_and_b32 v30, s59, v119
v_mfma_f32_16x16x32_bf16 v[184:187], v[96:99], v[76:79], v[184:187]
v_add_f32 v25, v25, v29
v_mfma_f32_16x16x32_bf16 v[188:191], v[100:103], v[76:79], v[188:191]
v_add_f32 v26, v26, v30
v_mfma_f32_16x16x32_bf16 v[192:195], v[104:107], v[76:79], v[192:195]
v_fma_f32 v27, v29, v29, v27
v_mfma_f32_16x16x32_bf16 v[196:199], v[108:111], v[76:79], v[196:199]
v_fma_f32 v28, v30, v30, v28
v_mfma_f32_16x16x32_bf16 v[216:219], v[36:39], v[76:79], v[216:219]
s_waitcnt lgkmcnt(0)
s_barrier
v_lshlrev_b32 v8, 2, v1
s_mov_b64 exec, 3
buffer_load_dword v9, v8, s[96:99], 0 offen sc1
s_mov_b64 exec, -1
v_mfma_f32_16x16x32_bf16 v[120:123], v[40:43], v[80:83], v[120:123]
ds_read_b128 v[96:99], v15 offset:49152
v_lshlrev_b32 v29, 16, v112
v_and_b32 v30, s59, v112
v_mfma_f32_16x16x32_bf16 v[124:127], v[40:43], v[84:87], v[124:127]
ds_read_b128 v[100:103], v15 offset:51200
v_add_f32 v25, v25, v29
v_mfma_f32_16x16x32_bf16 v[128:131], v[40:43], v[88:91], v[128:131]
ds_read_b128 v[104:107], v15 offset:53248
v_add_f32 v26, v26, v30
s_add_u32 m0, s42, 0
s_add_u32 s75, s75, s46
buffer_load_dwordx4 v13, s[16:19], s75 offen sc1 lds
v_mfma_f32_16x16x32_bf16 v[132:135], v[40:43], v[92:95], v[132:135]
ds_read_b128 v[108:111], v15 offset:55296
v_fma_f32 v27, v29, v29, v27
v_mfma_f32_16x16x32_bf16 v[136:139], v[80:83], v[44:47], v[136:139]
ds_read_b64_tr_b16 v[60:61], v16 offset:53248
v_fma_f32 v28, v30, v30, v28
v_mfma_f32_16x16x32_bf16 v[140:143], v[84:87], v[44:47], v[140:143]
ds_read_b64_tr_b16 v[62:63], v16 offset:53760
v_lshlrev_b32 v29, 16, v113
v_and_b32 v30, s59, v113
v_mfma_f32_16x16x32_bf16 v[144:147], v[88:91], v[44:47], v[144:147]
ds_read_b128 v[116:119], v32 offset:49152
v_add_f32 v25, v25, v29
s_add_u32 m0, s42, 8192
s_add_u32 s76, s76, s46
buffer_load_dwordx4 v13, s[20:23], s76 offen sc1 lds
v_mfma_f32_16x16x32_bf16 v[148:151], v[92:95], v[44:47], v[148:151]
ds_read_b64_tr_b16 v[64:65], v17 offset:16384
v_add_f32 v26, v26, v30
v_mfma_f32_16x16x32_bf16 v[152:155], v[80:83], v[48:51], v[152:155]
ds_read_b64_tr_b16 v[66:67], v17 offset:17408
v_fma_f32 v27, v29, v29, v27
v_mfma_f32_16x16x32_bf16 v[156:159], v[84:87], v[48:51], v[156:159]
ds_read_b64_tr_b16 v[68:69], v18 offset:16384
v_fma_f32 v28, v30, v30, v28
v_mfma_f32_16x16x32_bf16 v[160:163], v[88:91], v[48:51], v[160:163]
ds_read_b64_tr_b16 v[70:71], v18 offset:17408
v_lshlrev_b32 v29, 16, v114
v_and_b32 v30, s59, v114
s_add_u32 m0, s40, 24576
s_add_u32 s82, s36, 896
buffer_load_dwordx4 v10, s[8:11], s82 offen sc1 lds
v_mfma_f32_16x16x32_bf16 v[164:167], v[92:95], v[48:51], v[164:167]
ds_read_b64_tr_b16 v[72:73], v19 offset:16384
v_add_f32 v25, v25, v29
v_mfma_f32_16x16x32_bf16 v[168:171], v[80:83], v[52:55], v[168:171]
ds_read_b64_tr_b16 v[74:75], v19 offset:17408
v_add_f32 v26, v26, v30
v_mfma_f32_16x16x32_bf16 v[172:175], v[84:87], v[52:55], v[172:175]
ds_read_b64_tr_b16 v[76:77], v20 offset:16384
v_fma_f32 v27, v29, v29, v27
v_mfma_f32_16x16x32_bf16 v[176:179], v[88:91], v[52:55], v[176:179]
ds_read_b64_tr_b16 v[78:79], v20 offset:17408
v_fma_f32 v28, v30, v30, v28
s_add_u32 m0, s40, 25600
s_add_u32 s33, s37, 1376256
buffer_load_dwordx4 v11, s[8:11], s82 offen sc1 lds
s_add_u32 m0, s41, 24576
s_nop 0
buffer_load_dwordx4 v12, s[12:15], s33 offen sc1 lds
v_mfma_f32_16x16x32_bf16 v[180:183], v[92:95], v[52:55], v[180:183]
v_lshlrev_b32 v29, 16, v115
v_and_b32 v30, s59, v115
v_mfma_f32_16x16x32_bf16 v[184:187], v[80:83], v[56:59], v[184:187]
v_add_f32 v25, v25, v29
v_mfma_f32_16x16x32_bf16 v[188:191], v[84:87], v[56:59], v[188:191]
v_add_f32 v26, v26, v30
v_mfma_f32_16x16x32_bf16 v[192:195], v[88:91], v[56:59], v[192:195]
v_fma_f32 v27, v29, v29, v27
v_mfma_f32_16x16x32_bf16 v[196:199], v[92:95], v[56:59], v[196:199]
v_fma_f32 v28, v30, v30, v28
s_waitcnt lgkmcnt(0)
s_waitcnt vmcnt(13)
s_waitcnt vmcnt(8)
s_barrier
v_mfma_f32_16x16x32_bf16 v[120:123], v[60:63], v[96:99], v[120:123]
ds_read_b128 v[80:83], v14 offset:0
v_lshlrev_b32 v29, 16, v116
v_mfma_f32_16x16x32_bf16 v[124:127], v[60:63], v[100:103], v[124:127]
ds_read_b128 v[84:87], v14 offset:2048
v_and_b32 v30, s59, v116
v_mfma_f32_16x16x32_bf16 v[128:131], v[60:63], v[104:107], v[128:131]
ds_read_b128 v[88:91], v14 offset:4096
v_add_f32 v25, v25, v29
v_mfma_f32_16x16x32_bf16 v[132:135], v[60:63], v[108:111], v[132:135]
ds_read_b128 v[92:95], v14 offset:6144
v_add_f32 v26, v26, v30
v_mfma_f32_16x16x32_bf16 v[200:203], v[60:63], v[36:39], v[200:203]
ds_read_b64_tr_b16 v[40:41], v16 offset:0
v_fma_f32 v27, v29, v29, v27
v_mfma_f32_16x16x32_bf16 v[136:139], v[96:99], v[64:67], v[136:139]
ds_read_b64_tr_b16 v[42:43], v16 offset:512
v_fma_f32 v28, v30, v30, v28
v_mfma_f32_16x16x32_bf16 v[140:143], v[100:103], v[64:67], v[140:143]
ds_read_b128 v[112:115], v31 offset:0
v_lshlrev_b32 v29, 16, v117
v_mfma_f32_16x16x32_bf16 v[144:147], v[104:107], v[64:67], v[144:147]
ds_read_b64_tr_b16 v[44:45], v21 offset:0
v_and_b32 v30, s59, v117
v_mfma_f32_16x16x32_bf16 v[148:151], v[108:111], v[64:67], v[148:151]
ds_read_b64_tr_b16 v[46:47], v21 offset:1024
v_add_f32 v25, v25, v29
v_mfma_f32_16x16x32_bf16 v[204:207], v[36:39], v[64:67], v[204:207]
ds_read_b64_tr_b16 v[48:49], v22 offset:0
v_add_f32 v26, v26, v30
v_mfma_f32_16x16x32_bf16 v[152:155], v[96:99], v[68:71], v[152:155]
ds_read_b64_tr_b16 v[50:51], v22 offset:1024
v_fma_f32 v27, v29, v29, v27
v_mfma_f32_16x16x32_bf16 v[156:159], v[100:103], v[68:71], v[156:159]
ds_read_b64_tr_b16 v[52:53], v23 offset:0
v_fma_f32 v28, v30, v30, v28
v_mfma_f32_16x16x32_bf16 v[160:163], v[104:107], v[68:71], v[160:163]
ds_read_b64_tr_b16 v[54:55], v23 offset:1024
v_lshlrev_b32 v29, 16, v118
v_mfma_f32_16x16x32_bf16 v[164:167], v[108:111], v[68:71], v[164:167]
ds_read_b64_tr_b16 v[56:57], v24 offset:0
v_and_b32 v30, s59, v118
v_mfma_f32_16x16x32_bf16 v[208:211], v[36:39], v[68:71], v[208:211]
ds_read_b64_tr_b16 v[58:59], v24 offset:1024
v_add_f32 v25, v25, v29
v_mfma_f32_16x16x32_bf16 v[168:171], v[96:99], v[72:75], v[168:171]
v_add_f32 v26, v26, v30
v_mfma_f32_16x16x32_bf16 v[172:175], v[100:103], v[72:75], v[172:175]
v_fma_f32 v27, v29, v29, v27
v_mfma_f32_16x16x32_bf16 v[176:179], v[104:107], v[72:75], v[176:179]
v_fma_f32 v28, v30, v30, v28
v_mfma_f32_16x16x32_bf16 v[180:183], v[108:111], v[72:75], v[180:183]
v_lshlrev_b32 v29, 16, v119
v_mfma_f32_16x16x32_bf16 v[212:215], v[36:39], v[72:75], v[212:215]
v_and_b32 v30, s59, v119
v_mfma_f32_16x16x32_bf16 v[184:187], v[96:99], v[76:79], v[184:187]
v_add_f32 v25, v25, v29
v_mfma_f32_16x16x32_bf16 v[188:191], v[100:103], v[76:79], v[188:191]
v_add_f32 v26, v26, v30
v_mfma_f32_16x16x32_bf16 v[192:195], v[104:107], v[76:79], v[192:195]
v_fma_f32 v27, v29, v29, v27
v_mfma_f32_16x16x32_bf16 v[196:199], v[108:111], v[76:79], v[196:199]
v_fma_f32 v28, v30, v30, v28
v_mfma_f32_16x16x32_bf16 v[216:219], v[36:39], v[76:79], v[216:219]
s_waitcnt lgkmcnt(0)
s_barrier
v_mfma_f32_16x16x32_bf16 v[120:123], v[40:43], v[80:83], v[120:123]
ds_read_b128 v[96:99], v15 offset:0
v_lshlrev_b32 v29, 16, v112
v_and_b32 v30, s59, v112
v_mfma_f32_16x16x32_bf16 v[124:127], v[40:43], v[84:87], v[124:127]
ds_read_b128 v[100:103], v15 offset:2048
v_add_f32 v25, v25, v29
v_mfma_f32_16x16x32_bf16 v[128:131], v[40:43], v[88:91], v[128:131]
ds_read_b128 v[104:107], v15 offset:4096
v_add_f32 v26, v26, v30
v_mfma_f32_16x16x32_bf16 v[132:135], v[40:43], v[92:95], v[132:135]
ds_read_b128 v[108:111], v15 offset:6144
v_fma_f32 v27, v29, v29, v27
v_mfma_f32_16x16x32_bf16 v[136:139], v[80:83], v[44:47], v[136:139]
ds_read_b64_tr_b16 v[60:61], v16 offset:4096
v_fma_f32 v28, v30, v30, v28
v_mfma_f32_16x16x32_bf16 v[140:143], v[84:87], v[44:47], v[140:143]
ds_read_b64_tr_b16 v[62:63], v16 offset:4608
v_lshlrev_b32 v29, 16, v113
v_and_b32 v30, s59, v113
v_mfma_f32_16x16x32_bf16 v[144:147], v[88:91], v[44:47], v[144:147]
ds_read_b128 v[116:119], v32 offset:0
v_add_f32 v25, v25, v29
v_mfma_f32_16x16x32_bf16 v[148:151], v[92:95], v[44:47], v[148:151]
ds_read_b64_tr_b16 v[64:65], v21 offset:16384
v_add_f32 v26, v26, v30
v_mfma_f32_16x16x32_bf16 v[152:155], v[80:83], v[48:51], v[152:155]
ds_read_b64_tr_b16 v[66:67], v21 offset:17408
v_fma_f32 v27, v29, v29, v27
v_mfma_f32_16x16x32_bf16 v[156:159], v[84:87], v[48:51], v[156:159]
ds_read_b64_tr_b16 v[68:69], v22 offset:16384
v_fma_f32 v28, v30, v30, v28
v_mfma_f32_16x16x32_bf16 v[160:163], v[88:91], v[48:51], v[160:163]
ds_read_b64_tr_b16 v[70:71], v22 offset:17408
v_lshlrev_b32 v29, 16, v114
v_and_b32 v30, s59, v114
v_mfma_f32_16x16x32_bf16 v[164:167], v[92:95], v[48:51], v[164:167]
ds_read_b64_tr_b16 v[72:73], v23 offset:16384
v_add_f32 v25, v25, v29
v_mfma_f32_16x16x32_bf16 v[168:171], v[80:83], v[52:55], v[168:171]
ds_read_b64_tr_b16 v[74:75], v23 offset:17408
v_add_f32 v26, v26, v30
v_mfma_f32_16x16x32_bf16 v[172:175], v[84:87], v[52:55], v[172:175]
ds_read_b64_tr_b16 v[76:77], v24 offset:16384
v_fma_f32 v27, v29, v29, v27
v_mfma_f32_16x16x32_bf16 v[176:179], v[88:91], v[52:55], v[176:179]
ds_read_b64_tr_b16 v[78:79], v24 offset:17408
v_fma_f32 v28, v30, v30, v28
v_mfma_f32_16x16x32_bf16 v[180:183], v[92:95], v[52:55], v[180:183]
v_lshlrev_b32 v29, 16, v115
v_and_b32 v30, s59, v115
v_mfma_f32_16x16x32_bf16 v[184:187], v[80:83], v[56:59], v[184:187]
v_add_f32 v25, v25, v29
v_mfma_f32_16x16x32_bf16 v[188:191], v[84:87], v[56:59], v[188:191]
v_add_f32 v26, v26, v30
v_mfma_f32_16x16x32_bf16 v[192:195], v[88:91], v[56:59], v[192:195]
v_fma_f32 v27, v29, v29, v27
v_mfma_f32_16x16x32_bf16 v[196:199], v[92:95], v[56:59], v[196:199]
v_fma_f32 v28, v30, v30, v28
s_waitcnt lgkmcnt(0)
s_waitcnt vmcnt(6)
s_waitcnt vmcnt(0)
s_barrier
v_mfma_f32_16x16x32_bf16 v[120:123], v[60:63], v[96:99], v[120:123]
ds_read_b128 v[80:83], v14 offset:24576
v_lshlrev_b32 v29, 16, v116
v_mfma_f32_16x16x32_bf16 v[124:127], v[60:63], v[100:103], v[124:127]
ds_read_b128 v[84:87], v14 offset:26624
v_and_b32 v30, s59, v116
v_mfma_f32_16x16x32_bf16 v[128:131], v[60:63], v[104:107], v[128:131]
ds_read_b128 v[88:91], v14 offset:28672
v_add_f32 v25, v25, v29
v_mfma_f32_16x16x32_bf16 v[132:135], v[60:63], v[108:111], v[132:135]
ds_read_b128 v[92:95], v14 offset:30720
v_add_f32 v26, v26, v30
v_mfma_f32_16x16x32_bf16 v[200:203], v[60:63], v[36:39], v[200:203]
ds_read_b64_tr_b16 v[40:41], v16 offset:24576
v_fma_f32 v27, v29, v29, v27
v_mfma_f32_16x16x32_bf16 v[136:139], v[96:99], v[64:67], v[136:139]
ds_read_b64_tr_b16 v[42:43], v16 offset:25088
v_fma_f32 v28, v30, v30, v28
v_mfma_f32_16x16x32_bf16 v[140:143], v[100:103], v[64:67], v[140:143]
ds_read_b128 v[112:115], v31 offset:24576
v_lshlrev_b32 v29, 16, v117
v_mfma_f32_16x16x32_bf16 v[144:147], v[104:107], v[64:67], v[144:147]
ds_read_b64_tr_b16 v[44:45], v21 offset:32768
v_and_b32 v30, s59, v117
v_mfma_f32_16x16x32_bf16 v[148:151], v[108:111], v[64:67], v[148:151]
ds_read_b64_tr_b16 v[46:47], v21 offset:33792
v_add_f32 v25, v25, v29
v_mfma_f32_16x16x32_bf16 v[204:207], v[36:39], v[64:67], v[204:207]
ds_read_b64_tr_b16 v[48:49], v22 offset:32768
v_add_f32 v26, v26, v30
v_mfma_f32_16x16x32_bf16 v[152:155], v[96:99], v[68:71], v[152:155]
ds_read_b64_tr_b16 v[50:51], v22 offset:33792
v_fma_f32 v27, v29, v29, v27
v_mfma_f32_16x16x32_bf16 v[156:159], v[100:103], v[68:71], v[156:159]
ds_read_b64_tr_b16 v[52:53], v23 offset:32768
v_fma_f32 v28, v30, v30, v28
v_mfma_f32_16x16x32_bf16 v[160:163], v[104:107], v[68:71], v[160:163]
ds_read_b64_tr_b16 v[54:55], v23 offset:33792
v_lshlrev_b32 v29, 16, v118
v_mfma_f32_16x16x32_bf16 v[164:167], v[108:111], v[68:71], v[164:167]
ds_read_b64_tr_b16 v[56:57], v24 offset:32768
v_and_b32 v30, s59, v118
v_mfma_f32_16x16x32_bf16 v[208:211], v[36:39], v[68:71], v[208:211]
ds_read_b64_tr_b16 v[58:59], v24 offset:33792
v_add_f32 v25, v25, v29
v_mfma_f32_16x16x32_bf16 v[168:171], v[96:99], v[72:75], v[168:171]
v_add_f32 v26, v26, v30
v_mfma_f32_16x16x32_bf16 v[172:175], v[100:103], v[72:75], v[172:175]
v_fma_f32 v27, v29, v29, v27
v_mfma_f32_16x16x32_bf16 v[176:179], v[104:107], v[72:75], v[176:179]
v_fma_f32 v28, v30, v30, v28
v_mfma_f32_16x16x32_bf16 v[180:183], v[108:111], v[72:75], v[180:183]
v_lshlrev_b32 v29, 16, v119
v_mfma_f32_16x16x32_bf16 v[212:215], v[36:39], v[72:75], v[212:215]
v_and_b32 v30, s59, v119
v_mfma_f32_16x16x32_bf16 v[184:187], v[96:99], v[76:79], v[184:187]
v_add_f32 v25, v25, v29
v_mfma_f32_16x16x32_bf16 v[188:191], v[100:103], v[76:79], v[188:191]
v_add_f32 v26, v26, v30
v_mfma_f32_16x16x32_bf16 v[192:195], v[104:107], v[76:79], v[192:195]
v_fma_f32 v27, v29, v29, v27
v_mfma_f32_16x16x32_bf16 v[196:199], v[108:111], v[76:79], v[196:199]
v_fma_f32 v28, v30, v30, v28
v_mfma_f32_16x16x32_bf16 v[216:219], v[36:39], v[76:79], v[216:219]
s_waitcnt lgkmcnt(0)
s_barrier
v_mfma_f32_16x16x32_bf16 v[120:123], v[40:43], v[80:83], v[120:123]
ds_read_b128 v[96:99], v15 offset:24576
v_lshlrev_b32 v29, 16, v112
v_and_b32 v30, s59, v112
v_mfma_f32_16x16x32_bf16 v[124:127], v[40:43], v[84:87], v[124:127]
ds_read_b128 v[100:103], v15 offset:26624
v_add_f32 v25, v25, v29
v_mfma_f32_16x16x32_bf16 v[128:131], v[40:43], v[88:91], v[128:131]
ds_read_b128 v[104:107], v15 offset:28672
v_add_f32 v26, v26, v30
v_mfma_f32_16x16x32_bf16 v[132:135], v[40:43], v[92:95], v[132:135]
ds_read_b128 v[108:111], v15 offset:30720
v_fma_f32 v27, v29, v29, v27
v_mfma_f32_16x16x32_bf16 v[136:139], v[80:83], v[44:47], v[136:139]
ds_read_b64_tr_b16 v[60:61], v16 offset:28672
v_fma_f32 v28, v30, v30, v28
v_mfma_f32_16x16x32_bf16 v[140:143], v[84:87], v[44:47], v[140:143]
ds_read_b64_tr_b16 v[62:63], v16 offset:29184
v_lshlrev_b32 v29, 16, v113
v_and_b32 v30, s59, v113
v_mfma_f32_16x16x32_bf16 v[144:147], v[88:91], v[44:47], v[144:147]
ds_read_b128 v[116:119], v32 offset:24576
v_add_f32 v25, v25, v29
v_mfma_f32_16x16x32_bf16 v[148:151], v[92:95], v[44:47], v[148:151]
ds_read_b64_tr_b16 v[64:65], v17 offset:0
v_add_f32 v26, v26, v30
v_mfma_f32_16x16x32_bf16 v[152:155], v[80:83], v[48:51], v[152:155]
ds_read_b64_tr_b16 v[66:67], v17 offset:1024
v_fma_f32 v27, v29, v29, v27
v_mfma_f32_16x16x32_bf16 v[156:159], v[84:87], v[48:51], v[156:159]
ds_read_b64_tr_b16 v[68:69], v18 offset:0
v_fma_f32 v28, v30, v30, v28
v_mfma_f32_16x16x32_bf16 v[160:163], v[88:91], v[48:51], v[160:163]
ds_read_b64_tr_b16 v[70:71], v18 offset:1024
v_lshlrev_b32 v29, 16, v114
v_and_b32 v30, s59, v114
v_mfma_f32_16x16x32_bf16 v[164:167], v[92:95], v[48:51], v[164:167]
ds_read_b64_tr_b16 v[72:73], v19 offset:0
v_add_f32 v25, v25, v29
v_mfma_f32_16x16x32_bf16 v[168:171], v[80:83], v[52:55], v[168:171]
ds_read_b64_tr_b16 v[74:75], v19 offset:1024
v_add_f32 v26, v26, v30
v_mfma_f32_16x16x32_bf16 v[172:175], v[84:87], v[52:55], v[172:175]
ds_read_b64_tr_b16 v[76:77], v20 offset:0
v_fma_f32 v27, v29, v29, v27
v_mfma_f32_16x16x32_bf16 v[176:179], v[88:91], v[52:55], v[176:179]
ds_read_b64_tr_b16 v[78:79], v20 offset:1024
v_fma_f32 v28, v30, v30, v28
v_mfma_f32_16x16x32_bf16 v[180:183], v[92:95], v[52:55], v[180:183]
v_lshlrev_b32 v29, 16, v115
v_and_b32 v30, s59, v115
v_mfma_f32_16x16x32_bf16 v[184:187], v[80:83], v[56:59], v[184:187]
v_add_f32 v25, v25, v29
v_mfma_f32_16x16x32_bf16 v[188:191], v[84:87], v[56:59], v[188:191]
v_add_f32 v26, v26, v30
v_mfma_f32_16x16x32_bf16 v[192:195], v[88:91], v[56:59], v[192:195]
v_fma_f32 v27, v29, v29, v27
v_mfma_f32_16x16x32_bf16 v[196:199], v[92:95], v[56:59], v[196:199]
v_fma_f32 v28, v30, v30, v28
s_waitcnt lgkmcnt(0)
s_barrier
v_mfma_f32_16x16x32_bf16 v[120:123], v[60:63], v[96:99], v[120:123]
v_lshlrev_b32 v29, 16, v116
v_mfma_f32_16x16x32_bf16 v[124:127], v[60:63], v[100:103], v[124:127]
v_and_b32 v30, s59, v116
v_mfma_f32_16x16x32_bf16 v[128:131], v[60:63], v[104:107], v[128:131]
v_add_f32 v25, v25, v29
v_mfma_f32_16x16x32_bf16 v[132:135], v[60:63], v[108:111], v[132:135]
v_add_f32 v26, v26, v30
v_mfma_f32_16x16x32_bf16 v[200:203], v[60:63], v[36:39], v[200:203]
v_fma_f32 v27, v29, v29, v27
v_mfma_f32_16x16x32_bf16 v[136:139], v[96:99], v[64:67], v[136:139]
v_fma_f32 v28, v30, v30, v28
v_mfma_f32_16x16x32_bf16 v[140:143], v[100:103], v[64:67], v[140:143]
v_lshlrev_b32 v29, 16, v117
v_mfma_f32_16x16x32_bf16 v[144:147], v[104:107], v[64:67], v[144:147]
v_and_b32 v30, s59, v117
v_mfma_f32_16x16x32_bf16 v[148:151], v[108:111], v[64:67], v[148:151]
v_add_f32 v25, v25, v29
v_mfma_f32_16x16x32_bf16 v[204:207], v[36:39], v[64:67], v[204:207]
v_add_f32 v26, v26, v30
v_mfma_f32_16x16x32_bf16 v[152:155], v[96:99], v[68:71], v[152:155]
v_fma_f32 v27, v29, v29, v27
v_mfma_f32_16x16x32_bf16 v[156:159], v[100:103], v[68:71], v[156:159]
v_fma_f32 v28, v30, v30, v28
v_mfma_f32_16x16x32_bf16 v[160:163], v[104:107], v[68:71], v[160:163]
v_lshlrev_b32 v29, 16, v118
v_mfma_f32_16x16x32_bf16 v[164:167], v[108:111], v[68:71], v[164:167]
v_and_b32 v30, s59, v118
v_mfma_f32_16x16x32_bf16 v[208:211], v[36:39], v[68:71], v[208:211]
v_add_f32 v25, v25, v29
v_mfma_f32_16x16x32_bf16 v[168:171], v[96:99], v[72:75], v[168:171]
v_add_f32 v26, v26, v30
v_mfma_f32_16x16x32_bf16 v[172:175], v[100:103], v[72:75], v[172:175]
v_fma_f32 v27, v29, v29, v27
v_mfma_f32_16x16x32_bf16 v[176:179], v[104:107], v[72:75], v[176:179]
v_fma_f32 v28, v30, v30, v28
v_mfma_f32_16x16x32_bf16 v[180:183], v[108:111], v[72:75], v[180:183]
v_lshlrev_b32 v29, 16, v119
v_mfma_f32_16x16x32_bf16 v[212:215], v[36:39], v[72:75], v[212:215]
v_and_b32 v30, s59, v119
v_mfma_f32_16x16x32_bf16 v[184:187], v[96:99], v[76:79], v[184:187]
v_add_f32 v25, v25, v29
v_mfma_f32_16x16x32_bf16 v[188:191], v[100:103], v[76:79], v[188:191]
v_add_f32 v26, v26, v30
v_mfma_f32_16x16x32_bf16 v[192:195], v[104:107], v[76:79], v[192:195]
v_fma_f32 v27, v29, v29, v27
v_mfma_f32_16x16x32_bf16 v[196:199], v[108:111], v[76:79], v[196:199]
v_fma_f32 v28, v30, v30, v28
v_mfma_f32_16x16x32_bf16 v[216:219], v[36:39], v[76:79], v[216:219]
parallel_sum__mha_block__geglu_ffn__prompt_kernel_Btail:
s_nop 7
s_mov_b64 exec, 3
v_cmp_ne_u32 vcc, 0x01010101, v9
s_mov_b64 exec, -1
s_nop 2
s_cmp_eq_u64 vcc, 0
s_cbranch_scc1 parallel_sum__mha_block__geglu_ffn__prompt_kernel_clrokB
s_mov_b32 s83, 100000
s_mov_b32 s4, 0x3
s_mov_b32 s5, 0x0
s_mov_b64 exec, s[4:5]
poll2:
buffer_load_dword v9, v8, s[96:99], 0 offen sc1
s_waitcnt vmcnt(0)
v_cmp_ne_u32 vcc, 0x01010101, v9
s_nop 3
s_cmp_eq_u64 vcc, 0
s_cbranch_scc1 poll2_ok
s_sleep 2
s_sub_u32 s83, s83, 1
s_cmp_lg_u32 s83, 0
s_cbranch_scc1 poll2
poll2_ok:
s_mov_b64 exec, -1
parallel_sum__mha_block__geglu_ffn__prompt_kernel_clrokB:
v_add_f32 v25, v25, v26
v_add_f32 v27, v27, v28
v_mov_b32 v4, v25
s_nop 1
v_permlane32_swap_b32 v25, v4
v_add_f32 v25, v25, v4
v_mov_b32 v4, v25
s_nop 1
v_permlane16_swap_b32 v25, v4
v_add_f32 v25, v25, v4
v_mov_b32 v4, v27
s_nop 1
v_permlane32_swap_b32 v27, v4
v_add_f32 v27, v27, v4
v_mov_b32 v4, v27
s_nop 1
v_permlane16_swap_b32 v27, v4
v_add_f32 v27, v27, v4
v_mul_f32 v25, 0x3b000000, v25
v_mul_f32 v27, 0x3b000000, v27
v_fma_f32 v27, -v25, v25, v27
v_max_f32 v27, 0, v27
v_add_f32 v27, 0x3727c5ac, v27
v_rsq_f32 v26, v27
v_sqrt_f32 v29, v27
v_sub_f32 v28, 0, v25
s_lshl_b32 s33, s31, 6
s_lshl_b32 s34, s32, 4
s_add_u32 s33, s33, s34
v_add_u32 v4, s33, v2
v_lshlrev_b32 v4, 2, v4
v_add_u32 v4, 155648, v4
ds_write_b32 v4, v26
ds_write_b32 v4, v28 offset:512
ds_write_b32 v4, v29 offset:1024
s_mul_i32 s33, s32, 320
s_mul_i32 s34, s58, 1280
s_add_u32 s33, s33, s34
s_add_u32 s33, s33, 157184
v_lshlrev_b32 v5, 4, v3
v_add_u32 v5, s33, v5
v_lshlrev_b32 v6, 2, v2
v_add_u32 v6, s33, v6
s_nop 7
s_mov_b32 s4, 0x00010001
s_mov_b32 s5, 0x00010001
s_mov_b64 exec, s[4:5]
ds_write_b128 v5, v[200:203] offset:0
s_mov_b64 exec, 0xffff
ds_write_b32 v6, v204 offset:64
ds_write_b32 v6, v208 offset:128
ds_write_b32 v6, v212 offset:192
ds_write_b32 v6, v216 offset:256
s_mov_b64 exec, -1
s_waitcnt lgkmcnt(0)
s_barrier
v_lshlrev_b32 v232, 4, v1
s_lshl_b32 s33, s31, 6
v_add_u32 v4, s33, v2
v_lshlrev_b32 v4, 2, v4
v_add_u32 v4, 155648, v4
ds_read_b32 v220, v4 offset:0
ds_read_b32 v224, v4 offset:512
ds_read_b32 v221, v4 offset:64
ds_read_b32 v225, v4 offset:576
ds_read_b32 v222, v4 offset:128
ds_read_b32 v226, v4 offset:640
ds_read_b32 v223, v4 offset:192
ds_read_b32 v227, v4 offset:704
s_mul_i32 s33, s32, 320
v_lshlrev_b32 v5, 4, v3
v_add_u32 v5, s33, v5
v_add_u32 v5, 157184, v5
ds_read_b128 v[48:51], v5 offset:0
ds_read_b128 v[200:203], v5 offset:1280
s_waitcnt lgkmcnt(0)
v_add_f32 v48, v48, v200
v_add_f32 v49, v49, v201
v_add_f32 v50, v50, v202
v_add_f32 v51, v51, v203
s_cmp_lt_u32 s30, 8
s_cselect_b32 s44, 0x3eb8aa3b, 1.0
v_mul_f32 v233, s44, v220
v_pk_fma_f32 v[120:121], v[224:225], v[48:49], v[120:121] op_sel:[0,0,0] op_sel_hi:[0,1,1]
v_pk_fma_f32 v[122:123], v[224:225], v[50:51], v[122:123] op_sel:[0,0,0] op_sel_hi:[0,1,1]
v_pk_mul_f32 v[120:121], v[120:121], v[232:233] op_sel:[0,1] op_sel_hi:[1,1]
v_pk_mul_f32 v[122:123], v[122:123], v[232:233] op_sel:[0,1] op_sel_hi:[1,1]
v_cvt_pk_bf16_f32 v40, v120, v121
v_cvt_pk_bf16_f32 v41, v122, v123
v_mul_f32 v233, s44, v221
v_pk_fma_f32 v[124:125], v[224:225], v[48:49], v[124:125] op_sel:[1,0,0] op_sel_hi:[1,1,1]
v_pk_fma_f32 v[126:127], v[224:225], v[50:51], v[126:127] op_sel:[1,0,0] op_sel_hi:[1,1,1]
v_pk_mul_f32 v[124:125], v[124:125], v[232:233] op_sel:[0,1] op_sel_hi:[1,1]
v_pk_mul_f32 v[126:127], v[126:127], v[232:233] op_sel:[0,1] op_sel_hi:[1,1]
v_cvt_pk_bf16_f32 v42, v124, v125
v_cvt_pk_bf16_f32 v43, v126, v127
v_mul_f32 v233, s44, v222
v_pk_fma_f32 v[128:129], v[226:227], v[48:49], v[128:129] op_sel:[0,0,0] op_sel_hi:[0,1,1]
v_pk_fma_f32 v[130:131], v[226:227], v[50:51], v[130:131] op_sel:[0,0,0] op_sel_hi:[0,1,1]
v_pk_mul_f32 v[128:129], v[128:129], v[232:233] op_sel:[0,1] op_sel_hi:[1,1]
v_pk_mul_f32 v[130:131], v[130:131], v[232:233] op_sel:[0,1] op_sel_hi:[1,1]
v_cvt_pk_bf16_f32 v44, v128, v129
v_cvt_pk_bf16_f32 v45, v130, v131
v_mul_f32 v233, s44, v223
v_pk_fma_f32 v[132:133], v[226:227], v[48:49], v[132:133] op_sel:[1,0,0] op_sel_hi:[1,1,1]
v_pk_fma_f32 v[134:135], v[226:227], v[50:51], v[134:135] op_sel:[1,0,0] op_sel_hi:[1,1,1]
v_pk_mul_f32 v[132:133], v[132:133], v[232:233] op_sel:[0,1] op_sel_hi:[1,1]
v_pk_mul_f32 v[134:135], v[134:135], v[232:233] op_sel:[0,1] op_sel_hi:[1,1]
v_cvt_pk_bf16_f32 v46, v132, v133
v_cvt_pk_bf16_f32 v47, v134, v135
s_and_b32 s33, s30, 7
s_lshl_b32 s33, s33, 2
s_add_u32 s33, s33, s32
s_lshl_b32 s33, s33, 16
s_cmp_lt_u32 s30, 8
s_cselect_b32 s34, 0, 2097152
s_add_u32 s33, s33, s34
s_lshl_b32 s34, s29, 2
s_lshl_b32 s45, s31, 1
s_add_u32 s34, s34, s45
s_lshl_b32 s34, s34, 10
s_add_u32 s33, s33, s34
v_permlane16_swap_b32 v40, v42
v_permlane16_swap_b32 v41, v43
buffer_store_dwordx4 v[40:43], v232, s[24:27], s33 offen offset:0 sc1
v_permlane16_swap_b32 v44, v46
v_permlane16_swap_b32 v45, v47
buffer_store_dwordx4 v[44:47], v232, s[24:27], s33 offen offset:1024 sc1
s_lshl_b32 s33, s31, 8
v_lshlrev_b32 v6, 4, v3
v_add_u32 v6, s33, v6
v_add_u32 v6, 155648, v6
ds_read_b128 v[56:59], v6 offset:0
ds_read_b128 v[72:75], v6 offset:512
ds_read_b128 v[60:63], v6 offset:64
ds_read_b128 v[76:79], v6 offset:576
ds_read_b128 v[64:67], v6 offset:128
ds_read_b128 v[80:83], v6 offset:640
ds_read_b128 v[68:71], v6 offset:192
ds_read_b128 v[84:87], v6 offset:704
s_mul_i32 s33, s32, 320
v_lshlrev_b32 v7, 2, v2
v_add_u32 v7, s33, v7
v_add_u32 v7, 157184, v7
ds_read_b32 v88, v7 offset:64
ds_read_b32 v204, v7 offset:1344
ds_read_b32 v89, v7 offset:128
ds_read_b32 v208, v7 offset:1408
ds_read_b32 v90, v7 offset:192
ds_read_b32 v212, v7 offset:1472
ds_read_b32 v91, v7 offset:256
ds_read_b32 v216, v7 offset:1536
s_waitcnt lgkmcnt(6)
v_add_f32 v88, v88, v204
s_waitcnt lgkmcnt(4)
v_add_f32 v89, v89, v208
s_waitcnt lgkmcnt(2)
v_add_f32 v90, v90, v212
s_waitcnt lgkmcnt(0)
v_add_f32 v91, v91, v216
s_sub_u32 s33, s30, 14
s_lshl_b32 s33, s33, 4
s_lshl_b32 s34, s32, 2
s_add_u32 s33, s33, s34
s_lshl_b32 s33, s33, 16
s_lshl_b32 s34, s29, 2
s_lshl_b32 s45, s31, 1
s_add_u32 s34, s34, s45
s_lshl_b32 s34, s34, 10
s_add_u32 s33, s33, s34
s_add_u32 s33, s33, 4194304
v_pk_fma_f32 v[136:137], v[72:73], v[88:89], v[136:137] op_sel:[0,0,0] op_sel_hi:[1,0,1]
v_pk_fma_f32 v[138:139], v[74:75], v[88:89], v[138:139] op_sel:[0,0,0] op_sel_hi:[1,0,1]
v_pk_mul_f32 v[136:137], v[136:137], v[56:57] op_sel:[0,0] op_sel_hi:[1,1]
v_pk_mul_f32 v[138:139], v[138:139], v[58:59] op_sel:[0,0] op_sel_hi:[1,1]
v_cvt_pk_bf16_f32 v92, v136, v137
v_cvt_pk_bf16_f32 v93, v138, v139
v_pk_fma_f32 v[140:141], v[76:77], v[88:89], v[140:141] op_sel:[0,0,0] op_sel_hi:[1,0,1]
v_pk_fma_f32 v[142:143], v[78:79], v[88:89], v[142:143] op_sel:[0,0,0] op_sel_hi:[1,0,1]
v_pk_mul_f32 v[140:141], v[140:141], v[60:61] op_sel:[0,0] op_sel_hi:[1,1]
v_pk_mul_f32 v[142:143], v[142:143], v[62:63] op_sel:[0,0] op_sel_hi:[1,1]
v_cvt_pk_bf16_f32 v94, v140, v141
v_cvt_pk_bf16_f32 v95, v142, v143
s_nop 0
v_permlane32_swap_b32 v92, v94
v_permlane32_swap_b32 v93, v95
buffer_store_dwordx4 v[92:95], v232, s[24:27], s33 offen offset:0 sc1
v_pk_fma_f32 v[144:145], v[80:81], v[88:89], v[144:145] op_sel:[0,0,0] op_sel_hi:[1,0,1]
v_pk_fma_f32 v[146:147], v[82:83], v[88:89], v[146:147] op_sel:[0,0,0] op_sel_hi:[1,0,1]
v_pk_mul_f32 v[144:145], v[144:145], v[64:65] op_sel:[0,0] op_sel_hi:[1,1]
v_pk_mul_f32 v[146:147], v[146:147], v[66:67] op_sel:[0,0] op_sel_hi:[1,1]
v_cvt_pk_bf16_f32 v96, v144, v145
v_cvt_pk_bf16_f32 v97, v146, v147
v_pk_fma_f32 v[148:149], v[84:85], v[88:89], v[148:149] op_sel:[0,0,0] op_sel_hi:[1,0,1]
v_pk_fma_f32 v[150:151], v[86:87], v[88:89], v[150:151] op_sel:[0,0,0] op_sel_hi:[1,0,1]
v_pk_mul_f32 v[148:149], v[148:149], v[68:69] op_sel:[0,0] op_sel_hi:[1,1]
v_pk_mul_f32 v[150:151], v[150:151], v[70:71] op_sel:[0,0] op_sel_hi:[1,1]
v_cvt_pk_bf16_f32 v98, v148, v149
v_cvt_pk_bf16_f32 v99, v150, v151
s_nop 0
v_permlane32_swap_b32 v96, v98
v_permlane32_swap_b32 v97, v99
buffer_store_dwordx4 v[96:99], v232, s[24:27], s33 offen offset:1024 sc1
s_add_u32 s33, s33, 65536
v_pk_fma_f32 v[152:153], v[72:73], v[88:89], v[152:153] op_sel:[0,1,0] op_sel_hi:[1,1,1]
v_pk_fma_f32 v[154:155], v[74:75], v[88:89], v[154:155] op_sel:[0,1,0] op_sel_hi:[1,1,1]
v_pk_mul_f32 v[152:153], v[152:153], v[56:57] op_sel:[0,0] op_sel_hi:[1,1]
v_pk_mul_f32 v[154:155], v[154:155], v[58:59] op_sel:[0,0] op_sel_hi:[1,1]
v_cvt_pk_bf16_f32 v92, v152, v153
v_cvt_pk_bf16_f32 v93, v154, v155
v_pk_fma_f32 v[156:157], v[76:77], v[88:89], v[156:157] op_sel:[0,1,0] op_sel_hi:[1,1,1]
v_pk_fma_f32 v[158:159], v[78:79], v[88:89], v[158:159] op_sel:[0,1,0] op_sel_hi:[1,1,1]
v_pk_mul_f32 v[156:157], v[156:157], v[60:61] op_sel:[0,0] op_sel_hi:[1,1]
v_pk_mul_f32 v[158:159], v[158:159], v[62:63] op_sel:[0,0] op_sel_hi:[1,1]
v_cvt_pk_bf16_f32 v94, v156, v157
v_cvt_pk_bf16_f32 v95, v158, v159
s_nop 0
v_permlane32_swap_b32 v92, v94
v_permlane32_swap_b32 v93, v95
buffer_store_dwordx4 v[92:95], v232, s[24:27], s33 offen offset:0 sc1
v_pk_fma_f32 v[160:161], v[80:81], v[88:89], v[160:161] op_sel:[0,1,0] op_sel_hi:[1,1,1]
v_pk_fma_f32 v[162:163], v[82:83], v[88:89], v[162:163] op_sel:[0,1,0] op_sel_hi:[1,1,1]
v_pk_mul_f32 v[160:161], v[160:161], v[64:65] op_sel:[0,0] op_sel_hi:[1,1]
v_pk_mul_f32 v[162:163], v[162:163], v[66:67] op_sel:[0,0] op_sel_hi:[1,1]
v_cvt_pk_bf16_f32 v96, v160, v161
v_cvt_pk_bf16_f32 v97, v162, v163
v_pk_fma_f32 v[164:165], v[84:85], v[88:89], v[164:165] op_sel:[0,1,0] op_sel_hi:[1,1,1]
v_pk_fma_f32 v[166:167], v[86:87], v[88:89], v[166:167] op_sel:[0,1,0] op_sel_hi:[1,1,1]
v_pk_mul_f32 v[164:165], v[164:165], v[68:69] op_sel:[0,0] op_sel_hi:[1,1]
v_pk_mul_f32 v[166:167], v[166:167], v[70:71] op_sel:[0,0] op_sel_hi:[1,1]
v_cvt_pk_bf16_f32 v98, v164, v165
v_cvt_pk_bf16_f32 v99, v166, v167
s_nop 0
v_permlane32_swap_b32 v96, v98
v_permlane32_swap_b32 v97, v99
buffer_store_dwordx4 v[96:99], v232, s[24:27], s33 offen offset:1024 sc1
s_add_u32 s33, s33, 65536
v_pk_fma_f32 v[168:169], v[72:73], v[90:91], v[168:169] op_sel:[0,0,0] op_sel_hi:[1,0,1]
v_pk_fma_f32 v[170:171], v[74:75], v[90:91], v[170:171] op_sel:[0,0,0] op_sel_hi:[1,0,1]
v_pk_mul_f32 v[168:169], v[168:169], v[56:57] op_sel:[0,0] op_sel_hi:[1,1]
v_pk_mul_f32 v[170:171], v[170:171], v[58:59] op_sel:[0,0] op_sel_hi:[1,1]
v_cvt_pk_bf16_f32 v92, v168, v169
v_cvt_pk_bf16_f32 v93, v170, v171
v_pk_fma_f32 v[172:173], v[76:77], v[90:91], v[172:173] op_sel:[0,0,0] op_sel_hi:[1,0,1]
v_pk_fma_f32 v[174:175], v[78:79], v[90:91], v[174:175] op_sel:[0,0,0] op_sel_hi:[1,0,1]
v_pk_mul_f32 v[172:173], v[172:173], v[60:61] op_sel:[0,0] op_sel_hi:[1,1]
v_pk_mul_f32 v[174:175], v[174:175], v[62:63] op_sel:[0,0] op_sel_hi:[1,1]
v_cvt_pk_bf16_f32 v94, v172, v173
v_cvt_pk_bf16_f32 v95, v174, v175
s_nop 0
v_permlane32_swap_b32 v92, v94
v_permlane32_swap_b32 v93, v95
buffer_store_dwordx4 v[92:95], v232, s[24:27], s33 offen offset:0 sc1
v_pk_fma_f32 v[176:177], v[80:81], v[90:91], v[176:177] op_sel:[0,0,0] op_sel_hi:[1,0,1]
v_pk_fma_f32 v[178:179], v[82:83], v[90:91], v[178:179] op_sel:[0,0,0] op_sel_hi:[1,0,1]
v_pk_mul_f32 v[176:177], v[176:177], v[64:65] op_sel:[0,0] op_sel_hi:[1,1]
v_pk_mul_f32 v[178:179], v[178:179], v[66:67] op_sel:[0,0] op_sel_hi:[1,1]
v_cvt_pk_bf16_f32 v96, v176, v177
v_cvt_pk_bf16_f32 v97, v178, v179
v_pk_fma_f32 v[180:181], v[84:85], v[90:91], v[180:181] op_sel:[0,0,0] op_sel_hi:[1,0,1]
v_pk_fma_f32 v[182:183], v[86:87], v[90:91], v[182:183] op_sel:[0,0,0] op_sel_hi:[1,0,1]
v_pk_mul_f32 v[180:181], v[180:181], v[68:69] op_sel:[0,0] op_sel_hi:[1,1]
v_pk_mul_f32 v[182:183], v[182:183], v[70:71] op_sel:[0,0] op_sel_hi:[1,1]
v_cvt_pk_bf16_f32 v98, v180, v181
v_cvt_pk_bf16_f32 v99, v182, v183
s_nop 0
v_permlane32_swap_b32 v96, v98
v_permlane32_swap_b32 v97, v99
buffer_store_dwordx4 v[96:99], v232, s[24:27], s33 offen offset:1024 sc1
s_add_u32 s33, s33, 65536
v_pk_fma_f32 v[184:185], v[72:73], v[90:91], v[184:185] op_sel:[0,1,0] op_sel_hi:[1,1,1]
v_pk_fma_f32 v[186:187], v[74:75], v[90:91], v[186:187] op_sel:[0,1,0] op_sel_hi:[1,1,1]
v_pk_mul_f32 v[184:185], v[184:185], v[56:57] op_sel:[0,0] op_sel_hi:[1,1]
v_pk_mul_f32 v[186:187], v[186:187], v[58:59] op_sel:[0,0] op_sel_hi:[1,1]
v_cvt_pk_bf16_f32 v92, v184, v185
v_cvt_pk_bf16_f32 v93, v186, v187
v_pk_fma_f32 v[188:189], v[76:77], v[90:91], v[188:189] op_sel:[0,1,0] op_sel_hi:[1,1,1]
v_pk_fma_f32 v[190:191], v[78:79], v[90:91], v[190:191] op_sel:[0,1,0] op_sel_hi:[1,1,1]
v_pk_mul_f32 v[188:189], v[188:189], v[60:61] op_sel:[0,0] op_sel_hi:[1,1]
v_pk_mul_f32 v[190:191], v[190:191], v[62:63] op_sel:[0,0] op_sel_hi:[1,1]
v_cvt_pk_bf16_f32 v94, v188, v189
v_cvt_pk_bf16_f32 v95, v190, v191
s_nop 0
v_permlane32_swap_b32 v92, v94
v_permlane32_swap_b32 v93, v95
buffer_store_dwordx4 v[92:95], v232, s[24:27], s33 offen offset:0 sc1
v_pk_fma_f32 v[192:193], v[80:81], v[90:91], v[192:193] op_sel:[0,1,0] op_sel_hi:[1,1,1]
v_pk_fma_f32 v[194:195], v[82:83], v[90:91], v[194:195] op_sel:[0,1,0] op_sel_hi:[1,1,1]
v_pk_mul_f32 v[192:193], v[192:193], v[64:65] op_sel:[0,0] op_sel_hi:[1,1]
v_pk_mul_f32 v[194:195], v[194:195], v[66:67] op_sel:[0,0] op_sel_hi:[1,1]
v_cvt_pk_bf16_f32 v96, v192, v193
v_cvt_pk_bf16_f32 v97, v194, v195
v_pk_fma_f32 v[196:197], v[84:85], v[90:91], v[196:197] op_sel:[0,1,0] op_sel_hi:[1,1,1]
v_pk_fma_f32 v[198:199], v[86:87], v[90:91], v[198:199] op_sel:[0,1,0] op_sel_hi:[1,1,1]
v_pk_mul_f32 v[196:197], v[196:197], v[68:69] op_sel:[0,0] op_sel_hi:[1,1]
v_pk_mul_f32 v[198:199], v[198:199], v[70:71] op_sel:[0,0] op_sel_hi:[1,1]
v_cvt_pk_bf16_f32 v98, v196, v197
v_cvt_pk_bf16_f32 v99, v198, v199
s_nop 0
v_permlane32_swap_b32 v96, v98
v_permlane32_swap_b32 v97, v99
buffer_store_dwordx4 v[96:99], v232, s[24:27], s33 offen offset:1024 sc1
s_waitcnt vmcnt(0)
s_barrier
s_cmp_lg_u32 s28, 0
s_cbranch_scc1 parallel_sum__mha_block__geglu_ffn__prompt_kernel_pv
v_mov_b32 v8, 0
v_mov_b32 v9, 1
s_mov_b64 exec, 1
buffer_atomic_add v9, v8, s[24:27], s94 offen sc1
s_mov_b64 exec, -1
parallel_sum__mha_block__geglu_ffn__prompt_kernel_pv:
s_mov_b32 s101, 1
s_branch parallel_sum__mha_block__geglu_ffn__prompt_kernel_p2
parallel_sum__mha_block__geglu_ffn__prompt_kernel_p2:
s_load_dwordx4 s[52:55], s[0:1], 0
s_load_dwordx2 s[56:57], s[0:1], 16
s_load_dwordx4 s[60:63], s[0:1], 48
s_load_dwordx4 s[4:7], s[0:1], 64
v_and_b32 v1, 63, v0
v_lshrrev_b32 v3, 6, v0
v_lshlrev_b32 v2, 4, v1
v_readfirstlane_b32 s32, v3
s_and_b32 s33, s2, 7
s_lshl_b32 s33, s33, 2
s_lshr_b32 s35, s2, 6
s_add_u32 s33, s33, s35
s_lshr_b32 s34, s2, 3
s_and_b32 s34, s34, 7
s_waitcnt lgkmcnt(0)
s_mov_b32 s8, s6
s_and_b32 s9, s7, 0xffff
s_mov_b32 s10, 0x2000000
s_mov_b32 s11, 0x20000
s_mov_b32 s28, s4
s_and_b32 s29, s5, 0xffff
s_mov_b32 s30, 0x100
s_mov_b32 s31, 0x20000
s_mov_b32 s20, s52
s_and_b32 s21, s53, 0xffff
s_mov_b32 s22, 0x200000
s_mov_b32 s23, 0x20000
s_mov_b32 s16, s56
s_and_b32 s17, s57, 0xffff
s_mov_b32 s18, 0x80000
s_mov_b32 s19, 0x20000
s_mov_b32 s12, s60
s_and_b32 s13, s61, 0xffff
s_mov_b32 s14, 0x1c0000
s_mov_b32 s15, 0x20000
s_mov_b32 s24, s62
s_and_b32 s25, s63, 0xffff
s_mov_b32 s26, 0x200000
s_mov_b32 s27, 0x20000
s_lshr_b32 s35, s33, 2
s_lshl_b32 s35, s35, 11
s_lshr_b32 s36, s33, 4
s_add_u32 s36, s36, 14
s_lshl_b32 s36, s36, 11
v_and_b32 v3, 15, v1
v_lshlrev_b32 v3, 7, v3
s_add_u32 s37, s35, 16384
v_mov_b32 v4, s37
v_mov_b32 v5, s36
v_cmp_gt_u32 vcc, 16, v1
s_nop 1
v_cndmask_b32 v4, v5, v4, vcc
s_lshl_b32 s36, s34, 8
s_add_u32 s35, s35, s36
v_mov_b32 v5, s35
v_cmp_gt_u32 vcc, 32, v1
s_nop 1
v_cndmask_b32 v4, v5, v4, vcc
v_add_u32 v3, v3, v4
s_mov_b32 s37, 20971520
s_cmp_lg_u32 s32, 0
s_cbranch_scc1 parallel_sum__mha_block__geglu_ffn__prompt_kernel_nopoll
s_mov_b32 s49, 100000
s_mov_b32 s4, 0xffffffff
s_mov_b32 s5, 0x3
s_mov_b64 exec, s[4:5]
poll3:
buffer_load_dword v4, v3, s[8:11], s37 offen sc1
s_waitcnt vmcnt(0)
v_cmp_ne_u32 vcc, 1, v4
s_nop 3
s_cmp_eq_u64 vcc, 0
s_cbranch_scc1 poll3_ok
s_sleep 2
s_sub_u32 s49, s49, 1
s_cmp_lg_u32 s49, 0
s_cbranch_scc1 poll3
poll3_ok:
s_mov_b64 exec, -1
parallel_sum__mha_block__geglu_ffn__prompt_kernel_nopoll:
s_barrier
s_lshl_b32 s48, s33, 16
s_lshl_b32 s37, s32, 10
s_add_u32 s48, s48, s37
s_add_u32 m0, s37, 0
s_add_u32 s36, s48, 2097152
buffer_load_dwordx4 v2, s[8:11], s36 offen sc1 lds
s_add_u32 m0, s37, 65536
s_add_u32 s36, s48, 4194304
buffer_load_dwordx4 v2, s[8:11], s36 offen sc1 lds
s_cmp_ge_u32 s32, 4
s_cbranch_scc1 parallel_sum__mha_block__geglu_ffn__prompt_kernel_G
s_lshl_b32 s35, s33, 16
s_lshl_b32 s36, s34, 13
s_add_u32 s35, s35, s36
s_lshl_b32 s36, s32, 11
s_add_u32 s35, s35, s36
buffer_load_dwordx4 v[12:15], v2, s[8:11], s35 offen offset:0 sc1
buffer_load_dwordx4 v[16:19], v2, s[8:11], s35 offen offset:1024 sc1
v_mov_b32 v7, v2
v_lshrrev_b32 v3, 5, v1
v_lshlrev_b32 v3, 8, v3
v_and_b32 v4, 15, v1
v_lshlrev_b32 v4, 4, v4
v_add_u32 v8, v3, v4
v_add_u32 v8, 0x10000, v8
s_mov_b32 s46, 0x0000ffff
s_mov_b32 s47, 0x0000ffff
v_and_b32 v3, 27, v1
v_cmp_eq_u32 vcc, 16, v3
v_mov_b32 v4, 0x3f803f80
s_nop 0
v_cndmask_b32 v4, 0, v4, vcc
v_mov_b32 v28, v4
v_mov_b32 v29, v4
v_mov_b32 v30, v4
v_mov_b32 v31, v4
v_mov_b32 v32, v4
v_mov_b32 v33, v4
v_mov_b32 v34, v4
v_mov_b32 v35, v4
v_mov_b32 v36, v4
v_mov_b32 v37, v4
v_mov_b32 v38, v4
v_mov_b32 v39, v4
v_mov_b32 v40, v4
v_mov_b32 v41, v4
v_mov_b32 v42, v4
v_mov_b32 v43, v4
s_lshl_b32 s35, s34, 2
s_add_u32 s39, s35, s32
s_mul_i32 s35, s39, 294912
s_lshl_b32 s36, s33, 10
s_add_u32 s35, s35, s36
s_add_u32 s35, s35, 6406144
s_mov_b32 s77, s35
s_setprio 1
s_waitcnt vmcnt(2)
s_barrier
ds_read_b128 v[20:23], v7
ds_read_b128 v[24:27], v7 offset:1024
s_waitcnt vmcnt(1) lgkmcnt(1)
v_mfma_f32_32x32x16_bf16 v[60:75], v[20:23], v[12:15], 0
s_waitcnt lgkmcnt(0)
v_mfma_f32_32x32x16_bf16 v[76:91], v[24:27], v[12:15], 0
s_nop 9
v_max3_f32 v9, v60, v61, v62
v_max3_f32 v9, v9, v63, v64
v_max3_f32 v9, v9, v65, v66
v_max3_f32 v9, v9, v67, v68
v_max3_f32 v9, v9, v69, v70
v_max3_f32 v9, v9, v71, v72
v_max3_f32 v9, v9, v73, v74
v_max3_f32 v9, v9, v75, v76
v_max3_f32 v9, v9, v77, v78
v_max3_f32 v9, v9, v79, v80
v_max3_f32 v9, v9, v81, v82
v_max3_f32 v9, v9, v83, v84
v_max3_f32 v9, v9, v85, v86
v_max3_f32 v9, v9, v87, v88
v_max3_f32 v9, v9, v89, v90
v_max_f32 v9, v9, v91
v_mov_b32 v3, v9
s_nop 1
v_permlane32_swap_b32 v9, v3
v_max_f32 v9, v9, v3
v_add_f32 v9, 0x42800000, v9
v_sub_f32 v124, 0, v9
v_sub_f32 v125, 0, v9
v_sub_f32 v126, 0, v9
v_sub_f32 v127, 0, v9
v_sub_f32 v128, 0, v9
v_sub_f32 v129, 0, v9
v_sub_f32 v130, 0, v9
v_sub_f32 v131, 0, v9
v_sub_f32 v132, 0, v9
v_sub_f32 v133, 0, v9
v_sub_f32 v134, 0, v9
v_sub_f32 v135, 0, v9
v_sub_f32 v136, 0, v9
v_sub_f32 v137, 0, v9
v_sub_f32 v138, 0, v9
v_sub_f32 v139, 0, v9
s_waitcnt vmcnt(0)
v_mfma_f32_32x32x16_bf16 v[60:75], v[20:23], v[16:19], 0
v_mfma_f32_32x32x16_bf16 v[76:91], v[24:27], v[16:19], 0
s_nop 10
v_max3_f32 v9, v60, v61, v62
v_max3_f32 v9, v9, v63, v64
v_max3_f32 v9, v9, v65, v66
v_max3_f32 v9, v9, v67, v68
v_max3_f32 v9, v9, v69, v70
v_max3_f32 v9, v9, v71, v72
v_max3_f32 v9, v9, v73, v74
v_max3_f32 v9, v9, v75, v76
v_max3_f32 v9, v9, v77, v78
v_max3_f32 v9, v9, v79, v80
v_max3_f32 v9, v9, v81, v82
v_max3_f32 v9, v9, v83, v84
v_max3_f32 v9, v9, v85, v86
v_max3_f32 v9, v9, v87, v88
v_max3_f32 v9, v9, v89, v90
v_max_f32 v9, v9, v91
v_mov_b32 v3, v9
s_nop 1
v_permlane32_swap_b32 v9, v3
v_max_f32 v9, v9, v3
v_add_f32 v9, 0x42800000, v9
v_sub_f32 v140, 0, v9
v_sub_f32 v141, 0, v9
v_sub_f32 v142, 0, v9
v_sub_f32 v143, 0, v9
v_sub_f32 v144, 0, v9
v_sub_f32 v145, 0, v9
v_sub_f32 v146, 0, v9
v_sub_f32 v147, 0, v9
v_sub_f32 v148, 0, v9
v_sub_f32 v149, 0, v9
v_sub_f32 v150, 0, v9
v_sub_f32 v151, 0, v9
v_sub_f32 v152, 0, v9
v_sub_f32 v153, 0, v9
v_sub_f32 v154, 0, v9
v_sub_f32 v155, 0, v9
s_mov_b64 exec, s[46:47]
ds_read_b128 v[28:31], v8 offset:0
ds_read_b128 v[32:35], v8 offset:512
s_mov_b64 exec, -1
v_mfma_f32_32x32x16_bf16 v[60:75], v[20:23], v[12:15], v[124:139]
s_mov_b32 s38, 8
v_mfma_f32_32x32x16_bf16 v[76:91], v[20:23], v[16:19], v[140:155]
ds_read_b128 v[24:27], v7 offset:1024
s_nop 8
v_exp_f32 v60, v60
v_exp_f32 v61, v61
v_exp_f32 v62, v62
v_cvt_pk_bf16_f32 v44, v60, v61
v_exp_f32 v63, v63
v_exp_f32 v64, v64
v_cvt_pk_bf16_f32 v45, v62, v63
v_exp_f32 v65, v65
s_mov_b64 exec, s[46:47]
ds_read_b128 v[36:39], v8 offset:1024
ds_read_b128 v[40:43], v8 offset:1536
s_mov_b64 exec, -1
v_exp_f32 v66, v66
v_cvt_pk_bf16_f32 v46, v64, v65
v_exp_f32 v67, v67
v_exp_f32 v68, v68
v_cvt_pk_bf16_f32 v47, v66, v67
v_exp_f32 v69, v69
v_exp_f32 v70, v70
s_waitcnt lgkmcnt(4)
v_mfma_f32_32x32x16_bf16 v[92:107], v[28:31], v[44:47], 0
v_cvt_pk_bf16_f32 v48, v68, v69
v_exp_f32 v71, v71
v_exp_f32 v72, v72
v_cvt_pk_bf16_f32 v49, v70, v71
v_exp_f32 v73, v73
v_exp_f32 v74, v74
v_exp_f32 v75, v75
v_cvt_pk_bf16_f32 v50, v72, v73
v_cvt_pk_bf16_f32 v51, v74, v75
s_waitcnt lgkmcnt(0)
v_mfma_f32_32x32x16_bf16 v[60:75], v[24:27], v[12:15], v[124:139]
v_exp_f32 v76, v76
v_exp_f32 v77, v77
v_exp_f32 v78, v78
v_cvt_pk_bf16_f32 v52, v76, v77
v_exp_f32 v79, v79
v_exp_f32 v80, v80
v_cvt_pk_bf16_f32 v53, v78, v79
v_exp_f32 v81, v81
v_mfma_f32_32x32x16_bf16 v[92:107], v[32:35], v[48:51], v[92:107]
v_exp_f32 v82, v82
v_cvt_pk_bf16_f32 v54, v80, v81
v_exp_f32 v83, v83
v_exp_f32 v84, v84
v_cvt_pk_bf16_f32 v55, v82, v83
v_exp_f32 v85, v85
v_exp_f32 v86, v86
v_mfma_f32_32x32x16_bf16 v[108:123], v[28:31], v[52:55], 0
v_cvt_pk_bf16_f32 v56, v84, v85
v_exp_f32 v87, v87
v_exp_f32 v88, v88
v_cvt_pk_bf16_f32 v57, v86, v87
v_exp_f32 v89, v89
v_exp_f32 v90, v90
v_exp_f32 v91, v91
v_cvt_pk_bf16_f32 v58, v88, v89
v_cvt_pk_bf16_f32 v59, v90, v91
v_mfma_f32_32x32x16_bf16 v[76:91], v[24:27], v[16:19], v[140:155]
ds_read_b128 v[20:23], v7 offset:2048
v_exp_f32 v60, v60
v_exp_f32 v61, v61
v_exp_f32 v62, v62
v_cvt_pk_bf16_f32 v44, v60, v61
v_exp_f32 v63, v63
v_exp_f32 v64, v64
v_cvt_pk_bf16_f32 v45, v62, v63
v_exp_f32 v65, v65
v_mfma_f32_32x32x16_bf16 v[108:123], v[32:35], v[56:59], v[108:123]
s_mov_b64 exec, s[46:47]
ds_read_b128 v[28:31], v8 offset:2048
ds_read_b128 v[32:35], v8 offset:2560
s_mov_b64 exec, -1
v_exp_f32 v66, v66
v_cvt_pk_bf16_f32 v46, v64, v65
v_exp_f32 v67, v67
v_exp_f32 v68, v68
v_cvt_pk_bf16_f32 v47, v66, v67
v_exp_f32 v69, v69
v_exp_f32 v70, v70
v_mfma_f32_32x32x16_bf16 v[92:107], v[36:39], v[44:47], v[92:107]
v_cvt_pk_bf16_f32 v48, v68, v69
v_exp_f32 v71, v71
v_exp_f32 v72, v72
v_cvt_pk_bf16_f32 v49, v70, v71
v_exp_f32 v73, v73
v_exp_f32 v74, v74
v_exp_f32 v75, v75
v_cvt_pk_bf16_f32 v50, v72, v73
v_cvt_pk_bf16_f32 v51, v74, v75
s_waitcnt lgkmcnt(0)
v_mfma_f32_32x32x16_bf16 v[60:75], v[20:23], v[12:15], v[124:139]
v_exp_f32 v76, v76
v_exp_f32 v77, v77
v_exp_f32 v78, v78
v_cvt_pk_bf16_f32 v52, v76, v77
v_exp_f32 v79, v79
v_exp_f32 v80, v80
v_cvt_pk_bf16_f32 v53, v78, v79
v_exp_f32 v81, v81
v_mfma_f32_32x32x16_bf16 v[92:107], v[40:43], v[48:51], v[92:107]
v_exp_f32 v82, v82
v_cvt_pk_bf16_f32 v54, v80, v81
v_exp_f32 v83, v83
v_exp_f32 v84, v84
v_cvt_pk_bf16_f32 v55, v82, v83
v_exp_f32 v85, v85
v_exp_f32 v86, v86
v_mfma_f32_32x32x16_bf16 v[108:123], v[36:39], v[52:55], v[108:123]
v_cvt_pk_bf16_f32 v56, v84, v85
v_exp_f32 v87, v87
v_exp_f32 v88, v88
v_cvt_pk_bf16_f32 v57, v86, v87
v_exp_f32 v89, v89
v_exp_f32 v90, v90
v_exp_f32 v91, v91
v_cvt_pk_bf16_f32 v58, v88, v89
v_cvt_pk_bf16_f32 v59, v90, v91
v_mfma_f32_32x32x16_bf16 v[76:91], v[20:23], v[16:19], v[140:155]
ds_read_b128 v[24:27], v7 offset:3072
v_exp_f32 v60, v60
v_exp_f32 v61, v61
v_exp_f32 v62, v62
v_cvt_pk_bf16_f32 v44, v60, v61
v_exp_f32 v63, v63
v_exp_f32 v64, v64
v_cvt_pk_bf16_f32 v45, v62, v63
v_exp_f32 v65, v65
v_mfma_f32_32x32x16_bf16 v[108:123], v[40:43], v[56:59], v[108:123]
s_mov_b64 exec, s[46:47]
ds_read_b128 v[36:39], v8 offset:3072
ds_read_b128 v[40:43], v8 offset:3584
s_mov_b64 exec, -1
v_exp_f32 v66, v66
v_cvt_pk_bf16_f32 v46, v64, v65
v_exp_f32 v67, v67
v_exp_f32 v68, v68
v_cvt_pk_bf16_f32 v47, v66, v67
v_exp_f32 v69, v69
v_exp_f32 v70, v70
v_mfma_f32_32x32x16_bf16 v[92:107], v[28:31], v[44:47], v[92:107]
v_cvt_pk_bf16_f32 v48, v68, v69
v_exp_f32 v71, v71
v_exp_f32 v72, v72
v_cvt_pk_bf16_f32 v49, v70, v71
v_exp_f32 v73, v73
v_exp_f32 v74, v74
v_exp_f32 v75, v75
v_cvt_pk_bf16_f32 v50, v72, v73
v_cvt_pk_bf16_f32 v51, v74, v75
s_waitcnt lgkmcnt(0)
v_mfma_f32_32x32x16_bf16 v[60:75], v[24:27], v[12:15], v[124:139]
v_exp_f32 v76, v76
v_exp_f32 v77, v77
v_exp_f32 v78, v78
v_cvt_pk_bf16_f32 v52, v76, v77
v_exp_f32 v79, v79
v_exp_f32 v80, v80
v_cvt_pk_bf16_f32 v53, v78, v79
v_exp_f32 v81, v81
v_mfma_f32_32x32x16_bf16 v[92:107], v[32:35], v[48:51], v[92:107]
v_exp_f32 v82, v82
v_cvt_pk_bf16_f32 v54, v80, v81
v_exp_f32 v83, v83
v_exp_f32 v84, v84
v_cvt_pk_bf16_f32 v55, v82, v83
v_exp_f32 v85, v85
v_exp_f32 v86, v86
v_mfma_f32_32x32x16_bf16 v[108:123], v[28:31], v[52:55], v[108:123]
v_cvt_pk_bf16_f32 v56, v84, v85
v_exp_f32 v87, v87
v_exp_f32 v88, v88
v_cvt_pk_bf16_f32 v57, v86, v87
v_exp_f32 v89, v89
v_exp_f32 v90, v90
v_exp_f32 v91, v91
v_cvt_pk_bf16_f32 v58, v88, v89
v_cvt_pk_bf16_f32 v59, v90, v91
v_mfma_f32_32x32x16_bf16 v[76:91], v[24:27], v[16:19], v[140:155]
ds_read_b128 v[20:23], v7 offset:4096
v_exp_f32 v60, v60
v_exp_f32 v61, v61
v_exp_f32 v62, v62
v_cvt_pk_bf16_f32 v44, v60, v61
v_exp_f32 v63, v63
v_exp_f32 v64, v64
v_cvt_pk_bf16_f32 v45, v62, v63
v_exp_f32 v65, v65
v_mfma_f32_32x32x16_bf16 v[108:123], v[32:35], v[56:59], v[108:123]
s_mov_b64 exec, s[46:47]
ds_read_b128 v[28:31], v8 offset:4096
ds_read_b128 v[32:35], v8 offset:4608
s_mov_b64 exec, -1
v_exp_f32 v66, v66
v_cvt_pk_bf16_f32 v46, v64, v65
v_exp_f32 v67, v67
v_exp_f32 v68, v68
v_cvt_pk_bf16_f32 v47, v66, v67
v_exp_f32 v69, v69
v_exp_f32 v70, v70
v_mfma_f32_32x32x16_bf16 v[92:107], v[36:39], v[44:47], v[92:107]
v_cvt_pk_bf16_f32 v48, v68, v69
v_exp_f32 v71, v71
v_exp_f32 v72, v72
v_cvt_pk_bf16_f32 v49, v70, v71
v_exp_f32 v73, v73
v_exp_f32 v74, v74
v_exp_f32 v75, v75
v_cvt_pk_bf16_f32 v50, v72, v73
v_cvt_pk_bf16_f32 v51, v74, v75
s_waitcnt lgkmcnt(0)
v_mfma_f32_32x32x16_bf16 v[60:75], v[20:23], v[12:15], v[124:139]
v_exp_f32 v76, v76
v_exp_f32 v77, v77
v_exp_f32 v78, v78
v_cvt_pk_bf16_f32 v52, v76, v77
v_exp_f32 v79, v79
v_exp_f32 v80, v80
v_cvt_pk_bf16_f32 v53, v78, v79
v_exp_f32 v81, v81
v_mfma_f32_32x32x16_bf16 v[92:107], v[40:43], v[48:51], v[92:107]
v_exp_f32 v82, v82
v_cvt_pk_bf16_f32 v54, v80, v81
v_exp_f32 v83, v83
v_exp_f32 v84, v84
v_cvt_pk_bf16_f32 v55, v82, v83
v_exp_f32 v85, v85
v_exp_f32 v86, v86
v_mfma_f32_32x32x16_bf16 v[108:123], v[36:39], v[52:55], v[108:123]
v_cvt_pk_bf16_f32 v56, v84, v85
v_exp_f32 v87, v87
v_exp_f32 v88, v88
v_cvt_pk_bf16_f32 v57, v86, v87
v_exp_f32 v89, v89
v_exp_f32 v90, v90
v_exp_f32 v91, v91
v_cvt_pk_bf16_f32 v58, v88, v89
v_cvt_pk_bf16_f32 v59, v90, v91
v_mfma_f32_32x32x16_bf16 v[76:91], v[20:23], v[16:19], v[140:155]
ds_read_b128 v[24:27], v7 offset:5120
v_exp_f32 v60, v60
v_exp_f32 v61, v61
v_exp_f32 v62, v62
v_cvt_pk_bf16_f32 v44, v60, v61
v_exp_f32 v63, v63
v_exp_f32 v64, v64
v_cvt_pk_bf16_f32 v45, v62, v63
v_exp_f32 v65, v65
v_mfma_f32_32x32x16_bf16 v[108:123], v[40:43], v[56:59], v[108:123]
s_mov_b64 exec, s[46:47]
ds_read_b128 v[36:39], v8 offset:5120
ds_read_b128 v[40:43], v8 offset:5632
s_mov_b64 exec, -1
v_exp_f32 v66, v66
v_cvt_pk_bf16_f32 v46, v64, v65
v_exp_f32 v67, v67
v_exp_f32 v68, v68
v_cvt_pk_bf16_f32 v47, v66, v67
v_exp_f32 v69, v69
v_exp_f32 v70, v70
v_mfma_f32_32x32x16_bf16 v[92:107], v[28:31], v[44:47], v[92:107]
v_cvt_pk_bf16_f32 v48, v68, v69
v_exp_f32 v71, v71
v_exp_f32 v72, v72
v_cvt_pk_bf16_f32 v49, v70, v71
v_exp_f32 v73, v73
v_exp_f32 v74, v74
v_exp_f32 v75, v75
v_cvt_pk_bf16_f32 v50, v72, v73
v_cvt_pk_bf16_f32 v51, v74, v75
s_waitcnt lgkmcnt(0)
v_mfma_f32_32x32x16_bf16 v[60:75], v[24:27], v[12:15], v[124:139]
v_exp_f32 v76, v76
v_exp_f32 v77, v77
v_exp_f32 v78, v78
v_cvt_pk_bf16_f32 v52, v76, v77
v_exp_f32 v79, v79
v_exp_f32 v80, v80
v_cvt_pk_bf16_f32 v53, v78, v79
v_exp_f32 v81, v81
v_mfma_f32_32x32x16_bf16 v[92:107], v[32:35], v[48:51], v[92:107]
v_exp_f32 v82, v82
v_cvt_pk_bf16_f32 v54, v80, v81
v_exp_f32 v83, v83
v_exp_f32 v84, v84
v_cvt_pk_bf16_f32 v55, v82, v83
v_exp_f32 v85, v85
v_exp_f32 v86, v86
v_mfma_f32_32x32x16_bf16 v[108:123], v[28:31], v[52:55], v[108:123]
v_cvt_pk_bf16_f32 v56, v84, v85
v_exp_f32 v87, v87
v_exp_f32 v88, v88
v_cvt_pk_bf16_f32 v57, v86, v87
v_exp_f32 v89, v89
v_exp_f32 v90, v90
v_exp_f32 v91, v91
v_cvt_pk_bf16_f32 v58, v88, v89
v_cvt_pk_bf16_f32 v59, v90, v91
v_mfma_f32_32x32x16_bf16 v[76:91], v[24:27], v[16:19], v[140:155]
ds_read_b128 v[20:23], v7 offset:6144
v_exp_f32 v60, v60
v_exp_f32 v61, v61
v_exp_f32 v62, v62
v_cvt_pk_bf16_f32 v44, v60, v61
v_exp_f32 v63, v63
v_exp_f32 v64, v64
v_cvt_pk_bf16_f32 v45, v62, v63
v_exp_f32 v65, v65
v_mfma_f32_32x32x16_bf16 v[108:123], v[32:35], v[56:59], v[108:123]
s_mov_b64 exec, s[46:47]
ds_read_b128 v[28:31], v8 offset:6144
ds_read_b128 v[32:35], v8 offset:6656
s_mov_b64 exec, -1
v_exp_f32 v66, v66
v_cvt_pk_bf16_f32 v46, v64, v65
v_exp_f32 v67, v67
v_exp_f32 v68, v68
v_cvt_pk_bf16_f32 v47, v66, v67
v_exp_f32 v69, v69
v_exp_f32 v70, v70
v_mfma_f32_32x32x16_bf16 v[92:107], v[36:39], v[44:47], v[92:107]
v_cvt_pk_bf16_f32 v48, v68, v69
v_exp_f32 v71, v71
v_exp_f32 v72, v72
v_cvt_pk_bf16_f32 v49, v70, v71
v_exp_f32 v73, v73
v_exp_f32 v74, v74
v_exp_f32 v75, v75
v_cvt_pk_bf16_f32 v50, v72, v73
v_cvt_pk_bf16_f32 v51, v74, v75
s_waitcnt lgkmcnt(0)
v_mfma_f32_32x32x16_bf16 v[60:75], v[20:23], v[12:15], v[124:139]
v_exp_f32 v76, v76
v_exp_f32 v77, v77
v_exp_f32 v78, v78
v_cvt_pk_bf16_f32 v52, v76, v77
v_exp_f32 v79, v79
v_exp_f32 v80, v80
v_cvt_pk_bf16_f32 v53, v78, v79
v_exp_f32 v81, v81
v_mfma_f32_32x32x16_bf16 v[92:107], v[40:43], v[48:51], v[92:107]
v_exp_f32 v82, v82
v_cvt_pk_bf16_f32 v54, v80, v81
v_exp_f32 v83, v83
v_exp_f32 v84, v84
v_cvt_pk_bf16_f32 v55, v82, v83
v_exp_f32 v85, v85
v_exp_f32 v86, v86
v_mfma_f32_32x32x16_bf16 v[108:123], v[36:39], v[52:55], v[108:123]
v_cvt_pk_bf16_f32 v56, v84, v85
v_exp_f32 v87, v87
v_exp_f32 v88, v88
v_cvt_pk_bf16_f32 v57, v86, v87
v_exp_f32 v89, v89
v_exp_f32 v90, v90
v_exp_f32 v91, v91
v_cvt_pk_bf16_f32 v58, v88, v89
v_cvt_pk_bf16_f32 v59, v90, v91
v_mfma_f32_32x32x16_bf16 v[76:91], v[20:23], v[16:19], v[140:155]
ds_read_b128 v[24:27], v7 offset:7168
v_exp_f32 v60, v60
v_exp_f32 v61, v61
v_exp_f32 v62, v62
v_cvt_pk_bf16_f32 v44, v60, v61
v_exp_f32 v63, v63
v_exp_f32 v64, v64
v_cvt_pk_bf16_f32 v45, v62, v63
v_exp_f32 v65, v65
v_mfma_f32_32x32x16_bf16 v[108:123], v[40:43], v[56:59], v[108:123]
s_mov_b64 exec, s[46:47]
ds_read_b128 v[36:39], v8 offset:7168
ds_read_b128 v[40:43], v8 offset:7680
s_mov_b64 exec, -1
v_exp_f32 v66, v66
v_cvt_pk_bf16_f32 v46, v64, v65
v_exp_f32 v67, v67
v_exp_f32 v68, v68
v_cvt_pk_bf16_f32 v47, v66, v67
v_exp_f32 v69, v69
v_exp_f32 v70, v70
v_mfma_f32_32x32x16_bf16 v[92:107], v[28:31], v[44:47], v[92:107]
v_cvt_pk_bf16_f32 v48, v68, v69
v_exp_f32 v71, v71
v_exp_f32 v72, v72
v_cvt_pk_bf16_f32 v49, v70, v71
v_exp_f32 v73, v73
v_exp_f32 v74, v74
v_exp_f32 v75, v75
v_cvt_pk_bf16_f32 v50, v72, v73
v_cvt_pk_bf16_f32 v51, v74, v75
s_waitcnt lgkmcnt(0)
v_mfma_f32_32x32x16_bf16 v[60:75], v[24:27], v[12:15], v[124:139]
v_exp_f32 v76, v76
v_exp_f32 v77, v77
v_exp_f32 v78, v78
v_cvt_pk_bf16_f32 v52, v76, v77
v_exp_f32 v79, v79
v_exp_f32 v80, v80
v_cvt_pk_bf16_f32 v53, v78, v79
v_exp_f32 v81, v81
v_mfma_f32_32x32x16_bf16 v[92:107], v[32:35], v[48:51], v[92:107]
v_exp_f32 v82, v82
v_cvt_pk_bf16_f32 v54, v80, v81
v_exp_f32 v83, v83
v_exp_f32 v84, v84
v_cvt_pk_bf16_f32 v55, v82, v83
v_exp_f32 v85, v85
v_exp_f32 v86, v86
v_mfma_f32_32x32x16_bf16 v[108:123], v[28:31], v[52:55], v[108:123]
v_cvt_pk_bf16_f32 v56, v84, v85
v_exp_f32 v87, v87
v_exp_f32 v88, v88
v_cvt_pk_bf16_f32 v57, v86, v87
v_exp_f32 v89, v89
v_exp_f32 v90, v90
v_exp_f32 v91, v91
v_cvt_pk_bf16_f32 v58, v88, v89
v_cvt_pk_bf16_f32 v59, v90, v91
s_waitcnt vmcnt(0)
s_barrier
v_mfma_f32_32x32x16_bf16 v[76:91], v[24:27], v[16:19], v[140:155]
ds_read_b128 v[20:23], v7 offset:8192
v_exp_f32 v60, v60
v_exp_f32 v61, v61
v_exp_f32 v62, v62
v_cvt_pk_bf16_f32 v44, v60, v61
v_exp_f32 v63, v63
v_exp_f32 v64, v64
v_cvt_pk_bf16_f32 v45, v62, v63
v_exp_f32 v65, v65
v_mfma_f32_32x32x16_bf16 v[108:123], v[32:35], v[56:59], v[108:123]
s_mov_b64 exec, s[46:47]
ds_read_b128 v[28:31], v8 offset:8192
ds_read_b128 v[32:35], v8 offset:8704
s_mov_b64 exec, -1
v_exp_f32 v66, v66
v_cvt_pk_bf16_f32 v46, v64, v65
v_exp_f32 v67, v67
v_exp_f32 v68, v68
v_cvt_pk_bf16_f32 v47, v66, v67
v_exp_f32 v69, v69
v_exp_f32 v70, v70
v_mfma_f32_32x32x16_bf16 v[92:107], v[36:39], v[44:47], v[92:107]
v_cvt_pk_bf16_f32 v48, v68, v69
v_exp_f32 v71, v71
v_exp_f32 v72, v72
v_cvt_pk_bf16_f32 v49, v70, v71
v_exp_f32 v73, v73
v_exp_f32 v74, v74
v_exp_f32 v75, v75
v_cvt_pk_bf16_f32 v50, v72, v73
v_cvt_pk_bf16_f32 v51, v74, v75
s_waitcnt lgkmcnt(0)
v_mfma_f32_32x32x16_bf16 v[60:75], v[20:23], v[12:15], v[124:139]
v_add_u32 v7, 8192, v7
v_add_u32 v8, 8192, v8
s_sub_u32 s38, s38, 1
v_exp_f32 v76, v76
v_exp_f32 v77, v77
v_exp_f32 v78, v78
v_cvt_pk_bf16_f32 v52, v76, v77
v_exp_f32 v79, v79
v_exp_f32 v80, v80
v_cvt_pk_bf16_f32 v53, v78, v79
v_exp_f32 v81, v81
v_mfma_f32_32x32x16_bf16 v[92:107], v[40:43], v[48:51], v[92:107]
v_exp_f32 v82, v82
v_cvt_pk_bf16_f32 v54, v80, v81
v_exp_f32 v83, v83
v_exp_f32 v84, v84
v_cvt_pk_bf16_f32 v55, v82, v83
v_exp_f32 v85, v85
v_exp_f32 v86, v86
v_mfma_f32_32x32x16_bf16 v[108:123], v[36:39], v[52:55], v[108:123]
v_cvt_pk_bf16_f32 v56, v84, v85
v_exp_f32 v87, v87
v_exp_f32 v88, v88
v_cvt_pk_bf16_f32 v57, v86, v87
v_exp_f32 v89, v89
v_exp_f32 v90, v90
v_exp_f32 v91, v91
v_cvt_pk_bf16_f32 v58, v88, v89
v_cvt_pk_bf16_f32 v59, v90, v91
parallel_sum__mha_block__geglu_ffn__prompt_kernel_aloop:
v_mfma_f32_32x32x16_bf16 v[76:91], v[20:23], v[16:19], v[140:155]
ds_read_b128 v[24:27], v7 offset:1024
v_exp_f32 v60, v60
v_exp_f32 v61, v61
v_exp_f32 v62, v62
v_cvt_pk_bf16_f32 v44, v60, v61
v_exp_f32 v63, v63
v_exp_f32 v64, v64
v_cvt_pk_bf16_f32 v45, v62, v63
v_exp_f32 v65, v65
v_mfma_f32_32x32x16_bf16 v[108:123], v[40:43], v[56:59], v[108:123]
s_mov_b64 exec, s[46:47]
ds_read_b128 v[36:39], v8 offset:1024
ds_read_b128 v[40:43], v8 offset:1536
s_mov_b64 exec, -1
v_exp_f32 v66, v66
v_cvt_pk_bf16_f32 v46, v64, v65
v_exp_f32 v67, v67
v_exp_f32 v68, v68
v_cvt_pk_bf16_f32 v47, v66, v67
v_exp_f32 v69, v69
v_exp_f32 v70, v70
v_mfma_f32_32x32x16_bf16 v[92:107], v[28:31], v[44:47], v[92:107]
v_cvt_pk_bf16_f32 v48, v68, v69
v_exp_f32 v71, v71
v_exp_f32 v72, v72
v_cvt_pk_bf16_f32 v49, v70, v71
v_exp_f32 v73, v73
v_exp_f32 v74, v74
v_exp_f32 v75, v75
v_cvt_pk_bf16_f32 v50, v72, v73
v_cvt_pk_bf16_f32 v51, v74, v75
s_waitcnt lgkmcnt(0)
v_mfma_f32_32x32x16_bf16 v[60:75], v[24:27], v[12:15], v[124:139]
v_exp_f32 v76, v76
v_exp_f32 v77, v77
v_exp_f32 v78, v78
v_cvt_pk_bf16_f32 v52, v76, v77
v_exp_f32 v79, v79
v_exp_f32 v80, v80
v_cvt_pk_bf16_f32 v53, v78, v79
v_exp_f32 v81, v81
v_mfma_f32_32x32x16_bf16 v[92:107], v[32:35], v[48:51], v[92:107]
v_exp_f32 v82, v82
v_cvt_pk_bf16_f32 v54, v80, v81
v_exp_f32 v83, v83
v_exp_f32 v84, v84
v_cvt_pk_bf16_f32 v55, v82, v83
v_exp_f32 v85, v85
v_exp_f32 v86, v86
v_mfma_f32_32x32x16_bf16 v[108:123], v[28:31], v[52:55], v[108:123]
v_cvt_pk_bf16_f32 v56, v84, v85
v_exp_f32 v87, v87
v_exp_f32 v88, v88
v_cvt_pk_bf16_f32 v57, v86, v87
v_exp_f32 v89, v89
v_exp_f32 v90, v90
v_exp_f32 v91, v91
v_cvt_pk_bf16_f32 v58, v88, v89
v_cvt_pk_bf16_f32 v59, v90, v91
v_mfma_f32_32x32x16_bf16 v[76:91], v[24:27], v[16:19], v[140:155]
ds_read_b128 v[20:23], v7 offset:2048
v_exp_f32 v60, v60
v_exp_f32 v61, v61
v_exp_f32 v62, v62
v_cvt_pk_bf16_f32 v44, v60, v61
v_exp_f32 v63, v63
v_exp_f32 v64, v64
v_cvt_pk_bf16_f32 v45, v62, v63
v_exp_f32 v65, v65
v_mfma_f32_32x32x16_bf16 v[108:123], v[32:35], v[56:59], v[108:123]
s_mov_b64 exec, s[46:47]
ds_read_b128 v[28:31], v8 offset:2048
ds_read_b128 v[32:35], v8 offset:2560
s_mov_b64 exec, -1
v_exp_f32 v66, v66
v_cvt_pk_bf16_f32 v46, v64, v65
v_exp_f32 v67, v67
v_exp_f32 v68, v68
v_cvt_pk_bf16_f32 v47, v66, v67
v_exp_f32 v69, v69
v_exp_f32 v70, v70
v_mfma_f32_32x32x16_bf16 v[92:107], v[36:39], v[44:47], v[92:107]
v_cvt_pk_bf16_f32 v48, v68, v69
v_exp_f32 v71, v71
v_exp_f32 v72, v72
v_cvt_pk_bf16_f32 v49, v70, v71
v_exp_f32 v73, v73
v_exp_f32 v74, v74
v_exp_f32 v75, v75
v_cvt_pk_bf16_f32 v50, v72, v73
v_cvt_pk_bf16_f32 v51, v74, v75
s_waitcnt lgkmcnt(0)
v_mfma_f32_32x32x16_bf16 v[60:75], v[20:23], v[12:15], v[124:139]
v_exp_f32 v76, v76
v_exp_f32 v77, v77
v_exp_f32 v78, v78
v_cvt_pk_bf16_f32 v52, v76, v77
v_exp_f32 v79, v79
v_exp_f32 v80, v80
v_cvt_pk_bf16_f32 v53, v78, v79
v_exp_f32 v81, v81
v_mfma_f32_32x32x16_bf16 v[92:107], v[40:43], v[48:51], v[92:107]
v_exp_f32 v82, v82
v_cvt_pk_bf16_f32 v54, v80, v81
v_exp_f32 v83, v83
v_exp_f32 v84, v84
v_cvt_pk_bf16_f32 v55, v82, v83
v_exp_f32 v85, v85
v_exp_f32 v86, v86
v_mfma_f32_32x32x16_bf16 v[108:123], v[36:39], v[52:55], v[108:123]
v_cvt_pk_bf16_f32 v56, v84, v85
v_exp_f32 v87, v87
v_exp_f32 v88, v88
v_cvt_pk_bf16_f32 v57, v86, v87
v_exp_f32 v89, v89
v_exp_f32 v90, v90
v_exp_f32 v91, v91
v_cvt_pk_bf16_f32 v58, v88, v89
v_cvt_pk_bf16_f32 v59, v90, v91
v_mfma_f32_32x32x16_bf16 v[76:91], v[20:23], v[16:19], v[140:155]
ds_read_b128 v[24:27], v7 offset:3072
v_exp_f32 v60, v60
v_exp_f32 v61, v61
v_exp_f32 v62, v62
v_cvt_pk_bf16_f32 v44, v60, v61
v_exp_f32 v63, v63
v_exp_f32 v64, v64
v_cvt_pk_bf16_f32 v45, v62, v63
v_exp_f32 v65, v65
v_mfma_f32_32x32x16_bf16 v[108:123], v[40:43], v[56:59], v[108:123]
s_mov_b64 exec, s[46:47]
ds_read_b128 v[36:39], v8 offset:3072
ds_read_b128 v[40:43], v8 offset:3584
s_mov_b64 exec, -1
v_exp_f32 v66, v66
v_cvt_pk_bf16_f32 v46, v64, v65
v_exp_f32 v67, v67
v_exp_f32 v68, v68
v_cvt_pk_bf16_f32 v47, v66, v67
v_exp_f32 v69, v69
v_exp_f32 v70, v70
v_mfma_f32_32x32x16_bf16 v[92:107], v[28:31], v[44:47], v[92:107]
v_cvt_pk_bf16_f32 v48, v68, v69
v_exp_f32 v71, v71
v_exp_f32 v72, v72
v_cvt_pk_bf16_f32 v49, v70, v71
v_exp_f32 v73, v73
v_exp_f32 v74, v74
v_exp_f32 v75, v75
v_cvt_pk_bf16_f32 v50, v72, v73
v_cvt_pk_bf16_f32 v51, v74, v75
s_waitcnt lgkmcnt(0)
v_mfma_f32_32x32x16_bf16 v[60:75], v[24:27], v[12:15], v[124:139]
v_exp_f32 v76, v76
v_exp_f32 v77, v77
v_exp_f32 v78, v78
v_cvt_pk_bf16_f32 v52, v76, v77
v_exp_f32 v79, v79
v_exp_f32 v80, v80
v_cvt_pk_bf16_f32 v53, v78, v79
v_exp_f32 v81, v81
v_mfma_f32_32x32x16_bf16 v[92:107], v[32:35], v[48:51], v[92:107]
v_exp_f32 v82, v82
v_cvt_pk_bf16_f32 v54, v80, v81
v_exp_f32 v83, v83
v_exp_f32 v84, v84
v_cvt_pk_bf16_f32 v55, v82, v83
v_exp_f32 v85, v85
v_exp_f32 v86, v86
v_mfma_f32_32x32x16_bf16 v[108:123], v[28:31], v[52:55], v[108:123]
v_cvt_pk_bf16_f32 v56, v84, v85
v_exp_f32 v87, v87
v_exp_f32 v88, v88
v_cvt_pk_bf16_f32 v57, v86, v87
v_exp_f32 v89, v89
v_exp_f32 v90, v90
v_exp_f32 v91, v91
v_cvt_pk_bf16_f32 v58, v88, v89
v_cvt_pk_bf16_f32 v59, v90, v91
v_mfma_f32_32x32x16_bf16 v[76:91], v[24:27], v[16:19], v[140:155]
ds_read_b128 v[20:23], v7 offset:4096
v_exp_f32 v60, v60
v_exp_f32 v61, v61
v_exp_f32 v62, v62
v_cvt_pk_bf16_f32 v44, v60, v61
v_exp_f32 v63, v63
v_exp_f32 v64, v64
v_cvt_pk_bf16_f32 v45, v62, v63
v_exp_f32 v65, v65
v_mfma_f32_32x32x16_bf16 v[108:123], v[32:35], v[56:59], v[108:123]
s_mov_b64 exec, s[46:47]
ds_read_b128 v[28:31], v8 offset:4096
ds_read_b128 v[32:35], v8 offset:4608
s_mov_b64 exec, -1
v_exp_f32 v66, v66
v_cvt_pk_bf16_f32 v46, v64, v65
v_exp_f32 v67, v67
v_exp_f32 v68, v68
v_cvt_pk_bf16_f32 v47, v66, v67
v_exp_f32 v69, v69
v_exp_f32 v70, v70
v_mfma_f32_32x32x16_bf16 v[92:107], v[36:39], v[44:47], v[92:107]
v_cvt_pk_bf16_f32 v48, v68, v69
v_exp_f32 v71, v71
v_exp_f32 v72, v72
v_cvt_pk_bf16_f32 v49, v70, v71
v_exp_f32 v73, v73
v_exp_f32 v74, v74
v_exp_f32 v75, v75
v_cvt_pk_bf16_f32 v50, v72, v73
v_cvt_pk_bf16_f32 v51, v74, v75
s_waitcnt lgkmcnt(0)
v_mfma_f32_32x32x16_bf16 v[60:75], v[20:23], v[12:15], v[124:139]
v_exp_f32 v76, v76
v_exp_f32 v77, v77
v_exp_f32 v78, v78
v_cvt_pk_bf16_f32 v52, v76, v77
v_exp_f32 v79, v79
v_exp_f32 v80, v80
v_cvt_pk_bf16_f32 v53, v78, v79
v_exp_f32 v81, v81
v_mfma_f32_32x32x16_bf16 v[92:107], v[40:43], v[48:51], v[92:107]
v_exp_f32 v82, v82
v_cvt_pk_bf16_f32 v54, v80, v81
v_exp_f32 v83, v83
v_exp_f32 v84, v84
v_cvt_pk_bf16_f32 v55, v82, v83
v_exp_f32 v85, v85
v_exp_f32 v86, v86
v_mfma_f32_32x32x16_bf16 v[108:123], v[36:39], v[52:55], v[108:123]
v_cvt_pk_bf16_f32 v56, v84, v85
v_exp_f32 v87, v87
v_exp_f32 v88, v88
v_cvt_pk_bf16_f32 v57, v86, v87
v_exp_f32 v89, v89
v_exp_f32 v90, v90
v_exp_f32 v91, v91
v_cvt_pk_bf16_f32 v58, v88, v89
v_cvt_pk_bf16_f32 v59, v90, v91
v_mfma_f32_32x32x16_bf16 v[76:91], v[20:23], v[16:19], v[140:155]
ds_read_b128 v[24:27], v7 offset:5120
v_exp_f32 v60, v60
v_exp_f32 v61, v61
v_exp_f32 v62, v62
v_cvt_pk_bf16_f32 v44, v60, v61
v_exp_f32 v63, v63
v_exp_f32 v64, v64
v_cvt_pk_bf16_f32 v45, v62, v63
v_exp_f32 v65, v65
v_mfma_f32_32x32x16_bf16 v[108:123], v[40:43], v[56:59], v[108:123]
s_mov_b64 exec, s[46:47]
ds_read_b128 v[36:39], v8 offset:5120
ds_read_b128 v[40:43], v8 offset:5632
s_mov_b64 exec, -1
v_exp_f32 v66, v66
v_cvt_pk_bf16_f32 v46, v64, v65
v_exp_f32 v67, v67
v_exp_f32 v68, v68
v_cvt_pk_bf16_f32 v47, v66, v67
v_exp_f32 v69, v69
v_exp_f32 v70, v70
v_mfma_f32_32x32x16_bf16 v[92:107], v[28:31], v[44:47], v[92:107]
v_cvt_pk_bf16_f32 v48, v68, v69
v_exp_f32 v71, v71
v_exp_f32 v72, v72
v_cvt_pk_bf16_f32 v49, v70, v71
v_exp_f32 v73, v73
v_exp_f32 v74, v74
v_exp_f32 v75, v75
v_cvt_pk_bf16_f32 v50, v72, v73
v_cvt_pk_bf16_f32 v51, v74, v75
s_waitcnt lgkmcnt(0)
v_mfma_f32_32x32x16_bf16 v[60:75], v[24:27], v[12:15], v[124:139]
v_exp_f32 v76, v76
v_exp_f32 v77, v77
v_exp_f32 v78, v78
v_cvt_pk_bf16_f32 v52, v76, v77
v_exp_f32 v79, v79
v_exp_f32 v80, v80
v_cvt_pk_bf16_f32 v53, v78, v79
v_exp_f32 v81, v81
v_mfma_f32_32x32x16_bf16 v[92:107], v[32:35], v[48:51], v[92:107]
v_exp_f32 v82, v82
v_cvt_pk_bf16_f32 v54, v80, v81
v_exp_f32 v83, v83
v_exp_f32 v84, v84
v_cvt_pk_bf16_f32 v55, v82, v83
v_exp_f32 v85, v85
v_exp_f32 v86, v86
v_mfma_f32_32x32x16_bf16 v[108:123], v[28:31], v[52:55], v[108:123]
v_cvt_pk_bf16_f32 v56, v84, v85
v_exp_f32 v87, v87
v_exp_f32 v88, v88
v_cvt_pk_bf16_f32 v57, v86, v87
v_exp_f32 v89, v89
v_exp_f32 v90, v90
v_exp_f32 v91, v91
v_cvt_pk_bf16_f32 v58, v88, v89
v_cvt_pk_bf16_f32 v59, v90, v91
v_mfma_f32_32x32x16_bf16 v[76:91], v[24:27], v[16:19], v[140:155]
ds_read_b128 v[20:23], v7 offset:6144
v_exp_f32 v60, v60
v_exp_f32 v61, v61
v_exp_f32 v62, v62
v_cvt_pk_bf16_f32 v44, v60, v61
v_exp_f32 v63, v63
v_exp_f32 v64, v64
v_cvt_pk_bf16_f32 v45, v62, v63
v_exp_f32 v65, v65
v_mfma_f32_32x32x16_bf16 v[108:123], v[32:35], v[56:59], v[108:123]
s_mov_b64 exec, s[46:47]
ds_read_b128 v[28:31], v8 offset:6144
ds_read_b128 v[32:35], v8 offset:6656
s_mov_b64 exec, -1
v_exp_f32 v66, v66
v_cvt_pk_bf16_f32 v46, v64, v65
v_exp_f32 v67, v67
v_exp_f32 v68, v68
v_cvt_pk_bf16_f32 v47, v66, v67
v_exp_f32 v69, v69
v_exp_f32 v70, v70
v_mfma_f32_32x32x16_bf16 v[92:107], v[36:39], v[44:47], v[92:107]
v_cvt_pk_bf16_f32 v48, v68, v69
v_exp_f32 v71, v71
v_exp_f32 v72, v72
v_cvt_pk_bf16_f32 v49, v70, v71
v_exp_f32 v73, v73
v_exp_f32 v74, v74
v_exp_f32 v75, v75
v_cvt_pk_bf16_f32 v50, v72, v73
v_cvt_pk_bf16_f32 v51, v74, v75
s_waitcnt lgkmcnt(0)
v_mfma_f32_32x32x16_bf16 v[60:75], v[20:23], v[12:15], v[124:139]
v_exp_f32 v76, v76
v_exp_f32 v77, v77
v_exp_f32 v78, v78
v_cvt_pk_bf16_f32 v52, v76, v77
v_exp_f32 v79, v79
v_exp_f32 v80, v80
v_cvt_pk_bf16_f32 v53, v78, v79
v_exp_f32 v81, v81
v_mfma_f32_32x32x16_bf16 v[92:107], v[40:43], v[48:51], v[92:107]
v_exp_f32 v82, v82
v_cvt_pk_bf16_f32 v54, v80, v81
v_exp_f32 v83, v83
v_exp_f32 v84, v84
v_cvt_pk_bf16_f32 v55, v82, v83
v_exp_f32 v85, v85
v_exp_f32 v86, v86
v_mfma_f32_32x32x16_bf16 v[108:123], v[36:39], v[52:55], v[108:123]
v_cvt_pk_bf16_f32 v56, v84, v85
v_exp_f32 v87, v87
v_exp_f32 v88, v88
v_cvt_pk_bf16_f32 v57, v86, v87
v_exp_f32 v89, v89
v_exp_f32 v90, v90
v_exp_f32 v91, v91
v_cvt_pk_bf16_f32 v58, v88, v89
v_cvt_pk_bf16_f32 v59, v90, v91
v_mfma_f32_32x32x16_bf16 v[76:91], v[20:23], v[16:19], v[140:155]
ds_read_b128 v[24:27], v7 offset:7168
v_exp_f32 v60, v60
v_exp_f32 v61, v61
v_exp_f32 v62, v62
v_cvt_pk_bf16_f32 v44, v60, v61
v_exp_f32 v63, v63
v_exp_f32 v64, v64
v_cvt_pk_bf16_f32 v45, v62, v63
v_exp_f32 v65, v65
v_mfma_f32_32x32x16_bf16 v[108:123], v[40:43], v[56:59], v[108:123]
s_mov_b64 exec, s[46:47]
ds_read_b128 v[36:39], v8 offset:7168
ds_read_b128 v[40:43], v8 offset:7680
s_mov_b64 exec, -1
v_exp_f32 v66, v66
v_cvt_pk_bf16_f32 v46, v64, v65
v_exp_f32 v67, v67
v_exp_f32 v68, v68
v_cvt_pk_bf16_f32 v47, v66, v67
v_exp_f32 v69, v69
v_exp_f32 v70, v70
v_mfma_f32_32x32x16_bf16 v[92:107], v[28:31], v[44:47], v[92:107]
v_cvt_pk_bf16_f32 v48, v68, v69
v_exp_f32 v71, v71
v_exp_f32 v72, v72
v_cvt_pk_bf16_f32 v49, v70, v71
v_exp_f32 v73, v73
v_exp_f32 v74, v74
v_exp_f32 v75, v75
v_cvt_pk_bf16_f32 v50, v72, v73
v_cvt_pk_bf16_f32 v51, v74, v75
s_waitcnt lgkmcnt(0)
v_mfma_f32_32x32x16_bf16 v[60:75], v[24:27], v[12:15], v[124:139]
v_exp_f32 v76, v76
v_exp_f32 v77, v77
v_exp_f32 v78, v78
v_cvt_pk_bf16_f32 v52, v76, v77
v_exp_f32 v79, v79
v_exp_f32 v80, v80
v_cvt_pk_bf16_f32 v53, v78, v79
v_exp_f32 v81, v81
v_mfma_f32_32x32x16_bf16 v[92:107], v[32:35], v[48:51], v[92:107]
v_exp_f32 v82, v82
v_cvt_pk_bf16_f32 v54, v80, v81
v_exp_f32 v83, v83
v_exp_f32 v84, v84
v_cvt_pk_bf16_f32 v55, v82, v83
v_exp_f32 v85, v85
v_exp_f32 v86, v86
v_mfma_f32_32x32x16_bf16 v[108:123], v[28:31], v[52:55], v[108:123]
v_cvt_pk_bf16_f32 v56, v84, v85
v_exp_f32 v87, v87
v_exp_f32 v88, v88
v_cvt_pk_bf16_f32 v57, v86, v87
v_exp_f32 v89, v89
v_exp_f32 v90, v90
v_exp_f32 v91, v91
v_cvt_pk_bf16_f32 v58, v88, v89
v_cvt_pk_bf16_f32 v59, v90, v91
v_mfma_f32_32x32x16_bf16 v[76:91], v[24:27], v[16:19], v[140:155]
ds_read_b128 v[20:23], v7 offset:8192
v_exp_f32 v60, v60
v_exp_f32 v61, v61
v_exp_f32 v62, v62
v_cvt_pk_bf16_f32 v44, v60, v61
v_exp_f32 v63, v63
v_exp_f32 v64, v64
v_cvt_pk_bf16_f32 v45, v62, v63
v_exp_f32 v65, v65
v_mfma_f32_32x32x16_bf16 v[108:123], v[32:35], v[56:59], v[108:123]
s_mov_b64 exec, s[46:47]
ds_read_b128 v[28:31], v8 offset:8192
ds_read_b128 v[32:35], v8 offset:8704
s_mov_b64 exec, -1
v_exp_f32 v66, v66
v_cvt_pk_bf16_f32 v46, v64, v65
v_exp_f32 v67, v67
v_exp_f32 v68, v68
v_cvt_pk_bf16_f32 v47, v66, v67
v_exp_f32 v69, v69
v_exp_f32 v70, v70
v_mfma_f32_32x32x16_bf16 v[92:107], v[36:39], v[44:47], v[92:107]
v_cvt_pk_bf16_f32 v48, v68, v69
v_exp_f32 v71, v71
v_exp_f32 v72, v72
v_cvt_pk_bf16_f32 v49, v70, v71
v_exp_f32 v73, v73
v_exp_f32 v74, v74
v_exp_f32 v75, v75
v_cvt_pk_bf16_f32 v50, v72, v73
v_cvt_pk_bf16_f32 v51, v74, v75
s_waitcnt lgkmcnt(0)
v_mfma_f32_32x32x16_bf16 v[60:75], v[20:23], v[12:15], v[124:139]
v_add_u32 v7, 8192, v7
v_add_u32 v8, 8192, v8
s_sub_u32 s38, s38, 1
v_exp_f32 v76, v76
v_exp_f32 v77, v77
v_exp_f32 v78, v78
v_cvt_pk_bf16_f32 v52, v76, v77
v_exp_f32 v79, v79
v_exp_f32 v80, v80
v_cvt_pk_bf16_f32 v53, v78, v79
v_exp_f32 v81, v81
v_mfma_f32_32x32x16_bf16 v[92:107], v[40:43], v[48:51], v[92:107]
v_exp_f32 v82, v82
v_cvt_pk_bf16_f32 v54, v80, v81
v_exp_f32 v83, v83
v_exp_f32 v84, v84
v_cvt_pk_bf16_f32 v55, v82, v83
v_exp_f32 v85, v85
v_exp_f32 v86, v86
v_mfma_f32_32x32x16_bf16 v[108:123], v[36:39], v[52:55], v[108:123]
v_cvt_pk_bf16_f32 v56, v84, v85
v_exp_f32 v87, v87
v_exp_f32 v88, v88
v_cvt_pk_bf16_f32 v57, v86, v87
v_exp_f32 v89, v89
v_exp_f32 v90, v90
v_exp_f32 v91, v91
v_cvt_pk_bf16_f32 v58, v88, v89
v_cvt_pk_bf16_f32 v59, v90, v91
s_cmp_lg_u32 s38, 0
s_cbranch_scc1 parallel_sum__mha_block__geglu_ffn__prompt_kernel_aloop
v_mfma_f32_32x32x16_bf16 v[108:123], v[40:43], v[56:59], v[108:123]
s_waitcnt lgkmcnt(0)
s_barrier
s_nop 7
s_nop 3
v_mov_b32 v4, 0x7f800000
v_mov_b32 v5, 0x76800000
s_mov_b64 s[4:5], -1
v_add_f32 v3, |v92|, |v93|
v_add_f32 v3, v3, |v94|
v_add_f32 v3, v3, |v95|
v_add_f32 v3, v3, |v96|
v_add_f32 v3, v3, |v97|
v_add_f32 v3, v3, |v98|
v_add_f32 v3, v3, |v99|
v_cmp_lt_f32 vcc, v3, v4
s_nop 3
s_and_b64 s[4:5], s[4:5], vcc
v_cmp_lt_f32 vcc, v100, v5
s_nop 3
s_and_b64 s[4:5], s[4:5], vcc
v_add_f32 v3, |v108|, |v109|
v_add_f32 v3, v3, |v110|
v_add_f32 v3, v3, |v111|
v_add_f32 v3, v3, |v112|
v_add_f32 v3, v3, |v113|
v_add_f32 v3, v3, |v114|
v_add_f32 v3, v3, |v115|
v_cmp_lt_f32 vcc, v3, v4
s_nop 3
s_and_b64 s[4:5], s[4:5], vcc
v_cmp_lt_f32 vcc, v116, v5
s_nop 3
s_and_b64 s[4:5], s[4:5], vcc
s_cmp_eq_u64 s[4:5], -1
s_cbranch_scc1 parallel_sum__mha_block__geglu_ffn__prompt_kernel_afin
v_mov_b32 v7, v2
v_lshrrev_b32 v3, 5, v1
v_lshlrev_b32 v3, 8, v3
v_and_b32 v4, 15, v1
v_lshlrev_b32 v4, 4, v4
v_add_u32 v8, v3, v4
v_add_u32 v8, 0x10000, v8
v_mov_b32 v9, 0xff800000
v_mov_b32 v92, 0
v_mov_b32 v93, 0
v_mov_b32 v94, 0
v_mov_b32 v95, 0
v_mov_b32 v96, 0
v_mov_b32 v97, 0
v_mov_b32 v98, 0
v_mov_b32 v99, 0
v_mov_b32 v100, 0
v_mov_b32 v101, 0
v_mov_b32 v102, 0
v_mov_b32 v103, 0
v_mov_b32 v104, 0
v_mov_b32 v105, 0
v_mov_b32 v106, 0
v_mov_b32 v107, 0
s_mov_b32 s38, 64
parallel_sum__mha_block__geglu_ffn__prompt_kernel_slow0:
ds_read_b128 v[20:23], v7 offset:0
s_mov_b64 exec, s[46:47]
ds_read_b128 v[28:31], v8 offset:0
ds_read_b128 v[32:35], v8 offset:512
s_mov_b64 exec, -1
s_waitcnt lgkmcnt(0)
v_mfma_f32_32x32x16_bf16 v[60:75], v[20:23], v[12:15], 0
s_nop 11
v_max3_f32 v3, v60, v61, v62
v_max3_f32 v3, v3, v63, v64
v_max3_f32 v3, v3, v65, v66
v_max3_f32 v3, v3, v67, v68
v_max3_f32 v3, v3, v69, v70
v_max3_f32 v3, v3, v71, v72
v_max3_f32 v3, v3, v73, v74
v_max3_f32 v3, v3, v75, v9
v_mov_b32 v4, v3
s_nop 1
v_permlane32_swap_b32 v3, v4
v_max_f32 v3, v3, v4
v_sub_f32 v4, v9, v3
v_exp_f32 v4, v4
v_mov_b32 v9, v3
v_mul_f32 v92, v92, v4
v_mul_f32 v93, v93, v4
v_mul_f32 v94, v94, v4
v_mul_f32 v95, v95, v4
v_mul_f32 v96, v96, v4
v_mul_f32 v97, v97, v4
v_mul_f32 v98, v98, v4
v_mul_f32 v99, v99, v4
v_mul_f32 v100, v100, v4
v_mul_f32 v101, v101, v4
v_mul_f32 v102, v102, v4
v_mul_f32 v103, v103, v4
v_mul_f32 v104, v104, v4
v_mul_f32 v105, v105, v4
v_mul_f32 v106, v106, v4
v_mul_f32 v107, v107, v4
v_sub_f32 v60, v60, v9
v_sub_f32 v61, v61, v9
v_sub_f32 v62, v62, v9
v_sub_f32 v63, v63, v9
v_sub_f32 v64, v64, v9
v_sub_f32 v65, v65, v9
v_sub_f32 v66, v66, v9
v_sub_f32 v67, v67, v9
v_sub_f32 v68, v68, v9
v_sub_f32 v69, v69, v9
v_sub_f32 v70, v70, v9
v_sub_f32 v71, v71, v9
v_sub_f32 v72, v72, v9
v_sub_f32 v73, v73, v9
v_sub_f32 v74, v74, v9
v_sub_f32 v75, v75, v9
v_exp_f32 v60, v60
v_exp_f32 v61, v61
v_exp_f32 v62, v62
v_exp_f32 v63, v63
v_exp_f32 v64, v64
v_exp_f32 v65, v65
v_exp_f32 v66, v66
v_exp_f32 v67, v67
v_exp_f32 v68, v68
v_exp_f32 v69, v69
v_exp_f32 v70, v70
v_exp_f32 v71, v71
v_exp_f32 v72, v72
v_exp_f32 v73, v73
v_exp_f32 v74, v74
v_exp_f32 v75, v75
v_cvt_pk_bf16_f32 v44, v60, v61
v_cvt_pk_bf16_f32 v45, v62, v63
v_cvt_pk_bf16_f32 v46, v64, v65
v_cvt_pk_bf16_f32 v47, v66, v67
v_cvt_pk_bf16_f32 v48, v68, v69
v_cvt_pk_bf16_f32 v49, v70, v71
v_cvt_pk_bf16_f32 v50, v72, v73
v_cvt_pk_bf16_f32 v51, v74, v75
v_mfma_f32_32x32x16_bf16 v[92:107], v[28:31], v[44:47], v[92:107]
s_nop 0
v_mfma_f32_32x32x16_bf16 v[92:107], v[32:35], v[48:51], v[92:107]
v_add_u32 v7, 1024, v7
v_add_u32 v8, 1024, v8
s_sub_u32 s38, s38, 1
s_cmp_lg_u32 s38, 0
s_nop 7
s_nop 7
s_cbranch_scc1 parallel_sum__mha_block__geglu_ffn__prompt_kernel_slow0
v_mov_b32 v7, v2
v_lshrrev_b32 v3, 5, v1
v_lshlrev_b32 v3, 8, v3
v_and_b32 v4, 15, v1
v_lshlrev_b32 v4, 4, v4
v_add_u32 v8, v3, v4
v_add_u32 v8, 0x10000, v8
v_mov_b32 v9, 0xff800000
v_mov_b32 v108, 0
v_mov_b32 v109, 0
v_mov_b32 v110, 0
v_mov_b32 v111, 0
v_mov_b32 v112, 0
v_mov_b32 v113, 0
v_mov_b32 v114, 0
v_mov_b32 v115, 0
v_mov_b32 v116, 0
v_mov_b32 v117, 0
v_mov_b32 v118, 0
v_mov_b32 v119, 0
v_mov_b32 v120, 0
v_mov_b32 v121, 0
v_mov_b32 v122, 0
v_mov_b32 v123, 0
s_mov_b32 s38, 64
parallel_sum__mha_block__geglu_ffn__prompt_kernel_slow1:
ds_read_b128 v[20:23], v7 offset:0
s_mov_b64 exec, s[46:47]
ds_read_b128 v[28:31], v8 offset:0
ds_read_b128 v[32:35], v8 offset:512
s_mov_b64 exec, -1
s_waitcnt lgkmcnt(0)
v_mfma_f32_32x32x16_bf16 v[60:75], v[20:23], v[16:19], 0
s_nop 11
v_max3_f32 v3, v60, v61, v62
v_max3_f32 v3, v3, v63, v64
v_max3_f32 v3, v3, v65, v66
v_max3_f32 v3, v3, v67, v68
v_max3_f32 v3, v3, v69, v70
v_max3_f32 v3, v3, v71, v72
v_max3_f32 v3, v3, v73, v74
v_max3_f32 v3, v3, v75, v9
v_mov_b32 v4, v3
s_nop 1
v_permlane32_swap_b32 v3, v4
v_max_f32 v3, v3, v4
v_sub_f32 v4, v9, v3
v_exp_f32 v4, v4
v_mov_b32 v9, v3
v_mul_f32 v108, v108, v4
v_mul_f32 v109, v109, v4
v_mul_f32 v110, v110, v4
v_mul_f32 v111, v111, v4
v_mul_f32 v112, v112, v4
v_mul_f32 v113, v113, v4
v_mul_f32 v114, v114, v4
v_mul_f32 v115, v115, v4
v_mul_f32 v116, v116, v4
v_mul_f32 v117, v117, v4
v_mul_f32 v118, v118, v4
v_mul_f32 v119, v119, v4
v_mul_f32 v120, v120, v4
v_mul_f32 v121, v121, v4
v_mul_f32 v122, v122, v4
v_mul_f32 v123, v123, v4
v_sub_f32 v60, v60, v9
v_sub_f32 v61, v61, v9
v_sub_f32 v62, v62, v9
v_sub_f32 v63, v63, v9
v_sub_f32 v64, v64, v9
v_sub_f32 v65, v65, v9
v_sub_f32 v66, v66, v9
v_sub_f32 v67, v67, v9
v_sub_f32 v68, v68, v9
v_sub_f32 v69, v69, v9
v_sub_f32 v70, v70, v9
v_sub_f32 v71, v71, v9
v_sub_f32 v72, v72, v9
v_sub_f32 v73, v73, v9
v_sub_f32 v74, v74, v9
v_sub_f32 v75, v75, v9
v_exp_f32 v60, v60
v_exp_f32 v61, v61
v_exp_f32 v62, v62
v_exp_f32 v63, v63
v_exp_f32 v64, v64
v_exp_f32 v65, v65
v_exp_f32 v66, v66
v_exp_f32 v67, v67
v_exp_f32 v68, v68
v_exp_f32 v69, v69
v_exp_f32 v70, v70
v_exp_f32 v71, v71
v_exp_f32 v72, v72
v_exp_f32 v73, v73
v_exp_f32 v74, v74
v_exp_f32 v75, v75
v_cvt_pk_bf16_f32 v52, v60, v61
v_cvt_pk_bf16_f32 v53, v62, v63
v_cvt_pk_bf16_f32 v54, v64, v65
v_cvt_pk_bf16_f32 v55, v66, v67
v_cvt_pk_bf16_f32 v56, v68, v69
v_cvt_pk_bf16_f32 v57, v70, v71
v_cvt_pk_bf16_f32 v58, v72, v73
v_cvt_pk_bf16_f32 v59, v74, v75
v_mfma_f32_32x32x16_bf16 v[108:123], v[28:31], v[52:55], v[108:123]
s_nop 0
v_mfma_f32_32x32x16_bf16 v[108:123], v[32:35], v[56:59], v[108:123]
v_add_u32 v7, 1024, v7
v_add_u32 v8, 1024, v8
s_sub_u32 s38, s38, 1
s_cmp_lg_u32 s38, 0
s_nop 7
s_nop 7
s_cbranch_scc1 parallel_sum__mha_block__geglu_ffn__prompt_kernel_slow1
parallel_sum__mha_block__geglu_ffn__prompt_kernel_afin:
s_nop 7
s_nop 3
s_mov_b32 s35, s77
v_mov_b32 v3, v2
v_rcp_f32 v5, v100
s_nop 0
v_mul_f32 v92, v92, v5
v_mul_f32 v93, v93, v5
v_mul_f32 v94, v94, v5
v_mul_f32 v95, v95, v5
v_mul_f32 v96, v96, v5
v_mul_f32 v97, v97, v5
v_mul_f32 v98, v98, v5
v_mul_f32 v99, v99, v5
v_cvt_pk_bf16_f32 v44, v92, v93
v_cvt_pk_bf16_f32 v45, v94, v95
v_cvt_pk_bf16_f32 v46, v96, v97
v_cvt_pk_bf16_f32 v47, v98, v99
buffer_store_dwordx4 v[44:47], v3, s[8:11], s35 offen sc1
s_add_u32 s35, s35, 147456
v_rcp_f32 v5, v116
s_nop 0
v_mul_f32 v108, v108, v5
v_mul_f32 v109, v109, v5
v_mul_f32 v110, v110, v5
v_mul_f32 v111, v111, v5
v_mul_f32 v112, v112, v5
v_mul_f32 v113, v113, v5
v_mul_f32 v114, v114, v5
v_mul_f32 v115, v115, v5
v_cvt_pk_bf16_f32 v52, v108, v109
v_cvt_pk_bf16_f32 v53, v110, v111
v_cvt_pk_bf16_f32 v54, v112, v113
v_cvt_pk_bf16_f32 v55, v114, v115
buffer_store_dwordx4 v[52:55], v3, s[8:11], s35 offen sc1
s_lshl_b32 s35, s39, 12
s_lshl_b32 s36, s33, 7
s_add_u32 s35, s35, s36
s_add_u32 s35, s35, 21135360
v_mov_b32 v3, 0
v_mov_b32 v4, 1
s_waitcnt vmcnt(0)
s_mov_b64 exec, 1
buffer_atomic_add v4, v3, s[8:11], s35 offen sc1
s_mov_b64 exec, -1
s_endpgm
parallel_sum__mha_block__geglu_ffn__prompt_kernel_G:
s_sub_u32 s50, s32, 4
v_and_b32 v7, 15, v0
v_bfe_u32 v8, v0, 4, 2
s_and_b32 s35, s2, 7
s_lshl_b32 s35, s35, 2
s_lshr_b32 s36, s2, 3
s_and_b32 s36, s36, 3
s_add_u32 s39, s35, s36
s_lshr_b32 s40, s2, 5
v_lshrrev_b32 v3, 3, v1
v_lshlrev_b32 v3, 10, v3
v_and_b32 v4, 7, v1
v_and_b32 v5, 1, v8
v_lshlrev_b32 v5, 2, v5
v_xor_b32 v4, v4, v5
v_lshl_add_u32 v9, v4, 4, v3
s_lshl_b32 s41, s50, 13
s_add_u32 s41, s41, 131072
s_mul_i32 s42, s50, 458752
s_lshl_b32 s35, s40, 7
s_add_u32 s42, s42, s35
s_mul_i32 s43, s39, 294912
s_mul_i32 s35, s50, 28672
s_add_u32 s43, s43, s35
s_add_u32 s43, s43, 6291456
s_mul_i32 s44, s50, 131072
s_lshl_b32 s35, s40, 7
s_add_u32 s44, s44, s35
s_mul_i32 s45, s39, 294912
s_mul_i32 s35, s50, 8192
s_add_u32 s45, s45, s35
s_add_u32 s45, s45, 6406144
v_lshrrev_b32 v5, 2, v7
v_and_b32 v6, 3, v7
v_and_b32 v3, 1, v8
v_lshlrev_b32 v3, 1, v3
v_lshrrev_b32 v4, 1, v6
v_add_u32 v3, v3, v4
v_lshrrev_b32 v4, 1, v5
v_lshlrev_b32 v4, 2, v4
v_xor_b32 v3, v3, v4
v_lshlrev_b32 v3, 4, v3
v_and_b32 v4, 1, v6
v_lshl_add_u32 v3, v4, 3, v3
v_lshrrev_b32 v6, 1, v8
v_lshl_add_u32 v4, v6, 3, v5
v_lshl_add_u32 v11, v4, 7, v3
v_lshl_add_u32 v4, v6, 2, v5
v_lshl_add_u32 v15, v4, 7, v3
s_and_b32 s35, s50, 1
s_lshl_b32 s35, s35, 6
v_xor_b32 v11, s35, v11
v_xor_b32 v15, s35, v15
v_xor_b32 v12, 64, v11
v_xor_b32 v16, 64, v15
v_add_u32 v11, s41, v11
v_add_u32 v15, s41, v15
v_add_u32 v12, s41, v12
v_add_u32 v16, s41, v16
s_lshr_b32 s35, s50, 1
s_xor_b32 s35, s35, 0
s_mul_i32 s51, s35, 147456
s_lshr_b32 s35, s50, 1
s_xor_b32 s35, s35, 1
s_mul_i32 s58, s35, 147456
s_waitcnt vmcnt(0)
s_barrier
s_cmp_eq_u32 s101, 1
s_cbranch_scc1 parallel_sum__mha_block__geglu_ffn__prompt_kernel_nohp
v_add_u32 v3, s41, v2
ds_read_b128 v[140:143], v3 offset:0
ds_read_b128 v[144:147], v3 offset:1024
ds_read_b128 v[148:151], v3 offset:2048
ds_read_b128 v[152:155], v3 offset:3072
s_waitcnt lgkmcnt(0)
parallel_sum__mha_block__geglu_ffn__prompt_kernel_nohp:
s_sub_u32 s35, s32, 4
s_lshl_b32 s37, s35, 11
s_lshl_b32 s48, s33, 16
s_add_u32 s48, s48, s37
s_add_u32 m0, s37, 8192
s_add_u32 s36, s48, 2105344
buffer_load_dwordx4 v2, s[8:11], s36 offen sc1 lds
s_add_u32 m0, s37, 73728
s_add_u32 s36, s48, 4202496
buffer_load_dwordx4 v2, s[8:11], s36 offen sc1 lds
s_add_u32 m0, s37, 9216
s_add_u32 s36, s48, 2106368
buffer_load_dwordx4 v2, s[8:11], s36 offen sc1 lds
s_add_u32 m0, s37, 74752
s_add_u32 s36, s48, 4203520
buffer_load_dwordx4 v2, s[8:11], s36 offen sc1 lds
s_add_u32 m0, s37, 16384
s_add_u32 s36, s48, 2113536
buffer_load_dwordx4 v2, s[8:11], s36 offen sc1 lds
s_add_u32 m0, s37, 81920
s_add_u32 s36, s48, 4210688
buffer_load_dwordx4 v2, s[8:11], s36 offen sc1 lds
s_add_u32 m0, s37, 17408
s_add_u32 s36, s48, 2114560
buffer_load_dwordx4 v2, s[8:11], s36 offen sc1 lds
s_add_u32 m0, s37, 82944
s_add_u32 s36, s48, 4211712
buffer_load_dwordx4 v2, s[8:11], s36 offen sc1 lds
s_add_u32 m0, s37, 24576
s_add_u32 s36, s48, 2121728
buffer_load_dwordx4 v2, s[8:11], s36 offen sc1 lds
s_add_u32 m0, s37, 90112
s_add_u32 s36, s48, 4218880
buffer_load_dwordx4 v2, s[8:11], s36 offen sc1 lds
s_add_u32 m0, s37, 25600
s_add_u32 s36, s48, 2122752
buffer_load_dwordx4 v2, s[8:11], s36 offen sc1 lds
s_add_u32 m0, s37, 91136
s_add_u32 s36, s48, 4219904
buffer_load_dwordx4 v2, s[8:11], s36 offen sc1 lds
s_add_u32 m0, s37, 32768
s_add_u32 s36, s48, 2129920
buffer_load_dwordx4 v2, s[8:11], s36 offen sc1 lds
s_add_u32 m0, s37, 98304
s_add_u32 s36, s48, 4227072
buffer_load_dwordx4 v2, s[8:11], s36 offen sc1 lds
s_add_u32 m0, s37, 33792
s_add_u32 s36, s48, 2130944
buffer_load_dwordx4 v2, s[8:11], s36 offen sc1 lds
s_add_u32 m0, s37, 99328
s_add_u32 s36, s48, 4228096
buffer_load_dwordx4 v2, s[8:11], s36 offen sc1 lds
s_add_u32 m0, s37, 40960
s_add_u32 s36, s48, 2138112
buffer_load_dwordx4 v2, s[8:11], s36 offen sc1 lds
s_add_u32 m0, s37, 106496
s_add_u32 s36, s48, 4235264
buffer_load_dwordx4 v2, s[8:11], s36 offen sc1 lds
s_add_u32 m0, s37, 41984
s_add_u32 s36, s48, 2139136
buffer_load_dwordx4 v2, s[8:11], s36 offen sc1 lds
s_add_u32 m0, s37, 107520
s_add_u32 s36, s48, 4236288
buffer_load_dwordx4 v2, s[8:11], s36 offen sc1 lds
s_add_u32 m0, s37, 49152
s_add_u32 s36, s48, 2146304
buffer_load_dwordx4 v2, s[8:11], s36 offen sc1 lds
s_add_u32 m0, s37, 114688
s_add_u32 s36, s48, 4243456
buffer_load_dwordx4 v2, s[8:11], s36 offen sc1 lds
s_add_u32 m0, s37, 50176
s_add_u32 s36, s48, 2147328
buffer_load_dwordx4 v2, s[8:11], s36 offen sc1 lds
s_add_u32 m0, s37, 115712
s_add_u32 s36, s48, 4244480
buffer_load_dwordx4 v2, s[8:11], s36 offen sc1 lds
s_add_u32 m0, s37, 57344
s_add_u32 s36, s48, 2154496
buffer_load_dwordx4 v2, s[8:11], s36 offen sc1 lds
s_add_u32 m0, s37, 122880
s_add_u32 s36, s48, 4251648
buffer_load_dwordx4 v2, s[8:11], s36 offen sc1 lds
s_add_u32 m0, s37, 58368
s_add_u32 s36, s48, 2155520
buffer_load_dwordx4 v2, s[8:11], s36 offen sc1 lds
s_add_u32 m0, s37, 123904
s_add_u32 s36, s48, 4252672
buffer_load_dwordx4 v2, s[8:11], s36 offen sc1 lds
s_add_u32 m0, s41, 0
s_add_u32 s35, s42, 0
buffer_load_dwordx4 v9, s[12:15], s35 offen lds
s_add_u32 m0, s41, 1024
s_add_u32 s35, s42, 8192
buffer_load_dwordx4 v9, s[12:15], s35 offen lds
s_add_u32 m0, s41, 2048
s_add_u32 s35, s42, 16384
buffer_load_dwordx4 v9, s[12:15], s35 offen lds
s_add_u32 m0, s41, 3072
s_add_u32 s35, s42, 24576
buffer_load_dwordx4 v9, s[12:15], s35 offen lds
s_add_u32 m0, s41, 4096
s_add_u32 s35, s42, 32768
buffer_load_dwordx4 v9, s[12:15], s35 offen lds
s_add_u32 m0, s41, 5120
s_add_u32 s35, s42, 40960
buffer_load_dwordx4 v9, s[12:15], s35 offen lds
s_add_u32 m0, s41, 6144
s_add_u32 s35, s42, 49152
buffer_load_dwordx4 v9, s[12:15], s35 offen lds
s_add_u32 m0, s41, 7168
s_add_u32 s35, s42, 57344
buffer_load_dwordx4 v9, s[12:15], s35 offen lds
s_waitcnt vmcnt(8)
s_barrier
s_cmp_eq_u32 s101, 1
s_cbranch_scc1 parallel_sum__mha_block__geglu_ffn__prompt_kernel_nofh
s_add_u32 s35, s100, 0
buffer_store_dwordx4 v[240:243], v2, s[8:11], s35 offen offset:0 sc1
s_add_u32 s35, s100, 0
buffer_store_dwordx4 v[244:247], v2, s[8:11], s35 offen offset:1024 sc1
s_add_u32 s35, s100, 147456
buffer_store_dwordx4 v[248:251], v2, s[8:11], s35 offen offset:0 sc1
s_add_u32 s35, s100, 147456
buffer_store_dwordx4 v[252:255], v2, s[8:11], s35 offen offset:1024 sc1
s_add_u32 s35, s100, 4294963200
buffer_store_dwordx4 v[140:143], v2, s[8:11], s35 offen offset:0 sc1
s_add_u32 s35, s100, 4294963200
buffer_store_dwordx4 v[144:147], v2, s[8:11], s35 offen offset:1024 sc1
s_add_u32 s35, s100, 143360
buffer_store_dwordx4 v[148:151], v2, s[8:11], s35 offen offset:0 sc1
s_add_u32 s35, s100, 143360
buffer_store_dwordx4 v[152:155], v2, s[8:11], s35 offen offset:1024 sc1
s_lshl_b32 s35, s50, 7
s_add_u32 s35, s35, s95
v_mov_b32 v3, 0
v_mov_b32 v4, 1
s_waitcnt vmcnt(0)
s_mov_b64 exec, 1
buffer_atomic_add v4, v3, s[8:11], s35 offen sc1
s_mov_b64 exec, -1
parallel_sum__mha_block__geglu_ffn__prompt_kernel_nofh:
v_lshlrev_b32 v3, 7, v1
s_lshr_b32 s35, s39, 1
s_lshl_b32 s35, s35, 13
s_add_u32 s35, s35, 21004288
s_mov_b32 s49, 100000
s_mov_b32 s4, 0xffffffff
s_mov_b32 s5, 0xffffff
s_mov_b64 exec, s[4:5]
poll4:
buffer_load_dword v4, v3, s[8:11], s35 offen sc1
s_waitcnt vmcnt(0)
v_cmp_ne_u32 vcc, 1, v4
s_nop 3
s_cmp_eq_u64 vcc, 0
s_cbranch_scc1 poll4_ok
s_sleep 2
s_sub_u32 s49, s49, 1
s_cmp_lg_u32 s49, 0
s_cbranch_scc1 poll4
poll4_ok:
s_mov_b64 exec, -1
s_add_u32 s35, s43, s51
buffer_load_dwordx4 v[92:95], v2, s[8:11], s35 offen offset:0 sc1
buffer_load_dwordx4 v[100:103], v2, s[8:11], s35 offen offset:1024 sc1
s_add_u32 s35, s43, s58
buffer_load_dwordx4 v[96:99], v2, s[8:11], s35 offen offset:0 sc1
buffer_load_dwordx4 v[104:107], v2, s[8:11], s35 offen offset:1024 sc1
s_add_u32 s35, s43, s51
buffer_load_dwordx4 v[108:111], v2, s[8:11], s35 offen offset:2048 sc1
buffer_load_dwordx4 v[116:119], v2, s[8:11], s35 offen offset:3072 sc1
s_add_u32 s35, s43, s58
buffer_load_dwordx4 v[112:115], v2, s[8:11], s35 offen offset:2048 sc1
buffer_load_dwordx4 v[120:123], v2, s[8:11], s35 offen offset:3072 sc1
ds_read_b64_tr_b16 v[28:29], v11 offset:0
ds_read_b64_tr_b16 v[30:31], v11 offset:512
ds_read_b64_tr_b16 v[32:33], v12 offset:0
ds_read_b64_tr_b16 v[34:35], v12 offset:512
ds_read_b64_tr_b16 v[36:37], v11 offset:2048
ds_read_b64_tr_b16 v[38:39], v11 offset:2560
ds_read_b64_tr_b16 v[40:41], v12 offset:2048
ds_read_b64_tr_b16 v[42:43], v12 offset:2560
s_waitcnt lgkmcnt(0)
s_add_u32 m0, s41, 0
s_add_u32 s35, s42, 65536
buffer_load_dwordx4 v9, s[12:15], s35 offen lds
s_add_u32 m0, s41, 1024
s_add_u32 s35, s42, 73728
buffer_load_dwordx4 v9, s[12:15], s35 offen lds
s_add_u32 m0, s41, 2048
s_add_u32 s35, s42, 81920
buffer_load_dwordx4 v9, s[12:15], s35 offen lds
s_add_u32 m0, s41, 3072
s_add_u32 s35, s42, 90112
buffer_load_dwordx4 v9, s[12:15], s35 offen lds
s_add_u32 s35, s43, s51
s_add_u32 s35, s35, 4096
buffer_load_dwordx4 v[124:127], v2, s[8:11], s35 offen offset:0 sc1
buffer_load_dwordx4 v[132:135], v2, s[8:11], s35 offen offset:1024 sc1
s_add_u32 s35, s43, s58
s_add_u32 s35, s35, 4096
buffer_load_dwordx4 v[128:131], v2, s[8:11], s35 offen offset:0 sc1
buffer_load_dwordx4 v[136:139], v2, s[8:11], s35 offen offset:1024 sc1
s_waitcnt vmcnt(15)
v_mfma_f32_32x32x16_bf16 v[156:171], v[28:31], v[92:95], 0
v_mfma_f32_32x32x16_bf16 v[172:187], v[32:35], v[92:95], 0
s_waitcnt vmcnt(13)
v_mfma_f32_32x32x16_bf16 v[188:203], v[28:31], v[96:99], 0
v_mfma_f32_32x32x16_bf16 v[204:219], v[32:35], v[96:99], 0
v_mfma_f32_32x32x16_bf16 v[156:171], v[36:39], v[100:103], v[156:171]
v_mfma_f32_32x32x16_bf16 v[172:187], v[40:43], v[100:103], v[172:187]
s_waitcnt vmcnt(12)
v_mfma_f32_32x32x16_bf16 v[188:203], v[36:39], v[104:107], v[188:203]
v_mfma_f32_32x32x16_bf16 v[204:219], v[40:43], v[104:107], v[204:219]
ds_read_b64_tr_b16 v[44:45], v11 offset:4096
ds_read_b64_tr_b16 v[46:47], v11 offset:4608
ds_read_b64_tr_b16 v[48:49], v12 offset:4096
ds_read_b64_tr_b16 v[50:51], v12 offset:4608
ds_read_b64_tr_b16 v[52:53], v11 offset:6144
ds_read_b64_tr_b16 v[54:55], v11 offset:6656
ds_read_b64_tr_b16 v[56:57], v12 offset:6144
ds_read_b64_tr_b16 v[58:59], v12 offset:6656
s_waitcnt lgkmcnt(0)
s_add_u32 m0, s41, 4096
s_add_u32 s35, s42, 98304
buffer_load_dwordx4 v9, s[12:15], s35 offen lds
s_add_u32 m0, s41, 5120
s_add_u32 s35, s42, 106496
buffer_load_dwordx4 v9, s[12:15], s35 offen lds
s_add_u32 m0, s41, 6144
s_add_u32 s35, s42, 114688
buffer_load_dwordx4 v9, s[12:15], s35 offen lds
s_add_u32 m0, s41, 7168
s_add_u32 s35, s42, 122880
buffer_load_dwordx4 v9, s[12:15], s35 offen lds
s_add_u32 s35, s43, s51
s_add_u32 s35, s35, 6144
buffer_load_dwordx4 v[92:95], v2, s[8:11], s35 offen offset:0 sc1
buffer_load_dwordx4 v[100:103], v2, s[8:11], s35 offen offset:1024 sc1
s_add_u32 s35, s43, s58
s_add_u32 s35, s35, 6144
buffer_load_dwordx4 v[96:99], v2, s[8:11], s35 offen offset:0 sc1
buffer_load_dwordx4 v[104:107], v2, s[8:11], s35 offen offset:1024 sc1
s_waitcnt vmcnt(19)
v_mfma_f32_32x32x16_bf16 v[156:171], v[44:47], v[108:111], v[156:171]
v_mfma_f32_32x32x16_bf16 v[172:187], v[48:51], v[108:111], v[172:187]
s_waitcnt vmcnt(17)
v_mfma_f32_32x32x16_bf16 v[188:203], v[44:47], v[112:115], v[188:203]
v_mfma_f32_32x32x16_bf16 v[204:219], v[48:51], v[112:115], v[204:219]
v_mfma_f32_32x32x16_bf16 v[156:171], v[52:55], v[116:119], v[156:171]
v_mfma_f32_32x32x16_bf16 v[172:187], v[56:59], v[116:119], v[172:187]
s_waitcnt vmcnt(16)
v_mfma_f32_32x32x16_bf16 v[188:203], v[52:55], v[120:123], v[188:203]
v_mfma_f32_32x32x16_bf16 v[204:219], v[56:59], v[120:123], v[204:219]
s_waitcnt vmcnt(12)
ds_read_b64_tr_b16 v[28:29], v11 offset:0
ds_read_b64_tr_b16 v[30:31], v11 offset:512
ds_read_b64_tr_b16 v[32:33], v12 offset:0
ds_read_b64_tr_b16 v[34:35], v12 offset:512
ds_read_b64_tr_b16 v[36:37], v11 offset:2048
ds_read_b64_tr_b16 v[38:39], v11 offset:2560
ds_read_b64_tr_b16 v[40:41], v12 offset:2048
ds_read_b64_tr_b16 v[42:43], v12 offset:2560
s_waitcnt lgkmcnt(0)
s_add_u32 m0, s41, 0
s_add_u32 s35, s42, 131072
buffer_load_dwordx4 v9, s[12:15], s35 offen lds
s_add_u32 m0, s41, 1024
s_add_u32 s35, s42, 139264
buffer_load_dwordx4 v9, s[12:15], s35 offen lds
s_add_u32 m0, s41, 2048
s_add_u32 s35, s42, 147456
buffer_load_dwordx4 v9, s[12:15], s35 offen lds
s_add_u32 m0, s41, 3072
s_add_u32 s35, s42, 155648
buffer_load_dwordx4 v9, s[12:15], s35 offen lds
s_add_u32 s35, s43, s51
s_add_u32 s35, s35, 8192
buffer_load_dwordx4 v[108:111], v2, s[8:11], s35 offen offset:0 sc1
buffer_load_dwordx4 v[116:119], v2, s[8:11], s35 offen offset:1024 sc1
s_add_u32 s35, s43, s58
s_add_u32 s35, s35, 8192
buffer_load_dwordx4 v[112:115], v2, s[8:11], s35 offen offset:0 sc1
buffer_load_dwordx4 v[120:123], v2, s[8:11], s35 offen offset:1024 sc1
s_waitcnt vmcnt(19)
v_mfma_f32_32x32x16_bf16 v[156:171], v[28:31], v[124:127], v[156:171]
v_mfma_f32_32x32x16_bf16 v[172:187], v[32:35], v[124:127], v[172:187]
s_waitcnt vmcnt(17)
v_mfma_f32_32x32x16_bf16 v[188:203], v[28:31], v[128:131], v[188:203]
v_mfma_f32_32x32x16_bf16 v[204:219], v[32:35], v[128:131], v[204:219]
v_mfma_f32_32x32x16_bf16 v[156:171], v[36:39], v[132:135], v[156:171]
v_mfma_f32_32x32x16_bf16 v[172:187], v[40:43], v[132:135], v[172:187]
s_waitcnt vmcnt(16)
v_mfma_f32_32x32x16_bf16 v[188:203], v[36:39], v[136:139], v[188:203]
v_mfma_f32_32x32x16_bf16 v[204:219], v[40:43], v[136:139], v[204:219]
s_waitcnt vmcnt(12)
ds_read_b64_tr_b16 v[44:45], v11 offset:4096
ds_read_b64_tr_b16 v[46:47], v11 offset:4608
ds_read_b64_tr_b16 v[48:49], v12 offset:4096
ds_read_b64_tr_b16 v[50:51], v12 offset:4608
ds_read_b64_tr_b16 v[52:53], v11 offset:6144
ds_read_b64_tr_b16 v[54:55], v11 offset:6656
ds_read_b64_tr_b16 v[56:57], v12 offset:6144
ds_read_b64_tr_b16 v[58:59], v12 offset:6656
s_waitcnt lgkmcnt(0)
s_add_u32 m0, s41, 4096
s_add_u32 s35, s42, 163840
buffer_load_dwordx4 v9, s[12:15], s35 offen lds
s_add_u32 m0, s41, 5120
s_add_u32 s35, s42, 172032
buffer_load_dwordx4 v9, s[12:15], s35 offen lds
s_add_u32 m0, s41, 6144
s_add_u32 s35, s42, 180224
buffer_load_dwordx4 v9, s[12:15], s35 offen lds
s_add_u32 m0, s41, 7168
s_add_u32 s35, s42, 188416
buffer_load_dwordx4 v9, s[12:15], s35 offen lds
s_add_u32 s35, s43, s51
s_add_u32 s35, s35, 10240
buffer_load_dwordx4 v[124:127], v2, s[8:11], s35 offen offset:0 sc1
buffer_load_dwordx4 v[132:135], v2, s[8:11], s35 offen offset:1024 sc1
s_add_u32 s35, s43, s58
s_add_u32 s35, s35, 10240
buffer_load_dwordx4 v[128:131], v2, s[8:11], s35 offen offset:0 sc1
buffer_load_dwordx4 v[136:139], v2, s[8:11], s35 offen offset:1024 sc1
s_waitcnt vmcnt(19)
v_mfma_f32_32x32x16_bf16 v[156:171], v[44:47], v[92:95], v[156:171]
v_mfma_f32_32x32x16_bf16 v[172:187], v[48:51], v[92:95], v[172:187]
s_waitcnt vmcnt(17)
v_mfma_f32_32x32x16_bf16 v[188:203], v[44:47], v[96:99], v[188:203]
v_mfma_f32_32x32x16_bf16 v[204:219], v[48:51], v[96:99], v[204:219]
v_mfma_f32_32x32x16_bf16 v[156:171], v[52:55], v[100:103], v[156:171]
v_mfma_f32_32x32x16_bf16 v[172:187], v[56:59], v[100:103], v[172:187]
s_waitcnt vmcnt(16)
v_mfma_f32_32x32x16_bf16 v[188:203], v[52:55], v[104:107], v[188:203]
v_mfma_f32_32x32x16_bf16 v[204:219], v[56:59], v[104:107], v[204:219]
s_waitcnt vmcnt(12)
ds_read_b64_tr_b16 v[28:29], v11 offset:0
ds_read_b64_tr_b16 v[30:31], v11 offset:512
ds_read_b64_tr_b16 v[32:33], v12 offset:0
ds_read_b64_tr_b16 v[34:35], v12 offset:512
ds_read_b64_tr_b16 v[36:37], v11 offset:2048
ds_read_b64_tr_b16 v[38:39], v11 offset:2560
ds_read_b64_tr_b16 v[40:41], v12 offset:2048
ds_read_b64_tr_b16 v[42:43], v12 offset:2560
s_waitcnt lgkmcnt(0)
s_add_u32 m0, s41, 0
s_add_u32 s35, s42, 196608
buffer_load_dwordx4 v9, s[12:15], s35 offen lds
s_add_u32 m0, s41, 1024
s_add_u32 s35, s42, 204800
buffer_load_dwordx4 v9, s[12:15], s35 offen lds
s_add_u32 m0, s41, 2048
s_add_u32 s35, s42, 212992
buffer_load_dwordx4 v9, s[12:15], s35 offen lds
s_add_u32 m0, s41, 3072
s_add_u32 s35, s42, 221184
buffer_load_dwordx4 v9, s[12:15], s35 offen lds
s_add_u32 s35, s43, s51
s_add_u32 s35, s35, 12288
buffer_load_dwordx4 v[92:95], v2, s[8:11], s35 offen offset:0 sc1
buffer_load_dwordx4 v[100:103], v2, s[8:11], s35 offen offset:1024 sc1
s_add_u32 s35, s43, s58
s_add_u32 s35, s35, 12288
buffer_load_dwordx4 v[96:99], v2, s[8:11], s35 offen offset:0 sc1
buffer_load_dwordx4 v[104:107], v2, s[8:11], s35 offen offset:1024 sc1
s_waitcnt vmcnt(19)
v_mfma_f32_32x32x16_bf16 v[156:171], v[28:31], v[108:111], v[156:171]
v_mfma_f32_32x32x16_bf16 v[172:187], v[32:35], v[108:111], v[172:187]
s_waitcnt vmcnt(17)
v_mfma_f32_32x32x16_bf16 v[188:203], v[28:31], v[112:115], v[188:203]
v_mfma_f32_32x32x16_bf16 v[204:219], v[32:35], v[112:115], v[204:219]
v_mfma_f32_32x32x16_bf16 v[156:171], v[36:39], v[116:119], v[156:171]
v_mfma_f32_32x32x16_bf16 v[172:187], v[40:43], v[116:119], v[172:187]
s_waitcnt vmcnt(16)
v_mfma_f32_32x32x16_bf16 v[188:203], v[36:39], v[120:123], v[188:203]
v_mfma_f32_32x32x16_bf16 v[204:219], v[40:43], v[120:123], v[204:219]
s_waitcnt vmcnt(12)
ds_read_b64_tr_b16 v[44:45], v11 offset:4096
ds_read_b64_tr_b16 v[46:47], v11 offset:4608
ds_read_b64_tr_b16 v[48:49], v12 offset:4096
ds_read_b64_tr_b16 v[50:51], v12 offset:4608
ds_read_b64_tr_b16 v[52:53], v11 offset:6144
ds_read_b64_tr_b16 v[54:55], v11 offset:6656
ds_read_b64_tr_b16 v[56:57], v12 offset:6144
ds_read_b64_tr_b16 v[58:59], v12 offset:6656
s_waitcnt lgkmcnt(0)
s_add_u32 m0, s41, 4096
s_add_u32 s35, s42, 229376
buffer_load_dwordx4 v9, s[12:15], s35 offen lds
s_add_u32 m0, s41, 5120
s_add_u32 s35, s42, 237568
buffer_load_dwordx4 v9, s[12:15], s35 offen lds
s_add_u32 m0, s41, 6144
s_add_u32 s35, s42, 245760
buffer_load_dwordx4 v9, s[12:15], s35 offen lds
s_add_u32 m0, s41, 7168
s_add_u32 s35, s42, 253952
buffer_load_dwordx4 v9, s[12:15], s35 offen lds
s_add_u32 s35, s43, s51
s_add_u32 s35, s35, 14336
buffer_load_dwordx4 v[108:111], v2, s[8:11], s35 offen offset:0 sc1
buffer_load_dwordx4 v[116:119], v2, s[8:11], s35 offen offset:1024 sc1
s_add_u32 s35, s43, s58
s_add_u32 s35, s35, 14336
buffer_load_dwordx4 v[112:115], v2, s[8:11], s35 offen offset:0 sc1
buffer_load_dwordx4 v[120:123], v2, s[8:11], s35 offen offset:1024 sc1
s_waitcnt vmcnt(19)
v_mfma_f32_32x32x16_bf16 v[156:171], v[44:47], v[124:127], v[156:171]
v_mfma_f32_32x32x16_bf16 v[172:187], v[48:51], v[124:127], v[172:187]
s_waitcnt vmcnt(17)
v_mfma_f32_32x32x16_bf16 v[188:203], v[44:47], v[128:131], v[188:203]
v_mfma_f32_32x32x16_bf16 v[204:219], v[48:51], v[128:131], v[204:219]
v_mfma_f32_32x32x16_bf16 v[156:171], v[52:55], v[132:135], v[156:171]
v_mfma_f32_32x32x16_bf16 v[172:187], v[56:59], v[132:135], v[172:187]
s_waitcnt vmcnt(16)
v_mfma_f32_32x32x16_bf16 v[188:203], v[52:55], v[136:139], v[188:203]
v_mfma_f32_32x32x16_bf16 v[204:219], v[56:59], v[136:139], v[204:219]
s_waitcnt vmcnt(12)
ds_read_b64_tr_b16 v[28:29], v11 offset:0
ds_read_b64_tr_b16 v[30:31], v11 offset:512
ds_read_b64_tr_b16 v[32:33], v12 offset:0
ds_read_b64_tr_b16 v[34:35], v12 offset:512
ds_read_b64_tr_b16 v[36:37], v11 offset:2048
ds_read_b64_tr_b16 v[38:39], v11 offset:2560
ds_read_b64_tr_b16 v[40:41], v12 offset:2048
ds_read_b64_tr_b16 v[42:43], v12 offset:2560
s_waitcnt lgkmcnt(0)
s_add_u32 m0, s41, 0
s_add_u32 s35, s42, 262144
buffer_load_dwordx4 v9, s[12:15], s35 offen lds
s_add_u32 m0, s41, 1024
s_add_u32 s35, s42, 270336
buffer_load_dwordx4 v9, s[12:15], s35 offen lds
s_add_u32 m0, s41, 2048
s_add_u32 s35, s42, 278528
buffer_load_dwordx4 v9, s[12:15], s35 offen lds
s_add_u32 m0, s41, 3072
s_add_u32 s35, s42, 286720
buffer_load_dwordx4 v9, s[12:15], s35 offen lds
s_add_u32 s35, s43, s51
s_add_u32 s35, s35, 16384
buffer_load_dwordx4 v[124:127], v2, s[8:11], s35 offen offset:0 sc1
buffer_load_dwordx4 v[132:135], v2, s[8:11], s35 offen offset:1024 sc1
s_add_u32 s35, s43, s58
s_add_u32 s35, s35, 16384
buffer_load_dwordx4 v[128:131], v2, s[8:11], s35 offen offset:0 sc1
buffer_load_dwordx4 v[136:139], v2, s[8:11], s35 offen offset:1024 sc1
s_waitcnt vmcnt(19)
v_mfma_f32_32x32x16_bf16 v[156:171], v[28:31], v[92:95], v[156:171]
v_mfma_f32_32x32x16_bf16 v[172:187], v[32:35], v[92:95], v[172:187]
s_waitcnt vmcnt(17)
v_mfma_f32_32x32x16_bf16 v[188:203], v[28:31], v[96:99], v[188:203]
v_mfma_f32_32x32x16_bf16 v[204:219], v[32:35], v[96:99], v[204:219]
v_mfma_f32_32x32x16_bf16 v[156:171], v[36:39], v[100:103], v[156:171]
v_mfma_f32_32x32x16_bf16 v[172:187], v[40:43], v[100:103], v[172:187]
s_waitcnt vmcnt(16)
v_mfma_f32_32x32x16_bf16 v[188:203], v[36:39], v[104:107], v[188:203]
v_mfma_f32_32x32x16_bf16 v[204:219], v[40:43], v[104:107], v[204:219]
s_waitcnt vmcnt(12)
ds_read_b64_tr_b16 v[44:45], v11 offset:4096
ds_read_b64_tr_b16 v[46:47], v11 offset:4608
ds_read_b64_tr_b16 v[48:49], v12 offset:4096
ds_read_b64_tr_b16 v[50:51], v12 offset:4608
ds_read_b64_tr_b16 v[52:53], v11 offset:6144
ds_read_b64_tr_b16 v[54:55], v11 offset:6656
ds_read_b64_tr_b16 v[56:57], v12 offset:6144
ds_read_b64_tr_b16 v[58:59], v12 offset:6656
s_waitcnt lgkmcnt(0)
s_add_u32 m0, s41, 4096
s_add_u32 s35, s42, 294912
buffer_load_dwordx4 v9, s[12:15], s35 offen lds
s_add_u32 m0, s41, 5120
s_add_u32 s35, s42, 303104
buffer_load_dwordx4 v9, s[12:15], s35 offen lds
s_add_u32 m0, s41, 6144
s_add_u32 s35, s42, 311296
buffer_load_dwordx4 v9, s[12:15], s35 offen lds
s_add_u32 m0, s41, 7168
s_add_u32 s35, s42, 319488
buffer_load_dwordx4 v9, s[12:15], s35 offen lds
s_add_u32 s35, s43, s51
s_add_u32 s35, s35, 18432
buffer_load_dwordx4 v[92:95], v2, s[8:11], s35 offen offset:0 sc1
buffer_load_dwordx4 v[100:103], v2, s[8:11], s35 offen offset:1024 sc1
s_add_u32 s35, s43, s58
s_add_u32 s35, s35, 18432
buffer_load_dwordx4 v[96:99], v2, s[8:11], s35 offen offset:0 sc1
buffer_load_dwordx4 v[104:107], v2, s[8:11], s35 offen offset:1024 sc1
s_waitcnt vmcnt(19)
v_mfma_f32_32x32x16_bf16 v[156:171], v[44:47], v[108:111], v[156:171]
v_mfma_f32_32x32x16_bf16 v[172:187], v[48:51], v[108:111], v[172:187]
s_waitcnt vmcnt(17)
v_mfma_f32_32x32x16_bf16 v[188:203], v[44:47], v[112:115], v[188:203]
v_mfma_f32_32x32x16_bf16 v[204:219], v[48:51], v[112:115], v[204:219]
v_mfma_f32_32x32x16_bf16 v[156:171], v[52:55], v[116:119], v[156:171]
v_mfma_f32_32x32x16_bf16 v[172:187], v[56:59], v[116:119], v[172:187]
s_waitcnt vmcnt(16)
v_mfma_f32_32x32x16_bf16 v[188:203], v[52:55], v[120:123], v[188:203]
v_mfma_f32_32x32x16_bf16 v[204:219], v[56:59], v[120:123], v[204:219]
s_waitcnt vmcnt(12)
ds_read_b64_tr_b16 v[28:29], v11 offset:0
ds_read_b64_tr_b16 v[30:31], v11 offset:512
ds_read_b64_tr_b16 v[32:33], v12 offset:0
ds_read_b64_tr_b16 v[34:35], v12 offset:512
ds_read_b64_tr_b16 v[36:37], v11 offset:2048
ds_read_b64_tr_b16 v[38:39], v11 offset:2560
ds_read_b64_tr_b16 v[40:41], v12 offset:2048
ds_read_b64_tr_b16 v[42:43], v12 offset:2560
s_waitcnt lgkmcnt(0)
s_add_u32 m0, s41, 0
s_add_u32 s35, s44, 0
buffer_load_dwordx4 v9, s[16:19], s35 offen lds
s_add_u32 m0, s41, 1024
s_add_u32 s35, s44, 8192
buffer_load_dwordx4 v9, s[16:19], s35 offen lds
s_add_u32 m0, s41, 2048
s_add_u32 s35, s44, 16384
buffer_load_dwordx4 v9, s[16:19], s35 offen lds
s_add_u32 m0, s41, 3072
s_add_u32 s35, s44, 24576
buffer_load_dwordx4 v9, s[16:19], s35 offen lds
s_add_u32 s35, s43, s51
s_add_u32 s35, s35, 20480
buffer_load_dwordx4 v[108:111], v2, s[8:11], s35 offen offset:0 sc1
buffer_load_dwordx4 v[116:119], v2, s[8:11], s35 offen offset:1024 sc1
s_add_u32 s35, s43, s58
s_add_u32 s35, s35, 20480
buffer_load_dwordx4 v[112:115], v2, s[8:11], s35 offen offset:0 sc1
buffer_load_dwordx4 v[120:123], v2, s[8:11], s35 offen offset:1024 sc1
s_waitcnt vmcnt(19)
v_mfma_f32_32x32x16_bf16 v[156:171], v[28:31], v[124:127], v[156:171]
v_mfma_f32_32x32x16_bf16 v[172:187], v[32:35], v[124:127], v[172:187]
s_waitcnt vmcnt(17)
v_mfma_f32_32x32x16_bf16 v[188:203], v[28:31], v[128:131], v[188:203]
v_mfma_f32_32x32x16_bf16 v[204:219], v[32:35], v[128:131], v[204:219]
v_mfma_f32_32x32x16_bf16 v[156:171], v[36:39], v[132:135], v[156:171]
v_mfma_f32_32x32x16_bf16 v[172:187], v[40:43], v[132:135], v[172:187]
s_waitcnt vmcnt(16)
v_mfma_f32_32x32x16_bf16 v[188:203], v[36:39], v[136:139], v[188:203]
v_mfma_f32_32x32x16_bf16 v[204:219], v[40:43], v[136:139], v[204:219]
s_waitcnt vmcnt(12)
ds_read_b64_tr_b16 v[44:45], v11 offset:4096
ds_read_b64_tr_b16 v[46:47], v11 offset:4608
ds_read_b64_tr_b16 v[48:49], v12 offset:4096
ds_read_b64_tr_b16 v[50:51], v12 offset:4608
ds_read_b64_tr_b16 v[52:53], v11 offset:6144
ds_read_b64_tr_b16 v[54:55], v11 offset:6656
ds_read_b64_tr_b16 v[56:57], v12 offset:6144
ds_read_b64_tr_b16 v[58:59], v12 offset:6656
s_waitcnt lgkmcnt(0)
s_add_u32 m0, s41, 4096
s_add_u32 s35, s44, 32768
buffer_load_dwordx4 v9, s[16:19], s35 offen lds
s_add_u32 m0, s41, 5120
s_add_u32 s35, s44, 40960
buffer_load_dwordx4 v9, s[16:19], s35 offen lds
s_add_u32 m0, s41, 6144
s_add_u32 s35, s44, 49152
buffer_load_dwordx4 v9, s[16:19], s35 offen lds
s_add_u32 m0, s41, 7168
s_add_u32 s35, s44, 57344
buffer_load_dwordx4 v9, s[16:19], s35 offen lds
s_add_u32 s35, s43, s51
s_add_u32 s35, s35, 22528
buffer_load_dwordx4 v[124:127], v2, s[8:11], s35 offen offset:0 sc1
buffer_load_dwordx4 v[132:135], v2, s[8:11], s35 offen offset:1024 sc1
s_add_u32 s35, s43, s58
s_add_u32 s35, s35, 22528
buffer_load_dwordx4 v[128:131], v2, s[8:11], s35 offen offset:0 sc1
buffer_load_dwordx4 v[136:139], v2, s[8:11], s35 offen offset:1024 sc1
s_waitcnt vmcnt(19)
v_mfma_f32_32x32x16_bf16 v[156:171], v[44:47], v[92:95], v[156:171]
v_mfma_f32_32x32x16_bf16 v[172:187], v[48:51], v[92:95], v[172:187]
s_waitcnt vmcnt(17)
v_mfma_f32_32x32x16_bf16 v[188:203], v[44:47], v[96:99], v[188:203]
v_mfma_f32_32x32x16_bf16 v[204:219], v[48:51], v[96:99], v[204:219]
v_mfma_f32_32x32x16_bf16 v[156:171], v[52:55], v[100:103], v[156:171]
v_mfma_f32_32x32x16_bf16 v[172:187], v[56:59], v[100:103], v[172:187]
s_waitcnt vmcnt(16)
v_mfma_f32_32x32x16_bf16 v[188:203], v[52:55], v[104:107], v[188:203]
v_mfma_f32_32x32x16_bf16 v[204:219], v[56:59], v[104:107], v[204:219]
s_waitcnt vmcnt(12)
ds_read_b64_tr_b16 v[28:29], v15 offset:0
ds_read_b64_tr_b16 v[30:31], v15 offset:1024
ds_read_b64_tr_b16 v[32:33], v16 offset:0
ds_read_b64_tr_b16 v[34:35], v16 offset:1024
ds_read_b64_tr_b16 v[36:37], v15 offset:2048
ds_read_b64_tr_b16 v[38:39], v15 offset:3072
ds_read_b64_tr_b16 v[40:41], v16 offset:2048
ds_read_b64_tr_b16 v[42:43], v16 offset:3072
s_waitcnt lgkmcnt(0)
s_add_u32 m0, s41, 0
s_add_u32 s35, s44, 65536
buffer_load_dwordx4 v9, s[16:19], s35 offen lds
s_add_u32 m0, s41, 1024
s_add_u32 s35, s44, 73728
buffer_load_dwordx4 v9, s[16:19], s35 offen lds
s_add_u32 m0, s41, 2048
s_add_u32 s35, s44, 81920
buffer_load_dwordx4 v9, s[16:19], s35 offen lds
s_add_u32 m0, s41, 3072
s_add_u32 s35, s44, 90112
buffer_load_dwordx4 v9, s[16:19], s35 offen lds
s_waitcnt vmcnt(8)
ds_read_b64_tr_b16 v[44:45], v15 offset:4096
ds_read_b64_tr_b16 v[46:47], v15 offset:5120
ds_read_b64_tr_b16 v[48:49], v16 offset:4096
ds_read_b64_tr_b16 v[50:51], v16 offset:5120
ds_read_b64_tr_b16 v[52:53], v15 offset:6144
ds_read_b64_tr_b16 v[54:55], v15 offset:7168
ds_read_b64_tr_b16 v[56:57], v16 offset:6144
ds_read_b64_tr_b16 v[58:59], v16 offset:7168
s_waitcnt lgkmcnt(0)
s_add_u32 m0, s41, 4096
s_add_u32 s35, s44, 98304
buffer_load_dwordx4 v9, s[16:19], s35 offen lds
s_add_u32 m0, s41, 5120
s_add_u32 s35, s44, 106496
buffer_load_dwordx4 v9, s[16:19], s35 offen lds
s_add_u32 m0, s41, 6144
s_add_u32 s35, s44, 114688
buffer_load_dwordx4 v9, s[16:19], s35 offen lds
s_add_u32 m0, s41, 7168
s_add_u32 s35, s44, 122880
buffer_load_dwordx4 v9, s[16:19], s35 offen lds
s_waitcnt vmcnt(4)
ds_read_b64_tr_b16 v[60:61], v15 offset:0
ds_read_b64_tr_b16 v[62:63], v15 offset:1024
ds_read_b64_tr_b16 v[64:65], v16 offset:0
ds_read_b64_tr_b16 v[66:67], v16 offset:1024
ds_read_b64_tr_b16 v[68:69], v15 offset:2048
ds_read_b64_tr_b16 v[70:71], v15 offset:3072
ds_read_b64_tr_b16 v[72:73], v16 offset:2048
ds_read_b64_tr_b16 v[74:75], v16 offset:3072
s_waitcnt lgkmcnt(0)
s_add_u32 m0, s41, 0
s_add_u32 s35, s42, 327680
buffer_load_dwordx4 v9, s[12:15], s35 offen lds
s_add_u32 m0, s41, 1024
s_add_u32 s35, s42, 335872
buffer_load_dwordx4 v9, s[12:15], s35 offen lds
s_add_u32 m0, s41, 2048
s_add_u32 s35, s42, 344064
buffer_load_dwordx4 v9, s[12:15], s35 offen lds
s_add_u32 m0, s41, 3072
s_add_u32 s35, s42, 352256
buffer_load_dwordx4 v9, s[12:15], s35 offen lds
s_waitcnt vmcnt(4)
ds_read_b64_tr_b16 v[76:77], v15 offset:4096
ds_read_b64_tr_b16 v[78:79], v15 offset:5120
ds_read_b64_tr_b16 v[80:81], v16 offset:4096
ds_read_b64_tr_b16 v[82:83], v16 offset:5120
ds_read_b64_tr_b16 v[84:85], v15 offset:6144
ds_read_b64_tr_b16 v[86:87], v15 offset:7168
ds_read_b64_tr_b16 v[88:89], v16 offset:6144
ds_read_b64_tr_b16 v[90:91], v16 offset:7168
s_waitcnt lgkmcnt(0)
s_add_u32 m0, s41, 4096
s_add_u32 s35, s42, 360448
buffer_load_dwordx4 v9, s[12:15], s35 offen lds
s_add_u32 m0, s41, 5120
s_add_u32 s35, s42, 368640
buffer_load_dwordx4 v9, s[12:15], s35 offen lds
s_add_u32 m0, s41, 6144
s_add_u32 s35, s42, 376832
buffer_load_dwordx4 v9, s[12:15], s35 offen lds
s_add_u32 m0, s41, 7168
s_add_u32 s35, s42, 385024
buffer_load_dwordx4 v9, s[12:15], s35 offen lds
s_lshl_b32 s35, s39, 6
s_lshr_b32 s36, s50, 1
s_lshl_b32 s36, s36, 5
s_add_u32 s35, s35, s36
v_and_b32 v3, 31, v1
v_add_u32 v3, s35, v3
v_lshlrev_b32 v3, 10, v3
s_lshl_b32 s35, s40, 7
s_and_b32 s36, s50, 1
s_lshl_b32 s36, s36, 6
s_add_u32 s35, s35, s36
v_add_u32 v3, s35, v3
v_lshrrev_b32 v4, 5, v1
v_lshl_add_u32 v10, v4, 3, v3
buffer_load_dwordx2 v[20:21], v10, s[20:23], 0 offen offset:0
buffer_load_dwordx2 v[22:23], v10, s[20:23], 0 offen offset:16
buffer_load_dwordx2 v[24:25], v10, s[20:23], 0 offen offset:32
buffer_load_dwordx2 v[26:27], v10, s[20:23], 0 offen offset:48
v_lshl_add_u32 v10, v4, 4, v3
s_barrier
s_waitcnt vmcnt(8)
ds_read_b64_tr_b16 v[220:221], v11 offset:0
ds_read_b64_tr_b16 v[222:223], v11 offset:512
ds_read_b64_tr_b16 v[224:225], v12 offset:0
ds_read_b64_tr_b16 v[226:227], v12 offset:512
ds_read_b64_tr_b16 v[228:229], v11 offset:2048
ds_read_b64_tr_b16 v[230:231], v11 offset:2560
ds_read_b64_tr_b16 v[232:233], v12 offset:2048
ds_read_b64_tr_b16 v[234:235], v12 offset:2560
s_waitcnt lgkmcnt(0)
s_add_u32 m0, s41, 0
s_add_u32 s35, s42, 393216
buffer_load_dwordx4 v9, s[12:15], s35 offen lds
s_add_u32 m0, s41, 1024
s_add_u32 s35, s42, 401408
buffer_load_dwordx4 v9, s[12:15], s35 offen lds
s_add_u32 m0, s41, 2048
s_add_u32 s35, s42, 409600
buffer_load_dwordx4 v9, s[12:15], s35 offen lds
s_add_u32 m0, s41, 3072
s_add_u32 s35, s42, 417792
buffer_load_dwordx4 v9, s[12:15], s35 offen lds
s_add_u32 s35, s43, s51
s_add_u32 s35, s35, 24576
buffer_load_dwordx4 v[92:95], v2, s[8:11], s35 offen offset:0 sc1
buffer_load_dwordx4 v[100:103], v2, s[8:11], s35 offen offset:1024 sc1
s_add_u32 s35, s43, s58
s_add_u32 s35, s35, 24576
buffer_load_dwordx4 v[96:99], v2, s[8:11], s35 offen offset:0 sc1
buffer_load_dwordx4 v[104:107], v2, s[8:11], s35 offen offset:1024 sc1
v_mfma_f32_32x32x16_bf16 v[156:171], v[220:223], v[108:111], v[156:171]
v_mfma_f32_32x32x16_bf16 v[172:187], v[224:227], v[108:111], v[172:187]
v_mfma_f32_32x32x16_bf16 v[188:203], v[220:223], v[112:115], v[188:203]
v_mfma_f32_32x32x16_bf16 v[204:219], v[224:227], v[112:115], v[204:219]
v_mfma_f32_32x32x16_bf16 v[156:171], v[228:231], v[116:119], v[156:171]
v_mfma_f32_32x32x16_bf16 v[172:187], v[232:235], v[116:119], v[172:187]
v_mfma_f32_32x32x16_bf16 v[188:203], v[228:231], v[120:123], v[188:203]
v_mfma_f32_32x32x16_bf16 v[204:219], v[232:235], v[120:123], v[204:219]
s_waitcnt vmcnt(12)
ds_read_b64_tr_b16 v[220:221], v11 offset:4096
ds_read_b64_tr_b16 v[222:223], v11 offset:4608
ds_read_b64_tr_b16 v[224:225], v12 offset:4096
ds_read_b64_tr_b16 v[226:227], v12 offset:4608
ds_read_b64_tr_b16 v[228:229], v11 offset:6144
ds_read_b64_tr_b16 v[230:231], v11 offset:6656
ds_read_b64_tr_b16 v[232:233], v12 offset:6144
ds_read_b64_tr_b16 v[234:235], v12 offset:6656
s_waitcnt lgkmcnt(0)
s_add_u32 m0, s41, 4096
s_add_u32 s35, s42, 425984
buffer_load_dwordx4 v9, s[12:15], s35 offen lds
s_add_u32 m0, s41, 5120
s_add_u32 s35, s42, 434176
buffer_load_dwordx4 v9, s[12:15], s35 offen lds
s_add_u32 m0, s41, 6144
s_add_u32 s35, s42, 442368
buffer_load_dwordx4 v9, s[12:15], s35 offen lds
s_add_u32 m0, s41, 7168
s_add_u32 s35, s42, 450560
buffer_load_dwordx4 v9, s[12:15], s35 offen lds
s_add_u32 s35, s43, s51
s_add_u32 s35, s35, 26624
buffer_load_dwordx4 v[108:111], v2, s[8:11], s35 offen offset:0 sc1
buffer_load_dwordx4 v[116:119], v2, s[8:11], s35 offen offset:1024 sc1
s_add_u32 s35, s43, s58
s_add_u32 s35, s35, 26624
buffer_load_dwordx4 v[112:115], v2, s[8:11], s35 offen offset:0 sc1
buffer_load_dwordx4 v[120:123], v2, s[8:11], s35 offen offset:1024 sc1
v_mfma_f32_32x32x16_bf16 v[156:171], v[220:223], v[124:127], v[156:171]
v_mfma_f32_32x32x16_bf16 v[172:187], v[224:227], v[124:127], v[172:187]
v_mfma_f32_32x32x16_bf16 v[188:203], v[220:223], v[128:131], v[188:203]
v_mfma_f32_32x32x16_bf16 v[204:219], v[224:227], v[128:131], v[204:219]
v_mfma_f32_32x32x16_bf16 v[156:171], v[228:231], v[132:135], v[156:171]
v_mfma_f32_32x32x16_bf16 v[172:187], v[232:235], v[132:135], v[172:187]
v_mfma_f32_32x32x16_bf16 v[188:203], v[228:231], v[136:139], v[188:203]
v_mfma_f32_32x32x16_bf16 v[204:219], v[232:235], v[136:139], v[204:219]
s_waitcnt vmcnt(12)
ds_read_b64_tr_b16 v[220:221], v11 offset:0
ds_read_b64_tr_b16 v[222:223], v11 offset:512
ds_read_b64_tr_b16 v[224:225], v12 offset:0
ds_read_b64_tr_b16 v[226:227], v12 offset:512
ds_read_b64_tr_b16 v[228:229], v11 offset:2048
ds_read_b64_tr_b16 v[230:231], v11 offset:2560
ds_read_b64_tr_b16 v[232:233], v12 offset:2048
ds_read_b64_tr_b16 v[234:235], v12 offset:2560
s_waitcnt lgkmcnt(0)
s_waitcnt vmcnt(11)
v_mfma_f32_32x32x16_bf16 v[156:171], v[220:223], v[92:95], v[156:171]
v_mfma_f32_32x32x16_bf16 v[172:187], v[224:227], v[92:95], v[172:187]
s_waitcnt vmcnt(9)
v_mfma_f32_32x32x16_bf16 v[188:203], v[220:223], v[96:99], v[188:203]
v_mfma_f32_32x32x16_bf16 v[204:219], v[224:227], v[96:99], v[204:219]
v_mfma_f32_32x32x16_bf16 v[156:171], v[228:231], v[100:103], v[156:171]
v_mfma_f32_32x32x16_bf16 v[172:187], v[232:235], v[100:103], v[172:187]
s_waitcnt vmcnt(8)
v_mfma_f32_32x32x16_bf16 v[188:203], v[228:231], v[104:107], v[188:203]
v_mfma_f32_32x32x16_bf16 v[204:219], v[232:235], v[104:107], v[204:219]
s_waitcnt vmcnt(4)
ds_read_b64_tr_b16 v[220:221], v11 offset:4096
ds_read_b64_tr_b16 v[222:223], v11 offset:4608
ds_read_b64_tr_b16 v[224:225], v12 offset:4096
ds_read_b64_tr_b16 v[226:227], v12 offset:4608
ds_read_b64_tr_b16 v[228:229], v11 offset:6144
ds_read_b64_tr_b16 v[230:231], v11 offset:6656
ds_read_b64_tr_b16 v[232:233], v12 offset:6144
ds_read_b64_tr_b16 v[234:235], v12 offset:6656
s_waitcnt lgkmcnt(0)
s_waitcnt vmcnt(3)
v_mfma_f32_32x32x16_bf16 v[156:171], v[220:223], v[108:111], v[156:171]
v_mfma_f32_32x32x16_bf16 v[172:187], v[224:227], v[108:111], v[172:187]
s_waitcnt vmcnt(1)
v_mfma_f32_32x32x16_bf16 v[188:203], v[220:223], v[112:115], v[188:203]
v_mfma_f32_32x32x16_bf16 v[204:219], v[224:227], v[112:115], v[204:219]
v_mfma_f32_32x32x16_bf16 v[156:171], v[228:231], v[116:119], v[156:171]
v_mfma_f32_32x32x16_bf16 v[172:187], v[232:235], v[116:119], v[172:187]
s_waitcnt vmcnt(0)
v_mfma_f32_32x32x16_bf16 v[188:203], v[228:231], v[120:123], v[188:203]
v_mfma_f32_32x32x16_bf16 v[204:219], v[232:235], v[120:123], v[204:219]
v_lshlrev_b32 v3, 7, v1
s_lshl_b32 s35, s39, 12
s_lshl_b32 s36, s50, 10
s_add_u32 s35, s35, s36
s_add_u32 s35, s35, 21135360
s_mov_b32 s49, 100000
s_mov_b32 s4, 0xff
s_mov_b32 s5, 0x0
s_mov_b64 exec, s[4:5]
poll5:
buffer_load_dword v4, v3, s[8:11], s35 offen sc1
s_waitcnt vmcnt(0)
v_cmp_ne_u32 vcc, 1, v4
s_nop 3
s_cmp_eq_u64 vcc, 0
s_cbranch_scc1 poll5_ok
s_sleep 2
s_sub_u32 s49, s49, 1
s_cmp_lg_u32 s49, 0
s_cbranch_scc1 poll5
poll5_ok:
s_mov_b64 exec, -1
s_add_u32 s35, s45, s51
buffer_load_dwordx4 v[92:95], v2, s[8:11], s35 offen offset:0 sc1
buffer_load_dwordx4 v[100:103], v2, s[8:11], s35 offen offset:1024 sc1
s_add_u32 s35, s45, s58
buffer_load_dwordx4 v[96:99], v2, s[8:11], s35 offen offset:0 sc1
buffer_load_dwordx4 v[104:107], v2, s[8:11], s35 offen offset:1024 sc1
s_add_u32 s35, s45, s51
buffer_load_dwordx4 v[108:111], v2, s[8:11], s35 offen offset:2048 sc1
buffer_load_dwordx4 v[116:119], v2, s[8:11], s35 offen offset:3072 sc1
s_add_u32 s35, s45, s58
buffer_load_dwordx4 v[112:115], v2, s[8:11], s35 offen offset:2048 sc1
buffer_load_dwordx4 v[120:123], v2, s[8:11], s35 offen offset:3072 sc1
s_add_u32 s35, s45, s51
s_add_u32 s35, s35, 4096
buffer_load_dwordx4 v[124:127], v2, s[8:11], s35 offen offset:0 sc1
buffer_load_dwordx4 v[132:135], v2, s[8:11], s35 offen offset:1024 sc1
s_add_u32 s35, s45, s58
s_add_u32 s35, s35, 4096
buffer_load_dwordx4 v[128:131], v2, s[8:11], s35 offen offset:0 sc1
buffer_load_dwordx4 v[136:139], v2, s[8:11], s35 offen offset:1024 sc1
s_add_u32 s35, s45, s51
s_add_u32 s35, s35, 6144
buffer_load_dwordx4 v[140:143], v2, s[8:11], s35 offen offset:0 sc1
buffer_load_dwordx4 v[148:151], v2, s[8:11], s35 offen offset:1024 sc1
s_add_u32 s35, s45, s58
s_add_u32 s35, s35, 6144
buffer_load_dwordx4 v[144:147], v2, s[8:11], s35 offen offset:0 sc1
buffer_load_dwordx4 v[152:155], v2, s[8:11], s35 offen offset:1024 sc1
s_waitcnt vmcnt(15)
v_mfma_f32_32x32x16_bf16 v[156:171], v[28:31], v[92:95], v[156:171]
v_mfma_f32_32x32x16_bf16 v[172:187], v[32:35], v[92:95], v[172:187]
s_waitcnt vmcnt(13)
v_mfma_f32_32x32x16_bf16 v[188:203], v[28:31], v[96:99], v[188:203]
v_mfma_f32_32x32x16_bf16 v[204:219], v[32:35], v[96:99], v[204:219]
v_mfma_f32_32x32x16_bf16 v[156:171], v[36:39], v[100:103], v[156:171]
v_mfma_f32_32x32x16_bf16 v[172:187], v[40:43], v[100:103], v[172:187]
s_waitcnt vmcnt(12)
v_mfma_f32_32x32x16_bf16 v[188:203], v[36:39], v[104:107], v[188:203]
v_mfma_f32_32x32x16_bf16 v[204:219], v[40:43], v[104:107], v[204:219]
s_waitcnt vmcnt(11)
v_mfma_f32_32x32x16_bf16 v[156:171], v[44:47], v[108:111], v[156:171]
v_mfma_f32_32x32x16_bf16 v[172:187], v[48:51], v[108:111], v[172:187]
s_waitcnt vmcnt(9)
v_mfma_f32_32x32x16_bf16 v[188:203], v[44:47], v[112:115], v[188:203]
v_mfma_f32_32x32x16_bf16 v[204:219], v[48:51], v[112:115], v[204:219]
v_mfma_f32_32x32x16_bf16 v[156:171], v[52:55], v[116:119], v[156:171]
v_mfma_f32_32x32x16_bf16 v[172:187], v[56:59], v[116:119], v[172:187]
s_waitcnt vmcnt(8)
v_mfma_f32_32x32x16_bf16 v[188:203], v[52:55], v[120:123], v[188:203]
v_mfma_f32_32x32x16_bf16 v[204:219], v[56:59], v[120:123], v[204:219]
s_waitcnt vmcnt(7)
v_mfma_f32_32x32x16_bf16 v[156:171], v[60:63], v[124:127], v[156:171]
v_mfma_f32_32x32x16_bf16 v[172:187], v[64:67], v[124:127], v[172:187]
s_waitcnt vmcnt(5)
v_mfma_f32_32x32x16_bf16 v[188:203], v[60:63], v[128:131], v[188:203]
v_mfma_f32_32x32x16_bf16 v[204:219], v[64:67], v[128:131], v[204:219]
v_mfma_f32_32x32x16_bf16 v[156:171], v[68:71], v[132:135], v[156:171]
v_mfma_f32_32x32x16_bf16 v[172:187], v[72:75], v[132:135], v[172:187]
s_waitcnt vmcnt(4)
v_mfma_f32_32x32x16_bf16 v[188:203], v[68:71], v[136:139], v[188:203]
v_mfma_f32_32x32x16_bf16 v[204:219], v[72:75], v[136:139], v[204:219]
s_waitcnt vmcnt(3)
v_mfma_f32_32x32x16_bf16 v[156:171], v[76:79], v[140:143], v[156:171]
v_mfma_f32_32x32x16_bf16 v[172:187], v[80:83], v[140:143], v[172:187]
s_waitcnt vmcnt(1)
v_mfma_f32_32x32x16_bf16 v[188:203], v[76:79], v[144:147], v[188:203]
v_mfma_f32_32x32x16_bf16 v[204:219], v[80:83], v[144:147], v[204:219]
v_mfma_f32_32x32x16_bf16 v[156:171], v[84:87], v[148:151], v[156:171]
v_mfma_f32_32x32x16_bf16 v[172:187], v[88:91], v[148:151], v[172:187]
s_waitcnt vmcnt(0)
v_mfma_f32_32x32x16_bf16 v[188:203], v[84:87], v[152:155], v[188:203]
v_mfma_f32_32x32x16_bf16 v[204:219], v[88:91], v[152:155], v[204:219]
s_barrier
s_nop 7
s_xor_b32 s35, s50, 1
s_mul_i32 s35, s35, 12288
v_add_u32 v4, s35, v2
ds_write_b128 v4, v[172:175] offset:0
ds_write_b128 v4, v[176:179] offset:1024
ds_write_b128 v4, v[180:183] offset:2048
ds_write_b128 v4, v[184:187] offset:3072
s_xor_b32 s35, s50, 2
s_mul_i32 s35, s35, 12288
v_add_u32 v4, s35, v2
ds_write_b128 v4, v[188:191] offset:4096
ds_write_b128 v4, v[192:195] offset:5120
ds_write_b128 v4, v[196:199] offset:6144
ds_write_b128 v4, v[200:203] offset:7168
s_xor_b32 s35, s50, 3
s_mul_i32 s35, s35, 12288
v_add_u32 v4, s35, v2
ds_write_b128 v4, v[204:207] offset:8192
ds_write_b128 v4, v[208:211] offset:9216
ds_write_b128 v4, v[212:215] offset:10240
ds_write_b128 v4, v[216:219] offset:11264
s_waitcnt lgkmcnt(0)
s_barrier
s_mul_i32 s35, s50, 12288
v_add_u32 v3, s35, v2
ds_read_b128 v[92:95], v3 offset:0
ds_read_b128 v[108:111], v3 offset:4096
ds_read_b128 v[124:127], v3 offset:8192
ds_read_b128 v[96:99], v3 offset:1024
ds_read_b128 v[112:115], v3 offset:5120
ds_read_b128 v[128:131], v3 offset:9216
ds_read_b128 v[100:103], v3 offset:2048
ds_read_b128 v[116:119], v3 offset:6144
ds_read_b128 v[132:135], v3 offset:10240
ds_read_b128 v[104:107], v3 offset:3072
ds_read_b128 v[120:123], v3 offset:7168
ds_read_b128 v[136:139], v3 offset:11264
v_lshlrev_b32 v4, 16, v20
v_and_b32 v5, 0xffff0000, v20
v_add_f32 v156, v156, v4
v_add_f32 v157, v157, v5
v_lshlrev_b32 v4, 16, v21
v_and_b32 v5, 0xffff0000, v21
v_add_f32 v158, v158, v4
v_add_f32 v159, v159, v5
v_lshlrev_b32 v4, 16, v22
v_and_b32 v5, 0xffff0000, v22
v_add_f32 v160, v160, v4
v_add_f32 v161, v161, v5
v_lshlrev_b32 v4, 16, v23
v_and_b32 v5, 0xffff0000, v23
v_add_f32 v162, v162, v4
v_add_f32 v163, v163, v5
v_lshlrev_b32 v4, 16, v24
v_and_b32 v5, 0xffff0000, v24
v_add_f32 v164, v164, v4
v_add_f32 v165, v165, v5
v_lshlrev_b32 v4, 16, v25
v_and_b32 v5, 0xffff0000, v25
v_add_f32 v166, v166, v4
v_add_f32 v167, v167, v5
v_lshlrev_b32 v4, 16, v26
v_and_b32 v5, 0xffff0000, v26
v_add_f32 v168, v168, v4
v_add_f32 v169, v169, v5
v_lshlrev_b32 v4, 16, v27
v_and_b32 v5, 0xffff0000, v27
v_add_f32 v170, v170, v4
v_add_f32 v171, v171, v5
s_waitcnt lgkmcnt(10)
v_add_f32 v92, v92, v108
v_add_f32 v93, v93, v109
v_add_f32 v94, v94, v110
v_add_f32 v95, v95, v111
s_waitcnt lgkmcnt(9)
v_add_f32 v156, v156, v124
v_add_f32 v157, v157, v125
v_add_f32 v158, v158, v126
v_add_f32 v159, v159, v127
v_add_f32 v156, v156, v92
v_add_f32 v157, v157, v93
v_add_f32 v158, v158, v94
v_add_f32 v159, v159, v95
v_cvt_pk_bf16_f32 v28, v156, v157
v_cvt_pk_bf16_f32 v29, v158, v159
s_waitcnt lgkmcnt(7)
v_add_f32 v96, v96, v112
v_add_f32 v97, v97, v113
v_add_f32 v98, v98, v114
v_add_f32 v99, v99, v115
s_waitcnt lgkmcnt(6)
v_add_f32 v160, v160, v128
v_add_f32 v161, v161, v129
v_add_f32 v162, v162, v130
v_add_f32 v163, v163, v131
v_add_f32 v160, v160, v96
v_add_f32 v161, v161, v97
v_add_f32 v162, v162, v98
v_add_f32 v163, v163, v99
v_cvt_pk_bf16_f32 v30, v160, v161
v_cvt_pk_bf16_f32 v31, v162, v163
s_waitcnt lgkmcnt(4)
v_add_f32 v100, v100, v116
v_add_f32 v101, v101, v117
v_add_f32 v102, v102, v118
v_add_f32 v103, v103, v119
s_waitcnt lgkmcnt(3)
v_add_f32 v164, v164, v132
v_add_f32 v165, v165, v133
v_add_f32 v166, v166, v134
v_add_f32 v167, v167, v135
v_add_f32 v164, v164, v100
v_add_f32 v165, v165, v101
v_add_f32 v166, v166, v102
v_add_f32 v167, v167, v103
v_cvt_pk_bf16_f32 v32, v164, v165
v_cvt_pk_bf16_f32 v33, v166, v167
s_waitcnt lgkmcnt(1)
v_add_f32 v104, v104, v120
v_add_f32 v105, v105, v121
v_add_f32 v106, v106, v122
v_add_f32 v107, v107, v123
s_waitcnt lgkmcnt(0)
v_add_f32 v168, v168, v136
v_add_f32 v169, v169, v137
v_add_f32 v170, v170, v138
v_add_f32 v171, v171, v139
v_add_f32 v168, v168, v104
v_add_f32 v169, v169, v105
v_add_f32 v170, v170, v106
v_add_f32 v171, v171, v107
v_cvt_pk_bf16_f32 v34, v168, v169
v_cvt_pk_bf16_f32 v35, v170, v171
v_permlane32_swap_b32 v28, v30
v_permlane32_swap_b32 v29, v31
buffer_store_dwordx4 v[28:31], v10, s[24:27], 0 offen offset:0
v_permlane32_swap_b32 v32, v34
v_permlane32_swap_b32 v33, v35
buffer_store_dwordx4 v[32:35], v10, s[24:27], 0 offen offset:32
s_endpgm
parallel_sum__mha_block__geglu_ffn__prompt_kernel_end:
s_endpgm

.section .rodata,"a"
.p2align 6
.amdhsa_kernel parallel_sum__mha_block__geglu_ffn__prompt_kernel
  .amdhsa_next_free_vgpr 256
  .amdhsa_next_free_sgpr 102
  .amdhsa_accum_offset 256
  .amdhsa_group_segment_fixed_size 0
  .amdhsa_kernarg_size 80
  .amdhsa_user_sgpr_count 2
  .amdhsa_user_sgpr_kernarg_segment_ptr 1
  .amdhsa_system_sgpr_workgroup_id_x 1
  .amdhsa_float_denorm_mode_32 3
.end_amdhsa_kernel
```
